```python
import torch

def _softmax(x, axis=-1):
    return torch.softmax(x, dim=axis)
def _gelu(x):
    return torch.nn.functional.gelu(x, approximate="tanh")
def _silu(x):
    return torch.nn.functional.silu(x)
def _sigmoid(x):
    return torch.sigmoid(x)
def _layernorm(x, axis=-1, eps=1e-5):
    m = x.mean(dim=axis, keepdim=True)
    v = x.var(dim=axis, keepdim=True, unbiased=False)
    return (x - m) / torch.sqrt(v + eps)
def _scatter_add(tgt, idx, src, axis=0):
    return tgt.clone().index_add_(axis, idx, src)
def _segment_sum(src, seg, n):
    out = torch.zeros((n,) + src.shape[1:], dtype=src.dtype)
    return out.index_add_(0, seg, src)
def _pad(x, pw):
    flat = tuple(v for pair in reversed(pw) for v in pair)
    return torch.nn.functional.pad(x, flat)

kernel_name = 'recurrent_scan__ssm_conv_s5__dense_activation_silu__prompt'

def setup_inputs():

    _w = (lambda a: (lambda t: t.to(torch.bfloat16) if t.is_floating_point() else t)(torch.as_tensor(a)))
    def _A_setup():
        B, S, D = 1, 2048, 576
        P = D
        Lambda_re = -0.5 * (lambda _x: torch.exp(torch.as_tensor(_x)))((lambda *s: torch.randn(*s, dtype=torch.bfloat16) * 0.8)(P))
        Lambda_im = (lambda *s: torch.randn(*s, dtype=torch.bfloat16) * 0.8)(P) * 1.0
        B_re = (lambda *s: torch.randn(*s, dtype=torch.bfloat16) * 0.8)(P, D) * (D ** -0.5)
        B_im = (lambda *s: torch.randn(*s, dtype=torch.bfloat16) * 0.8)(P, D) * (D ** -0.5)
        C_re = (lambda *s: torch.randn(*s, dtype=torch.bfloat16) * 0.8)(D, P) * (P ** -0.5)
        C_im = (lambda *s: torch.randn(*s, dtype=torch.bfloat16) * 0.8)(D, P) * (P ** -0.5)
        log_dt = (lambda *s: torch.randn(*s, dtype=torch.bfloat16) * 0.8)(P) * 0.3 - 2.0
        Dskip = (lambda *s: torch.randn(*s, dtype=torch.bfloat16) * 0.4)(D)
        return {
            "x": _w((lambda *s: torch.randn(*s, dtype=torch.bfloat16) * 0.05)(B, S, D)),
            "Lambda_re": _w(Lambda_re),
            "Lambda_im": _w(Lambda_im),
            "B_re": _w(B_re),
            "B_im": _w(B_im),
            "C_re": _w(C_re),
            "C_im": _w(C_im),
            "log_dt": _w(log_dt),
            "Dskip": _w(Dskip),
        }
    _A_in = _A_setup()

    def _B_setup():
        B, S, D, F = 1, 2048, 576, 4608
        return {
            "x": _w((lambda *s: torch.randn(*s, dtype=torch.bfloat16) * 0.05)(B, S, D)),
            "w1": _w((lambda *s: torch.randn(*s, dtype=torch.bfloat16) * 0.8)(D, F) * (D ** -0.5)),
            "w2": _w((lambda *s: torch.randn(*s, dtype=torch.bfloat16) * 0.1)(F, D) * (F ** -0.5)),
        }
    _B_in = _B_setup()

    return {
        "A_x": _A_in["x"],
        "A_Lambda_re": _A_in["Lambda_re"],
        "A_Lambda_im": _A_in["Lambda_im"],
        "A_B_re": _A_in["B_re"],
        "A_B_im": _A_in["B_im"],
        "A_C_re": _A_in["C_re"],
        "A_C_im": _A_in["C_im"],
        "A_log_dt": _A_in["log_dt"],
        "A_Dskip": _A_in["Dskip"],
        "B_x": _B_in["x"],
        "B_w1": _B_in["w1"],
        "B_w2": _B_in["w2"],
    }

def reference(A_x, A_Lambda_re, A_Lambda_im, A_B_re, A_B_im, A_C_re, A_C_im, A_log_dt, A_Dskip, B_x, B_w1, B_w2):
    def _A_ref(x, Lambda_re, Lambda_im, B_re, B_im, C_re, C_im, log_dt, Dskip):
        Bsz, L, H = x.shape
        Lam = Lambda_re + 1j * Lambda_im
        Bmat = B_re + 1j * B_im
        Cmat = C_re + 1j * C_im
        dt = torch.exp(log_dt)
        Lam_bar = torch.exp(dt * Lam)
        B_bar = ((Lam_bar - 1.0) / Lam)[:, None] * Bmat
        Bu = torch.einsum("bld,pd->blp", x + 0j, B_bar)
        h = torch.zeros_like(Bu[:, 0, :])
        hs = []
        for t in range(L):
            h = Lam_bar[None, :] * h + Bu[:, t, :]
            hs.append(h)
        hseq = torch.stack(hs, 1)
        y = 2.0 * torch.einsum("blp,dp->bld", hseq, Cmat).real + x * Dskip[None, None, :]
        return y

    def _B_ref(x, w1, w2):
        h = torch.einsum("bsd,df->bsf", x, w1)
        h = _silu(h)
        out = torch.einsum("bsf,fd->bsd", h, w2)
        return out

    x = A_x
    xn = _layernorm(x, axis=-1)
    s = _A_ref(xn, A_Lambda_re, A_Lambda_im, A_B_re, A_B_im, A_C_re, A_C_im, A_log_dt, A_Dskip)
    g = _silu(_B_ref(xn, B_w1, B_w2))
    return x + s * g
```

```asm
; @launch grid=(256,1,1) block=(512,1,1) lds=163840
.amdgcn_target "amdgcn-amd-amdhsa--gfx950"
.text
.globl recurrent_scan__ssm_conv_s5__dense_activation_silu__prompt_kernel
.p2align 8
.type recurrent_scan__ssm_conv_s5__dense_activation_silu__prompt_kernel,@function
recurrent_scan__ssm_conv_s5__dense_activation_silu__prompt_kernel:
  s_cmp_ge_u32 s2, 256
  s_cbranch_scc1 L_end
  s_load_dwordx16 s[60:75], s[0:1], 0
  s_load_dwordx8 s[76:83], s[0:1], 64
  s_load_dwordx4 s[84:87], s[0:1], 96
  s_load_dwordx2 s[88:89], s[0:1], 112
  v_lshrrev_b32 v83, 6, v0
  v_and_b32 v64, 63, v0
  v_readfirstlane_b32 s24, v83
  s_and_b32 s3, s2, 7
  s_lshr_b32 s28, s3, 1
  s_and_b32 s27, s3, 1
  s_lshl_b32 s27, s27, 3
  s_lshr_b32 s3, s2, 5
  s_add_u32 s27, s27, s3
  s_lshr_b32 s3, s2, 3
  s_and_b32 s29, s3, 3
  s_and_b32 s25, s24, 3
  s_lshr_b32 s26, s24, 2
  v_lshrrev_b32 v65, 3, v64
  v_and_b32 v66, 7, v64
  v_lshrrev_b32 v67, 2, v65
  v_and_b32 v83, 3, v65
  v_lshl_add_u32 v67, v67, 3, v83
  v_mul_u32_u24 v68, 1152, v67
  v_lshl_add_u32 v68, v66, 4, v68
  s_lshl_b32 s43, s24, 4
  s_lshl_b32 s42, s27, 7
  s_add_u32 s42, s42, s43
  s_mul_i32 s44, s42, 1152
  s_cmp_eq_u32 s29, 3
  s_cselect_b32 s43, 0, s28
  s_and_b32 s43, s43, 1
  s_mul_i32 s43, s43, 4608
  s_add_u32 s45, s44, 4608
  s_add_u32 s44, s44, s43
  s_sub_u32 s45, s45, s43
  v_mov_b32 v69, v0
  v_lshlrev_b32 v0, 4, v64
  s_getpc_b64 s[20:21]
L_pc:
  s_sub_u32 s20, s20, L_pc-recurrent_scan__ssm_conv_s5__dense_activation_silu__prompt_kernel
  s_subb_u32 s21, s21, 0
  s_andn2_b32 s46, s2, 7
  s_add_u32 s46, s46, s24
  s_lshl_b32 s46, s46, 7
  v_lshl_add_u32 v84, v64, 15, s46
  v_mov_b32 v85, s21
  v_cmp_gt_u32 vcc, L_code_end-recurrent_scan__ssm_conv_s5__dense_activation_silu__prompt_kernel, v84
  s_nop 0
  s_mov_b64 s[46:47], vcc
  v_add_co_u32 v84, vcc, s20, v84
  s_nop 1
  v_addc_co_u32 v85, vcc, 0, v85, vcc
  s_mov_b64 exec, s[46:47]
  global_load_dword v77, v[84:85], off
  s_mov_b64 exec, -1
  v_mul_u32_u24 v106, 456, v69
  v_lshrrev_b32 v106, 16, v106
  v_mul_u32_u24 v107, 144, v106
  v_sub_u32 v107, v69, v107
  s_mul_i32 s46, s28, 144
  v_add_lshl_u32 v108, v107, s46, 1
  s_waitcnt lgkmcnt(0)
  global_load_ushort v109, v108, s[62:63]
  global_load_ushort v110, v108, s[64:65]
  global_load_ushort v111, v108, s[74:75]
  s_mov_b32 s4, s60
  s_mov_b32 s5, s61
  s_mov_b32 s6, 2359296
  s_mov_b32 s7, 0x20000
  buffer_load_dwordx4 v[184:187], v68, s[4:7], s44 offen offset:0
  buffer_load_dwordx4 v[188:191], v68, s[4:7], s44 offen offset:128
  buffer_load_dwordx4 v[192:195], v68, s[4:7], s44 offen offset:256
  buffer_load_dwordx4 v[196:199], v68, s[4:7], s44 offen offset:384
  buffer_load_dwordx4 v[200:203], v68, s[4:7], s44 offen offset:512
  buffer_load_dwordx4 v[204:207], v68, s[4:7], s44 offen offset:640
  buffer_load_dwordx4 v[208:211], v68, s[4:7], s44 offen offset:768
  buffer_load_dwordx4 v[212:215], v68, s[4:7], s44 offen offset:896
  buffer_load_dwordx4 v[216:219], v68, s[4:7], s44 offen offset:1024
  s_cmp_eq_u32 s29, 3
  s_cbranch_scc1 L_ssm
  s_mov_b32 s52, 0x3f803f80
  s_lshl_b32 s46, s27, 7
  s_load_dword s30, s[88:89], s46
  s_mul_i32 s35, s24, 3072
  s_mov_b32 s50, 0x00003f80
  s_mov_b32 s51, 0x3f800000
  v_and_b32 v73, 15, v64
  v_lshrrev_b32 v74, 4, v64
  s_mov_b32 s8, s80
  s_mov_b32 s9, s81
  s_mov_b32 s10, 5308416
  s_mov_b32 s11, 0x20000
  v_and_b32 v92, 6, v65
  v_xor_b32 v92, v92, v66
  v_lshlrev_b32 v92, 4, v92
  s_movk_i32 s46, 0x2400
  v_mul_lo_u32 v1, v67, s46
  v_add_u32 v1, v1, v92
  v_mul_u32_u24 v2, 1152, v65
  v_add_u32 v2, v2, v92
  s_mul_i32 s46, s28, 2304
  s_mul_i32 s47, s29, 768
  s_add_u32 s46, s46, s47
  s_lshl_b32 s47, s26, 5
  s_and_b32 s48, s24, 1
  s_lshl_b32 s48, s48, 4
  s_add_u32 s47, s47, s48
  s_and_b32 s48, s24, 2
  s_lshl_b32 s48, s48, 1
  s_add_u32 s47, s47, s48
  s_mul_i32 s32, s47, 9216
  s_add_u32 s32, s32, s46
  s_lshl_b32 s33, s24, 10
  s_and_b32 s46, s27, 7
  s_mul_i32 s46, s46, 3
  s_add_u32 s46, s46, s29
  s_lshl_b32 s46, s46, 3
  s_add_u32 s46, s46, s24
  v_mul_u32_u24 v92, 57, v64
  v_lshrrev_b32 v92, 10, v92
  v_mul_u32_u24 v104, 6912, v92
  v_lshl_add_u32 v104, v64, 7, v104
  v_lshlrev_b32 v105, 7, v64
  s_mul_i32 s57, s46, 27648
  s_mul_i32 s48, s28, 2304
  s_add_u32 s57, s57, s48
  s_mul_i32 s58, s46, 6912
  s_mul_i32 s48, s28, 1327104
  s_add_u32 s58, s58, s48
  v_mul_u32_u24 v92, 342, v64
  v_lshrrev_b32 v92, 10, v92
  v_mul_u32_u24 v44, 768, v92
  v_lshl_add_u32 v44, v64, 7, v44
  s_mul_i32 s47, s46, 3456
  s_lshl_b32 s48, s28, 8
  s_add_u32 s47, s47, s48
  v_add_u32 v44, s47, v44
  v_bfe_u32 v92, v64, 2, 3
  v_lshrrev_b32 v93, 1, v92
  v_and_b32 v94, 3, v64
  v_lshlrev_b32 v94, 3, v94
  v_lshl_add_u32 v94, v92, 7, v94
  v_lshrrev_b32 v95, 5, v64
  s_lshl_b32 s47, s26, 1
  v_xor_b32 v96, s47, v93
  v_lshl_add_u32 v97, v95, 10, v94
  v_lshl_add_u32 v3, v96, 5, v97
  v_xor_b32 v4, 32, v3
  v_add_u32 v5, 49152, v3
  v_add_u32 v6, 49152, v4
  v_add_u32 v7, 98304, v3
  v_add_u32 v8, 98304, v4
  s_and_b32 s47, s28, 2
  s_xor_b32 s47, s47, s26
  v_xor_b32 v96, s47, v93
  s_mul_i32 s48, s26, 12288
  v_mul_u32_u24 v97, 3072, v95
  v_add3_u32 v97, v97, s48, v94
  v_xor_b32 v20, 0, v96
  v_lshl_add_u32 v20, v20, 5, v97
  v_xor_b32 v21, 1, v96
  v_lshl_add_u32 v21, v21, 5, v97
  v_xor_b32 v22, 2, v96
  v_lshl_add_u32 v22, v22, 5, v97
  v_xor_b32 v23, 3, v96
  v_lshl_add_u32 v23, v23, 5, v97
  v_lshrrev_b32 v98, 2, v73
  v_and_b32 v99, 3, v73
  v_lshl_add_u32 v98, v98, 3, v99
  s_lshl_b32 s46, s25, 8
  s_add_u32 s46, s46, 162816
  v_lshl_add_u32 v98, v98, 3, s46
  s_bfe_u32 s46, s42, 0x60001
  v_add_u32 v100, s46, v65
  v_mul_u32_u24 v100, 192, v100
  v_and_b32 v101, 3, v66
  v_lshl_add_u32 v100, v101, 4, v100
  v_add_u32 v100, 147456, v100
  s_bitcmp1_b32 s28, 1
  s_cselect_b32 s53, 4, 0
  s_mul_i32 s46, s25, 18432
  s_add_u32 s46, s46, 73728
  v_xor_b32 v70, v65, v66
  s_bfe_u32 s47, s42, 0x20005
  s_mul_i32 s47, s47, 18432
  s_and_b32 s48, s42, 16
  s_lshl_b32 s48, s48, 3
  s_add_u32 s47, s47, s48
  s_add_u32 s47, s47, 73728
  v_lshlrev_b32 v70, 4, v70
  v_lshl_add_u32 v70, v66, 8, v70
  v_add_u32 v70, s47, v70
  v_xor_b32 v71, v73, v74
  v_lshlrev_b32 v71, 4, v71
  v_lshl_add_u32 v71, v74, 8, v71
  v_add_u32 v71, s46, v71
  v_xor_b32 v72, 64, v71
  s_and_b32 s48, s42, 127
  v_add_u32 v75, s48, v67
  v_lshlrev_b32 v75, 3, v75
  v_add_u32 v82, 162816, v75
  s_waitcnt vmcnt(8)
  buffer_load_dwordx4 v[220:223], v68, s[4:7], s45 offen offset:0
  v_dot2_f32_bf16 v76, v184, s52, 0
  v_dot2_f32_bf16 v78, v184, v184, 0
  v_dot2_f32_bf16 v77, v185, s52, 0
  v_dot2_f32_bf16 v79, v185, v185, 0
  v_dot2_f32_bf16 v76, v186, s52, v76
  v_dot2_f32_bf16 v78, v186, v186, v78
  v_dot2_f32_bf16 v77, v187, s52, v77
  v_dot2_f32_bf16 v79, v187, v187, v79
  s_waitcnt vmcnt(8)
  buffer_load_dwordx4 v[224:227], v68, s[4:7], s45 offen offset:128
  v_dot2_f32_bf16 v76, v188, s52, v76
  v_dot2_f32_bf16 v78, v188, v188, v78
  v_dot2_f32_bf16 v77, v189, s52, v77
  v_dot2_f32_bf16 v79, v189, v189, v79
  v_dot2_f32_bf16 v76, v190, s52, v76
  v_dot2_f32_bf16 v78, v190, v190, v78
  v_dot2_f32_bf16 v77, v191, s52, v77
  v_dot2_f32_bf16 v79, v191, v191, v79
  s_waitcnt vmcnt(8)
  buffer_load_dwordx4 v[228:231], v68, s[4:7], s45 offen offset:256
  v_dot2_f32_bf16 v76, v192, s52, v76
  v_dot2_f32_bf16 v78, v192, v192, v78
  v_dot2_f32_bf16 v77, v193, s52, v77
  v_dot2_f32_bf16 v79, v193, v193, v79
  v_dot2_f32_bf16 v76, v194, s52, v76
  v_dot2_f32_bf16 v78, v194, v194, v78
  v_dot2_f32_bf16 v77, v195, s52, v77
  v_dot2_f32_bf16 v79, v195, v195, v79
  s_waitcnt vmcnt(8)
  buffer_load_dwordx4 v[232:235], v68, s[4:7], s45 offen offset:384
  v_dot2_f32_bf16 v76, v196, s52, v76
  v_dot2_f32_bf16 v78, v196, v196, v78
  v_dot2_f32_bf16 v77, v197, s52, v77
  v_dot2_f32_bf16 v79, v197, v197, v79
  v_dot2_f32_bf16 v76, v198, s52, v76
  v_dot2_f32_bf16 v78, v198, v198, v78
  v_dot2_f32_bf16 v77, v199, s52, v77
  v_dot2_f32_bf16 v79, v199, v199, v79
  s_waitcnt vmcnt(8)
  buffer_load_dwordx4 v[236:239], v68, s[4:7], s45 offen offset:512
  v_dot2_f32_bf16 v76, v200, s52, v76
  v_dot2_f32_bf16 v78, v200, v200, v78
  v_dot2_f32_bf16 v77, v201, s52, v77
  v_dot2_f32_bf16 v79, v201, v201, v79
  v_dot2_f32_bf16 v76, v202, s52, v76
  v_dot2_f32_bf16 v78, v202, v202, v78
  v_dot2_f32_bf16 v77, v203, s52, v77
  v_dot2_f32_bf16 v79, v203, v203, v79
  s_waitcnt vmcnt(8)
  buffer_load_dwordx4 v[240:243], v68, s[4:7], s45 offen offset:640
  v_dot2_f32_bf16 v76, v204, s52, v76
  v_dot2_f32_bf16 v78, v204, v204, v78
  v_dot2_f32_bf16 v77, v205, s52, v77
  v_dot2_f32_bf16 v79, v205, v205, v79
  v_dot2_f32_bf16 v76, v206, s52, v76
  v_dot2_f32_bf16 v78, v206, v206, v78
  v_dot2_f32_bf16 v77, v207, s52, v77
  v_dot2_f32_bf16 v79, v207, v207, v79
  s_waitcnt vmcnt(8)
  buffer_load_dwordx4 v[244:247], v68, s[4:7], s45 offen offset:768
  v_dot2_f32_bf16 v76, v208, s52, v76
  v_dot2_f32_bf16 v78, v208, v208, v78
  v_dot2_f32_bf16 v77, v209, s52, v77
  v_dot2_f32_bf16 v79, v209, v209, v79
  v_dot2_f32_bf16 v76, v210, s52, v76
  v_dot2_f32_bf16 v78, v210, v210, v78
  v_dot2_f32_bf16 v77, v211, s52, v77
  v_dot2_f32_bf16 v79, v211, v211, v79
  s_waitcnt vmcnt(8)
  buffer_load_dwordx4 v[248:251], v68, s[4:7], s45 offen offset:896
  v_dot2_f32_bf16 v76, v212, s52, v76
  v_dot2_f32_bf16 v78, v212, v212, v78
  v_dot2_f32_bf16 v77, v213, s52, v77
  v_dot2_f32_bf16 v79, v213, v213, v79
  v_dot2_f32_bf16 v76, v214, s52, v76
  v_dot2_f32_bf16 v78, v214, v214, v78
  v_dot2_f32_bf16 v77, v215, s52, v77
  v_dot2_f32_bf16 v79, v215, v215, v79
  s_waitcnt vmcnt(8)
  buffer_load_dwordx4 v[252:255], v68, s[4:7], s45 offen offset:1024
  v_dot2_f32_bf16 v76, v216, s52, v76
  v_dot2_f32_bf16 v78, v216, v216, v78
  v_dot2_f32_bf16 v77, v217, s52, v77
  v_dot2_f32_bf16 v79, v217, v217, v79
  v_dot2_f32_bf16 v76, v218, s52, v76
  v_dot2_f32_bf16 v78, v218, v218, v78
  v_dot2_f32_bf16 v77, v219, s52, v77
  v_dot2_f32_bf16 v79, v219, v219, v79
  s_mov_b32 exec_lo, 0x41041041
  s_mov_b32 exec_hi, 0x10410
  buffer_load_dword v19, v104, s[8:11], s57 offen
  s_mov_b64 exec, -1
  s_lshl_b32 exec_lo, 0x0f0f0f0f, s53
  s_mov_b32 exec_hi, exec_lo
  s_cmp_lg_u32 s29, 0
  s_cbranch_scc1 L_xs_2
  ds_write_b128 v100, v[184:187] offset:0
  ds_write_b128 v100, v[188:191] offset:64
  ds_write_b128 v100, v[192:195] offset:128
  s_branch L_xs_1
L_xs_2:
  s_cmp_lg_u32 s29, 1
  s_cbranch_scc1 L_xs_3
  ds_write_b128 v100, v[196:199] offset:0
  ds_write_b128 v100, v[200:203] offset:64
  ds_write_b128 v100, v[204:207] offset:128
  s_branch L_xs_1
L_xs_3:
  ds_write_b128 v100, v[208:211] offset:0
  ds_write_b128 v100, v[212:215] offset:64
  ds_write_b128 v100, v[216:219] offset:128
L_xs_1:
  s_mov_b64 exec, -1
  v_add_f32 v76, v76, v77
  v_add_f32 v78, v78, v79
  s_nop 0
  v_add_f32_dpp v76, v76, v76 quad_perm:[1,0,3,2] row_mask:0xf bank_mask:0xf
  v_add_f32_dpp v78, v78, v78 quad_perm:[1,0,3,2] row_mask:0xf bank_mask:0xf
  s_nop 0
  v_add_f32_dpp v76, v76, v76 quad_perm:[2,3,0,1] row_mask:0xf bank_mask:0xf
  v_add_f32_dpp v78, v78, v78 quad_perm:[2,3,0,1] row_mask:0xf bank_mask:0xf
  s_nop 0
  v_add_f32_dpp v76, v76, v76 row_half_mirror row_mask:0xf bank_mask:0xf
  v_add_f32_dpp v78, v78, v78 row_half_mirror row_mask:0xf bank_mask:0xf
  v_mul_f32 v76, 0x3ae38e39, v76
  v_mul_f32 v78, 0x3ae38e39, v78
  v_fma_f32 v78, -v76, v76, v78
  v_max_f32 v78, 0, v78
  v_cvt_pk_bf16_f32 v77, v76, v78
  v_lshlrev_b32 v81, 16, v77
  v_and_b32 v78, 0xffff0000, v77
  v_add_f32 v78, 0x3727c5ac, v78
  v_cvt_pk_bf16_f32 v78, v78, v78
  v_and_b32 v78, 0xffff0000, v78
  v_sqrt_f32 v78, v78
  s_nop 0
  v_cvt_pk_bf16_f32 v78, v78, v78
  v_and_b32 v80, 0xffff0000, v78
  ds_write_b64 v82, v[80:81] offset:0
  v_dot2_f32_bf16 v84, v184, s50, v81 neg_lo:[0,0,1]
  v_dot2_f32_bf16 v85, v184, s51, v81 neg_lo:[0,0,1]
  v_dot2_f32_bf16 v86, v185, s50, v81 neg_lo:[0,0,1]
  v_dot2_f32_bf16 v87, v185, s51, v81 neg_lo:[0,0,1]
  v_dot2_f32_bf16 v88, v186, s50, v81 neg_lo:[0,0,1]
  v_dot2_f32_bf16 v89, v186, s51, v81 neg_lo:[0,0,1]
  v_dot2_f32_bf16 v90, v187, s50, v81 neg_lo:[0,0,1]
  v_dot2_f32_bf16 v91, v187, s51, v81 neg_lo:[0,0,1]
  v_cvt_pk_bf16_f32 v184, v84, v85
  v_cvt_pk_bf16_f32 v185, v86, v87
  v_cvt_pk_bf16_f32 v186, v88, v89
  v_cvt_pk_bf16_f32 v187, v90, v91
  ds_write_b128 v70, v[184:187] offset:0
  v_dot2_f32_bf16 v84, v188, s50, v81 neg_lo:[0,0,1]
  v_dot2_f32_bf16 v85, v188, s51, v81 neg_lo:[0,0,1]
  v_dot2_f32_bf16 v86, v189, s50, v81 neg_lo:[0,0,1]
  v_dot2_f32_bf16 v87, v189, s51, v81 neg_lo:[0,0,1]
  v_dot2_f32_bf16 v88, v190, s50, v81 neg_lo:[0,0,1]
  v_dot2_f32_bf16 v89, v190, s51, v81 neg_lo:[0,0,1]
  v_dot2_f32_bf16 v90, v191, s50, v81 neg_lo:[0,0,1]
  v_dot2_f32_bf16 v91, v191, s51, v81 neg_lo:[0,0,1]
  v_cvt_pk_bf16_f32 v188, v84, v85
  v_cvt_pk_bf16_f32 v189, v86, v87
  v_cvt_pk_bf16_f32 v190, v88, v89
  v_cvt_pk_bf16_f32 v191, v90, v91
  ds_write_b128 v70, v[188:191] offset:2048
  v_dot2_f32_bf16 v84, v192, s50, v81 neg_lo:[0,0,1]
  v_dot2_f32_bf16 v85, v192, s51, v81 neg_lo:[0,0,1]
  v_dot2_f32_bf16 v86, v193, s50, v81 neg_lo:[0,0,1]
  v_dot2_f32_bf16 v87, v193, s51, v81 neg_lo:[0,0,1]
  v_dot2_f32_bf16 v88, v194, s50, v81 neg_lo:[0,0,1]
  v_dot2_f32_bf16 v89, v194, s51, v81 neg_lo:[0,0,1]
  v_dot2_f32_bf16 v90, v195, s50, v81 neg_lo:[0,0,1]
  v_dot2_f32_bf16 v91, v195, s51, v81 neg_lo:[0,0,1]
  v_cvt_pk_bf16_f32 v192, v84, v85
  v_cvt_pk_bf16_f32 v193, v86, v87
  v_cvt_pk_bf16_f32 v194, v88, v89
  v_cvt_pk_bf16_f32 v195, v90, v91
  ds_write_b128 v70, v[192:195] offset:4096
  v_dot2_f32_bf16 v84, v196, s50, v81 neg_lo:[0,0,1]
  v_dot2_f32_bf16 v85, v196, s51, v81 neg_lo:[0,0,1]
  v_dot2_f32_bf16 v86, v197, s50, v81 neg_lo:[0,0,1]
  v_dot2_f32_bf16 v87, v197, s51, v81 neg_lo:[0,0,1]
  v_dot2_f32_bf16 v88, v198, s50, v81 neg_lo:[0,0,1]
  v_dot2_f32_bf16 v89, v198, s51, v81 neg_lo:[0,0,1]
  v_dot2_f32_bf16 v90, v199, s50, v81 neg_lo:[0,0,1]
  v_dot2_f32_bf16 v91, v199, s51, v81 neg_lo:[0,0,1]
  v_cvt_pk_bf16_f32 v196, v84, v85
  v_cvt_pk_bf16_f32 v197, v86, v87
  v_cvt_pk_bf16_f32 v198, v88, v89
  v_cvt_pk_bf16_f32 v199, v90, v91
  ds_write_b128 v70, v[196:199] offset:6144
  v_dot2_f32_bf16 v84, v200, s50, v81 neg_lo:[0,0,1]
  v_dot2_f32_bf16 v85, v200, s51, v81 neg_lo:[0,0,1]
  v_dot2_f32_bf16 v86, v201, s50, v81 neg_lo:[0,0,1]
  v_dot2_f32_bf16 v87, v201, s51, v81 neg_lo:[0,0,1]
  v_dot2_f32_bf16 v88, v202, s50, v81 neg_lo:[0,0,1]
  v_dot2_f32_bf16 v89, v202, s51, v81 neg_lo:[0,0,1]
  v_dot2_f32_bf16 v90, v203, s50, v81 neg_lo:[0,0,1]
  v_dot2_f32_bf16 v91, v203, s51, v81 neg_lo:[0,0,1]
  v_cvt_pk_bf16_f32 v200, v84, v85
  v_cvt_pk_bf16_f32 v201, v86, v87
  v_cvt_pk_bf16_f32 v202, v88, v89
  v_cvt_pk_bf16_f32 v203, v90, v91
  ds_write_b128 v70, v[200:203] offset:8192
  v_dot2_f32_bf16 v84, v204, s50, v81 neg_lo:[0,0,1]
  v_dot2_f32_bf16 v85, v204, s51, v81 neg_lo:[0,0,1]
  v_dot2_f32_bf16 v86, v205, s50, v81 neg_lo:[0,0,1]
  v_dot2_f32_bf16 v87, v205, s51, v81 neg_lo:[0,0,1]
  v_dot2_f32_bf16 v88, v206, s50, v81 neg_lo:[0,0,1]
  v_dot2_f32_bf16 v89, v206, s51, v81 neg_lo:[0,0,1]
  v_dot2_f32_bf16 v90, v207, s50, v81 neg_lo:[0,0,1]
  v_dot2_f32_bf16 v91, v207, s51, v81 neg_lo:[0,0,1]
  v_cvt_pk_bf16_f32 v204, v84, v85
  v_cvt_pk_bf16_f32 v205, v86, v87
  v_cvt_pk_bf16_f32 v206, v88, v89
  v_cvt_pk_bf16_f32 v207, v90, v91
  ds_write_b128 v70, v[204:207] offset:10240
  v_dot2_f32_bf16 v84, v208, s50, v81 neg_lo:[0,0,1]
  v_dot2_f32_bf16 v85, v208, s51, v81 neg_lo:[0,0,1]
  v_dot2_f32_bf16 v86, v209, s50, v81 neg_lo:[0,0,1]
  v_dot2_f32_bf16 v87, v209, s51, v81 neg_lo:[0,0,1]
  v_dot2_f32_bf16 v88, v210, s50, v81 neg_lo:[0,0,1]
  v_dot2_f32_bf16 v89, v210, s51, v81 neg_lo:[0,0,1]
  v_dot2_f32_bf16 v90, v211, s50, v81 neg_lo:[0,0,1]
  v_dot2_f32_bf16 v91, v211, s51, v81 neg_lo:[0,0,1]
  v_cvt_pk_bf16_f32 v208, v84, v85
  v_cvt_pk_bf16_f32 v209, v86, v87
  v_cvt_pk_bf16_f32 v210, v88, v89
  v_cvt_pk_bf16_f32 v211, v90, v91
  ds_write_b128 v70, v[208:211] offset:12288
  v_dot2_f32_bf16 v84, v212, s50, v81 neg_lo:[0,0,1]
  v_dot2_f32_bf16 v85, v212, s51, v81 neg_lo:[0,0,1]
  v_dot2_f32_bf16 v86, v213, s50, v81 neg_lo:[0,0,1]
  v_dot2_f32_bf16 v87, v213, s51, v81 neg_lo:[0,0,1]
  v_dot2_f32_bf16 v88, v214, s50, v81 neg_lo:[0,0,1]
  v_dot2_f32_bf16 v89, v214, s51, v81 neg_lo:[0,0,1]
  v_dot2_f32_bf16 v90, v215, s50, v81 neg_lo:[0,0,1]
  v_dot2_f32_bf16 v91, v215, s51, v81 neg_lo:[0,0,1]
  v_cvt_pk_bf16_f32 v212, v84, v85
  v_cvt_pk_bf16_f32 v213, v86, v87
  v_cvt_pk_bf16_f32 v214, v88, v89
  v_cvt_pk_bf16_f32 v215, v90, v91
  ds_write_b128 v70, v[212:215] offset:14336
  v_dot2_f32_bf16 v84, v216, s50, v81 neg_lo:[0,0,1]
  v_dot2_f32_bf16 v85, v216, s51, v81 neg_lo:[0,0,1]
  v_dot2_f32_bf16 v86, v217, s50, v81 neg_lo:[0,0,1]
  v_dot2_f32_bf16 v87, v217, s51, v81 neg_lo:[0,0,1]
  v_dot2_f32_bf16 v88, v218, s50, v81 neg_lo:[0,0,1]
  v_dot2_f32_bf16 v89, v218, s51, v81 neg_lo:[0,0,1]
  v_dot2_f32_bf16 v90, v219, s50, v81 neg_lo:[0,0,1]
  v_dot2_f32_bf16 v91, v219, s51, v81 neg_lo:[0,0,1]
  v_cvt_pk_bf16_f32 v216, v84, v85
  v_cvt_pk_bf16_f32 v217, v86, v87
  v_cvt_pk_bf16_f32 v218, v88, v89
  v_cvt_pk_bf16_f32 v219, v90, v91
  ds_write_b128 v70, v[216:219] offset:16384
  s_mov_b32 exec_lo, 0x82082082
  s_mov_b32 exec_hi, 0x20820
  buffer_load_dword v19, v104, s[8:11], s57 offen
  s_mov_b64 exec, -1
  s_waitcnt lgkmcnt(0)
  s_barrier
  ds_read_b128 v[112:115], v71 offset:0
  ds_read_b128 v[116:119], v72 offset:1024
  ds_read_b128 v[120:123], v71 offset:2048
  ds_read_b128 v[124:127], v72 offset:3072
  ds_read_b128 v[128:131], v71 offset:4096
  ds_read_b128 v[132:135], v72 offset:5120
  ds_read_b128 v[136:139], v71 offset:6144
  ds_read_b128 v[140:143], v72 offset:7168
  ds_read_b128 v[144:147], v71 offset:8192
  ds_read_b128 v[148:151], v72 offset:9216
  ds_read_b128 v[152:155], v71 offset:10240
  ds_read_b128 v[156:159], v72 offset:11264
  ds_read_b128 v[160:163], v71 offset:12288
  ds_read_b128 v[164:167], v72 offset:13312
  ds_read_b128 v[168:171], v71 offset:14336
  ds_read_b128 v[172:175], v72 offset:15360
  ds_read_b128 v[176:179], v71 offset:16384
  ds_read_b128 v[180:183], v72 offset:17408
  s_waitcnt vmcnt(10)
  v_dot2_f32_bf16 v76, v220, s52, 0
  v_dot2_f32_bf16 v78, v220, v220, 0
  v_dot2_f32_bf16 v77, v221, s52, 0
  v_dot2_f32_bf16 v79, v221, v221, 0
  v_dot2_f32_bf16 v76, v222, s52, v76
  v_dot2_f32_bf16 v78, v222, v222, v78
  v_dot2_f32_bf16 v77, v223, s52, v77
  v_dot2_f32_bf16 v79, v223, v223, v79
  s_waitcnt vmcnt(9)
  v_dot2_f32_bf16 v76, v224, s52, v76
  v_dot2_f32_bf16 v78, v224, v224, v78
  v_dot2_f32_bf16 v77, v225, s52, v77
  v_dot2_f32_bf16 v79, v225, v225, v79
  v_dot2_f32_bf16 v76, v226, s52, v76
  v_dot2_f32_bf16 v78, v226, v226, v78
  v_dot2_f32_bf16 v77, v227, s52, v77
  v_dot2_f32_bf16 v79, v227, v227, v79
  s_waitcnt vmcnt(8)
  v_dot2_f32_bf16 v76, v228, s52, v76
  v_dot2_f32_bf16 v78, v228, v228, v78
  v_dot2_f32_bf16 v77, v229, s52, v77
  v_dot2_f32_bf16 v79, v229, v229, v79
  v_dot2_f32_bf16 v76, v230, s52, v76
  v_dot2_f32_bf16 v78, v230, v230, v78
  v_dot2_f32_bf16 v77, v231, s52, v77
  v_dot2_f32_bf16 v79, v231, v231, v79
  s_waitcnt vmcnt(7)
  v_dot2_f32_bf16 v76, v232, s52, v76
  v_dot2_f32_bf16 v78, v232, v232, v78
  v_dot2_f32_bf16 v77, v233, s52, v77
  v_dot2_f32_bf16 v79, v233, v233, v79
  v_dot2_f32_bf16 v76, v234, s52, v76
  v_dot2_f32_bf16 v78, v234, v234, v78
  v_dot2_f32_bf16 v77, v235, s52, v77
  v_dot2_f32_bf16 v79, v235, v235, v79
  s_waitcnt vmcnt(6)
  v_dot2_f32_bf16 v76, v236, s52, v76
  v_dot2_f32_bf16 v78, v236, v236, v78
  v_dot2_f32_bf16 v77, v237, s52, v77
  v_dot2_f32_bf16 v79, v237, v237, v79
  v_dot2_f32_bf16 v76, v238, s52, v76
  v_dot2_f32_bf16 v78, v238, v238, v78
  v_dot2_f32_bf16 v77, v239, s52, v77
  v_dot2_f32_bf16 v79, v239, v239, v79
  s_waitcnt vmcnt(5)
  v_dot2_f32_bf16 v76, v240, s52, v76
  v_dot2_f32_bf16 v78, v240, v240, v78
  v_dot2_f32_bf16 v77, v241, s52, v77
  v_dot2_f32_bf16 v79, v241, v241, v79
  v_dot2_f32_bf16 v76, v242, s52, v76
  v_dot2_f32_bf16 v78, v242, v242, v78
  v_dot2_f32_bf16 v77, v243, s52, v77
  v_dot2_f32_bf16 v79, v243, v243, v79
  s_waitcnt vmcnt(4)
  s_add_u32 m0, s33, 0
  s_add_u32 s49, s32, 0
  buffer_load_dwordx4 v1, s[8:11], s49 offen lds
  v_dot2_f32_bf16 v76, v244, s52, v76
  v_dot2_f32_bf16 v78, v244, v244, v78
  v_dot2_f32_bf16 v77, v245, s52, v77
  v_dot2_f32_bf16 v79, v245, v245, v79
  v_dot2_f32_bf16 v76, v246, s52, v76
  v_dot2_f32_bf16 v78, v246, v246, v78
  v_dot2_f32_bf16 v77, v247, s52, v77
  v_dot2_f32_bf16 v79, v247, v247, v79
  s_waitcnt vmcnt(4)
  s_add_u32 m0, s33, 8192
  s_add_u32 s49, s32, 589824
  buffer_load_dwordx4 v1, s[8:11], s49 offen lds
  v_dot2_f32_bf16 v76, v248, s52, v76
  v_dot2_f32_bf16 v78, v248, v248, v78
  v_dot2_f32_bf16 v77, v249, s52, v77
  v_dot2_f32_bf16 v79, v249, v249, v79
  v_dot2_f32_bf16 v76, v250, s52, v76
  v_dot2_f32_bf16 v78, v250, v250, v78
  v_dot2_f32_bf16 v77, v251, s52, v77
  v_dot2_f32_bf16 v79, v251, v251, v79
  s_waitcnt vmcnt(4)
  s_add_u32 m0, s33, 16384
  s_add_u32 s49, s32, 1179648
  buffer_load_dwordx4 v1, s[8:11], s49 offen lds
  v_dot2_f32_bf16 v76, v252, s52, v76
  v_dot2_f32_bf16 v78, v252, v252, v78
  v_dot2_f32_bf16 v77, v253, s52, v77
  v_dot2_f32_bf16 v79, v253, v253, v79
  v_dot2_f32_bf16 v76, v254, s52, v76
  v_dot2_f32_bf16 v78, v254, v254, v78
  v_dot2_f32_bf16 v77, v255, s52, v77
  v_dot2_f32_bf16 v79, v255, v255, v79
  s_nop 1
  v_add_f32 v76, v76, v77
  v_add_f32 v78, v78, v79
  s_nop 0
  v_add_f32_dpp v76, v76, v76 quad_perm:[1,0,3,2] row_mask:0xf bank_mask:0xf
  v_add_f32_dpp v78, v78, v78 quad_perm:[1,0,3,2] row_mask:0xf bank_mask:0xf
  s_nop 0
  v_add_f32_dpp v76, v76, v76 quad_perm:[2,3,0,1] row_mask:0xf bank_mask:0xf
  v_add_f32_dpp v78, v78, v78 quad_perm:[2,3,0,1] row_mask:0xf bank_mask:0xf
  s_nop 0
  v_add_f32_dpp v76, v76, v76 row_half_mirror row_mask:0xf bank_mask:0xf
  v_add_f32_dpp v78, v78, v78 row_half_mirror row_mask:0xf bank_mask:0xf
  v_mul_f32 v76, 0x3ae38e39, v76
  v_mul_f32 v78, 0x3ae38e39, v78
  v_fma_f32 v78, -v76, v76, v78
  v_max_f32 v78, 0, v78
  v_cvt_pk_bf16_f32 v77, v76, v78
  v_lshlrev_b32 v81, 16, v77
  v_and_b32 v78, 0xffff0000, v77
  v_add_f32 v78, 0x3727c5ac, v78
  v_cvt_pk_bf16_f32 v78, v78, v78
  v_and_b32 v78, 0xffff0000, v78
  v_sqrt_f32 v78, v78
  s_nop 0
  v_cvt_pk_bf16_f32 v78, v78, v78
  v_and_b32 v80, 0xffff0000, v78
  ds_write_b64 v82, v[80:81] offset:32
  s_waitcnt lgkmcnt(0)
  s_barrier
  v_dot2_f32_bf16 v84, v220, s50, v81 neg_lo:[0,0,1]
  v_dot2_f32_bf16 v85, v220, s51, v81 neg_lo:[0,0,1]
  v_dot2_f32_bf16 v86, v221, s50, v81 neg_lo:[0,0,1]
  v_dot2_f32_bf16 v87, v221, s51, v81 neg_lo:[0,0,1]
  v_dot2_f32_bf16 v88, v222, s50, v81 neg_lo:[0,0,1]
  v_dot2_f32_bf16 v89, v222, s51, v81 neg_lo:[0,0,1]
  v_dot2_f32_bf16 v90, v223, s50, v81 neg_lo:[0,0,1]
  v_dot2_f32_bf16 v91, v223, s51, v81 neg_lo:[0,0,1]
  v_cvt_pk_bf16_f32 v220, v84, v85
  v_cvt_pk_bf16_f32 v221, v86, v87
  v_cvt_pk_bf16_f32 v222, v88, v89
  v_cvt_pk_bf16_f32 v223, v90, v91
  ds_write_b128 v70, v[220:223] offset:0
  s_add_u32 m0, s33, 24576
  s_add_u32 s49, s32, 1769472
  buffer_load_dwordx4 v1, s[8:11], s49 offen lds
  v_dot2_f32_bf16 v84, v224, s50, v81 neg_lo:[0,0,1]
  v_dot2_f32_bf16 v85, v224, s51, v81 neg_lo:[0,0,1]
  v_dot2_f32_bf16 v86, v225, s50, v81 neg_lo:[0,0,1]
  v_dot2_f32_bf16 v87, v225, s51, v81 neg_lo:[0,0,1]
  v_dot2_f32_bf16 v88, v226, s50, v81 neg_lo:[0,0,1]
  v_dot2_f32_bf16 v89, v226, s51, v81 neg_lo:[0,0,1]
  v_dot2_f32_bf16 v90, v227, s50, v81 neg_lo:[0,0,1]
  v_dot2_f32_bf16 v91, v227, s51, v81 neg_lo:[0,0,1]
  v_cvt_pk_bf16_f32 v224, v84, v85
  v_cvt_pk_bf16_f32 v225, v86, v87
  v_cvt_pk_bf16_f32 v226, v88, v89
  v_cvt_pk_bf16_f32 v227, v90, v91
  ds_write_b128 v70, v[224:227] offset:2048
  s_add_u32 m0, s33, 32768
  s_add_u32 s49, s32, 2359296
  buffer_load_dwordx4 v1, s[8:11], s49 offen lds
  s_mov_b32 exec_lo, 0x4104104
  s_mov_b32 exec_hi, 0x41041
  buffer_load_dword v19, v104, s[8:11], s57 offen
  s_mov_b64 exec, -1
  v_dot2_f32_bf16 v84, v228, s50, v81 neg_lo:[0,0,1]
  v_dot2_f32_bf16 v85, v228, s51, v81 neg_lo:[0,0,1]
  v_dot2_f32_bf16 v86, v229, s50, v81 neg_lo:[0,0,1]
  v_dot2_f32_bf16 v87, v229, s51, v81 neg_lo:[0,0,1]
  v_dot2_f32_bf16 v88, v230, s50, v81 neg_lo:[0,0,1]
  v_dot2_f32_bf16 v89, v230, s51, v81 neg_lo:[0,0,1]
  v_dot2_f32_bf16 v90, v231, s50, v81 neg_lo:[0,0,1]
  v_dot2_f32_bf16 v91, v231, s51, v81 neg_lo:[0,0,1]
  v_cvt_pk_bf16_f32 v228, v84, v85
  v_cvt_pk_bf16_f32 v229, v86, v87
  v_cvt_pk_bf16_f32 v230, v88, v89
  v_cvt_pk_bf16_f32 v231, v90, v91
  ds_write_b128 v70, v[228:231] offset:4096
  s_add_u32 m0, s33, 40960
  s_add_u32 s49, s32, 2949120
  buffer_load_dwordx4 v1, s[8:11], s49 offen lds
  v_dot2_f32_bf16 v84, v232, s50, v81 neg_lo:[0,0,1]
  v_dot2_f32_bf16 v85, v232, s51, v81 neg_lo:[0,0,1]
  v_dot2_f32_bf16 v86, v233, s50, v81 neg_lo:[0,0,1]
  v_dot2_f32_bf16 v87, v233, s51, v81 neg_lo:[0,0,1]
  v_dot2_f32_bf16 v88, v234, s50, v81 neg_lo:[0,0,1]
  v_dot2_f32_bf16 v89, v234, s51, v81 neg_lo:[0,0,1]
  v_dot2_f32_bf16 v90, v235, s50, v81 neg_lo:[0,0,1]
  v_dot2_f32_bf16 v91, v235, s51, v81 neg_lo:[0,0,1]
  v_cvt_pk_bf16_f32 v232, v84, v85
  v_cvt_pk_bf16_f32 v233, v86, v87
  v_cvt_pk_bf16_f32 v234, v88, v89
  v_cvt_pk_bf16_f32 v235, v90, v91
  ds_write_b128 v70, v[232:235] offset:6144
  s_add_u32 m0, s33, 49152
  s_add_u32 s49, s32, 3538944
  buffer_load_dwordx4 v1, s[8:11], s49 offen lds
  v_dot2_f32_bf16 v84, v236, s50, v81 neg_lo:[0,0,1]
  v_dot2_f32_bf16 v85, v236, s51, v81 neg_lo:[0,0,1]
  v_dot2_f32_bf16 v86, v237, s50, v81 neg_lo:[0,0,1]
  v_dot2_f32_bf16 v87, v237, s51, v81 neg_lo:[0,0,1]
  v_dot2_f32_bf16 v88, v238, s50, v81 neg_lo:[0,0,1]
  v_dot2_f32_bf16 v89, v238, s51, v81 neg_lo:[0,0,1]
  v_dot2_f32_bf16 v90, v239, s50, v81 neg_lo:[0,0,1]
  v_dot2_f32_bf16 v91, v239, s51, v81 neg_lo:[0,0,1]
  v_cvt_pk_bf16_f32 v236, v84, v85
  v_cvt_pk_bf16_f32 v237, v86, v87
  v_cvt_pk_bf16_f32 v238, v88, v89
  v_cvt_pk_bf16_f32 v239, v90, v91
  ds_write_b128 v70, v[236:239] offset:8192
  s_add_u32 m0, s33, 57344
  s_add_u32 s49, s32, 4128768
  buffer_load_dwordx4 v1, s[8:11], s49 offen lds
  v_dot2_f32_bf16 v84, v240, s50, v81 neg_lo:[0,0,1]
  v_dot2_f32_bf16 v85, v240, s51, v81 neg_lo:[0,0,1]
  v_dot2_f32_bf16 v86, v241, s50, v81 neg_lo:[0,0,1]
  v_dot2_f32_bf16 v87, v241, s51, v81 neg_lo:[0,0,1]
  v_dot2_f32_bf16 v88, v242, s50, v81 neg_lo:[0,0,1]
  v_dot2_f32_bf16 v89, v242, s51, v81 neg_lo:[0,0,1]
  v_dot2_f32_bf16 v90, v243, s50, v81 neg_lo:[0,0,1]
  v_dot2_f32_bf16 v91, v243, s51, v81 neg_lo:[0,0,1]
  v_cvt_pk_bf16_f32 v240, v84, v85
  v_cvt_pk_bf16_f32 v241, v86, v87
  v_cvt_pk_bf16_f32 v242, v88, v89
  v_cvt_pk_bf16_f32 v243, v90, v91
  ds_write_b128 v70, v[240:243] offset:10240
  s_add_u32 m0, s33, 65536
  s_add_u32 s49, s32, 4718592
  buffer_load_dwordx4 v1, s[8:11], s49 offen lds
  s_mov_b32 exec_lo, 0x8208208
  s_mov_b32 exec_hi, 0x82082
  buffer_load_dword v19, v104, s[8:11], s57 offen
  s_mov_b64 exec, -1
  v_dot2_f32_bf16 v84, v244, s50, v81 neg_lo:[0,0,1]
  v_dot2_f32_bf16 v85, v244, s51, v81 neg_lo:[0,0,1]
  v_dot2_f32_bf16 v86, v245, s50, v81 neg_lo:[0,0,1]
  v_dot2_f32_bf16 v87, v245, s51, v81 neg_lo:[0,0,1]
  v_dot2_f32_bf16 v88, v246, s50, v81 neg_lo:[0,0,1]
  v_dot2_f32_bf16 v89, v246, s51, v81 neg_lo:[0,0,1]
  v_dot2_f32_bf16 v90, v247, s50, v81 neg_lo:[0,0,1]
  v_dot2_f32_bf16 v91, v247, s51, v81 neg_lo:[0,0,1]
  v_cvt_pk_bf16_f32 v244, v84, v85
  v_cvt_pk_bf16_f32 v245, v86, v87
  v_cvt_pk_bf16_f32 v246, v88, v89
  v_cvt_pk_bf16_f32 v247, v90, v91
  ds_write_b128 v70, v[244:247] offset:12288
  v_dot2_f32_bf16 v84, v248, s50, v81 neg_lo:[0,0,1]
  v_dot2_f32_bf16 v85, v248, s51, v81 neg_lo:[0,0,1]
  v_dot2_f32_bf16 v86, v249, s50, v81 neg_lo:[0,0,1]
  v_dot2_f32_bf16 v87, v249, s51, v81 neg_lo:[0,0,1]
  v_dot2_f32_bf16 v88, v250, s50, v81 neg_lo:[0,0,1]
  v_dot2_f32_bf16 v89, v250, s51, v81 neg_lo:[0,0,1]
  v_dot2_f32_bf16 v90, v251, s50, v81 neg_lo:[0,0,1]
  v_dot2_f32_bf16 v91, v251, s51, v81 neg_lo:[0,0,1]
  v_cvt_pk_bf16_f32 v248, v84, v85
  v_cvt_pk_bf16_f32 v249, v86, v87
  v_cvt_pk_bf16_f32 v250, v88, v89
  v_cvt_pk_bf16_f32 v251, v90, v91
  ds_write_b128 v70, v[248:251] offset:14336
  v_dot2_f32_bf16 v84, v252, s50, v81 neg_lo:[0,0,1]
  v_dot2_f32_bf16 v85, v252, s51, v81 neg_lo:[0,0,1]
  v_dot2_f32_bf16 v86, v253, s50, v81 neg_lo:[0,0,1]
  v_dot2_f32_bf16 v87, v253, s51, v81 neg_lo:[0,0,1]
  v_dot2_f32_bf16 v88, v254, s50, v81 neg_lo:[0,0,1]
  v_dot2_f32_bf16 v89, v254, s51, v81 neg_lo:[0,0,1]
  v_dot2_f32_bf16 v90, v255, s50, v81 neg_lo:[0,0,1]
  v_dot2_f32_bf16 v91, v255, s51, v81 neg_lo:[0,0,1]
  v_cvt_pk_bf16_f32 v252, v84, v85
  v_cvt_pk_bf16_f32 v253, v86, v87
  v_cvt_pk_bf16_f32 v254, v88, v89
  v_cvt_pk_bf16_f32 v255, v90, v91
  ds_write_b128 v70, v[252:255] offset:16384
  s_waitcnt lgkmcnt(0)
  s_barrier
  ds_read_b128 v[184:187], v71 offset:0
  ds_read_b128 v[188:191], v72 offset:1024
  ds_read_b128 v[192:195], v71 offset:2048
  ds_read_b128 v[196:199], v72 offset:3072
  ds_read_b128 v[200:203], v71 offset:4096
  ds_read_b128 v[204:207], v72 offset:5120
  ds_read_b128 v[208:211], v71 offset:6144
  ds_read_b128 v[212:215], v72 offset:7168
  ds_read_b128 v[216:219], v71 offset:8192
  ds_read_b128 v[220:223], v72 offset:9216
  ds_read_b128 v[224:227], v71 offset:10240
  ds_read_b128 v[228:231], v72 offset:11264
  ds_read_b128 v[232:235], v71 offset:12288
  ds_read_b128 v[236:239], v72 offset:13312
  ds_read_b128 v[240:243], v71 offset:14336
  ds_read_b128 v[244:247], v72 offset:15360
  ds_read_b128 v[248:251], v71 offset:16384
  ds_read_b128 v[252:255], v72 offset:17408
  ds_read_b32 v46, v98 offset:4
  ds_read_b32 v11, v98
  ds_read_b32 v12, v98 offset:32
  s_waitcnt lgkmcnt(0)
  s_waitcnt vmcnt(4)
  s_barrier
  ds_read_b64_tr_b16 v[24:25], v3 offset:0
  ds_read_b64_tr_b16 v[26:27], v3 offset:2048
  ds_read_b64_tr_b16 v[28:29], v4 offset:0
  ds_read_b64_tr_b16 v[30:31], v4 offset:2048
  ds_read_b64_tr_b16 v[32:33], v3 offset:4096
  ds_read_b64_tr_b16 v[34:35], v3 offset:6144
  ds_read_b64_tr_b16 v[36:37], v4 offset:4096
  ds_read_b64_tr_b16 v[38:39], v4 offset:6144
  s_waitcnt lgkmcnt(4)
  ds_read_b64_tr_b16 v[40:41], v3 offset:8192
  v_mfma_f32_16x16x32_bf16 v[80:83], v[24:27], v[112:115], 0
  s_add_u32 m0, s33, 73728
  s_add_u32 s49, s32, 128
  buffer_load_dwordx4 v1, s[8:11], s49 offen lds
  ds_read_b64_tr_b16 v[42:43], v3 offset:10240
  v_mfma_f32_16x16x32_bf16 v[88:91], v[24:27], v[184:187], 0
  v_rcp_f32 v9, v11
  ds_read_b64_tr_b16 v[24:25], v4 offset:8192
  v_mfma_f32_16x16x32_bf16 v[84:87], v[28:31], v[112:115], 0
  s_add_u32 m0, s33, 81920
  s_add_u32 s49, s32, 589952
  buffer_load_dwordx4 v1, s[8:11], s49 offen lds
  ds_read_b64_tr_b16 v[26:27], v4 offset:10240
  v_mfma_f32_16x16x32_bf16 v[92:95], v[28:31], v[184:187], 0
  v_rcp_f32 v10, v12
  s_waitcnt lgkmcnt(4)
  ds_read_b64_tr_b16 v[28:29], v3 offset:12288
  v_mfma_f32_16x16x32_bf16 v[80:83], v[32:35], v[116:119], v[80:83]
  v_mul_f32 v9, 0xbfb8aa3b, v9
  v_mul_f32 v10, 0xbfb8aa3b, v10
  ds_read_b64_tr_b16 v[30:31], v3 offset:14336
  v_mfma_f32_16x16x32_bf16 v[88:91], v[32:35], v[188:191], v[88:91]
  v_mov_b32 v73, v105
  ds_read_b64_tr_b16 v[32:33], v4 offset:12288
  v_mfma_f32_16x16x32_bf16 v[84:87], v[36:39], v[116:119], v[84:87]
  s_add_u32 m0, s33, 90112
  s_add_u32 s49, s32, 1179776
  buffer_load_dwordx4 v1, s[8:11], s49 offen lds
  ds_read_b64_tr_b16 v[34:35], v4 offset:14336
  v_mfma_f32_16x16x32_bf16 v[92:95], v[36:39], v[188:191], v[92:95]
  s_mov_b32 s16, s88
  s_mov_b32 s17, s89
  s_mov_b32 s18, 46137344
  s_mov_b32 s19, 0x20000
  s_waitcnt lgkmcnt(4)
  ds_read_b64_tr_b16 v[36:37], v3 offset:16384
  v_mfma_f32_16x16x32_bf16 v[80:83], v[40:43], v[120:123], v[80:83]
  s_mov_b32 s12, s82
  s_mov_b32 s13, s83
  s_mov_b32 s14, 5308416
  s_mov_b32 s15, 0x20000
  ds_read_b64_tr_b16 v[38:39], v3 offset:18432
  v_mfma_f32_16x16x32_bf16 v[88:91], v[40:43], v[192:195], v[88:91]
  s_add_u32 s46, s29, 0
  s_cmp_ge_u32 s46, 3
  s_cselect_b32 s47, 3, 0
  s_sub_u32 s46, s46, s47
  ds_read_b64_tr_b16 v[40:41], v4 offset:16384
  v_mfma_f32_16x16x32_bf16 v[84:87], v[24:27], v[120:123], v[84:87]
  s_add_u32 m0, s33, 98304
  s_add_u32 s49, s32, 1769600
  buffer_load_dwordx4 v1, s[8:11], s49 offen lds
  ds_read_b64_tr_b16 v[42:43], v4 offset:18432
  v_mfma_f32_16x16x32_bf16 v[92:95], v[24:27], v[192:195], v[92:95]
  s_mul_i32 s47, s28, 3
  s_add_u32 s47, s47, s46
  s_mul_i32 s48, s47, 442368
  s_mul_i32 s56, s24, 9216
  s_waitcnt lgkmcnt(4)
  ds_read_b64_tr_b16 v[24:25], v3 offset:20480
  v_mfma_f32_16x16x32_bf16 v[80:83], v[28:31], v[124:127], v[80:83]
  s_add_u32 s48, s48, s56
  s_mul_i32 s56, s29, 384
  s_add_u32 s36, s48, s56
  s_mul_i32 s48, s27, 12
  ds_read_b64_tr_b16 v[26:27], v3 offset:22528
  v_mfma_f32_16x16x32_bf16 v[88:91], v[28:31], v[196:199], v[88:91]
  s_add_u32 s48, s48, s47
  s_lshl_b32 s48, s48, 3
  s_add_u32 s48, s48, s24
  s_mul_i32 s39, s48, 12288
  ds_read_b64_tr_b16 v[28:29], v4 offset:20480
  v_mfma_f32_16x16x32_bf16 v[84:87], v[32:35], v[124:127], v[84:87]
  s_add_u32 m0, s33, 106496
  s_add_u32 s49, s32, 2359424
  buffer_load_dwordx4 v1, s[8:11], s49 offen lds
  ds_read_b64_tr_b16 v[30:31], v4 offset:22528
  v_mfma_f32_16x16x32_bf16 v[92:95], v[32:35], v[196:199], v[92:95]
  s_add_u32 s39, s39, 1048576
  s_lshl_b32 s48, s48, 6
  s_add_u32 s48, s48, 65536
  s_mov_b32 s55, s48
  s_waitcnt lgkmcnt(4)
  ds_read_b64_tr_b16 v[32:33], v3 offset:24576
  v_mfma_f32_16x16x32_bf16 v[80:83], v[36:39], v[128:131], v[80:83]
  s_add_u32 s46, s29, 1
  s_cmp_ge_u32 s46, 3
  s_cselect_b32 s47, 3, 0
  s_sub_u32 s46, s46, s47
  ds_read_b64_tr_b16 v[34:35], v3 offset:26624
  v_mfma_f32_16x16x32_bf16 v[88:91], v[36:39], v[200:203], v[88:91]
  s_mul_i32 s47, s28, 3
  s_add_u32 s47, s47, s46
  s_mul_i32 s48, s47, 442368
  s_mul_i32 s56, s24, 9216
  ds_read_b64_tr_b16 v[36:37], v4 offset:24576
  v_mfma_f32_16x16x32_bf16 v[84:87], v[40:43], v[128:131], v[84:87]
  s_add_u32 m0, s33, 114688
  s_add_u32 s49, s32, 2949248
  buffer_load_dwordx4 v1, s[8:11], s49 offen lds
  ds_read_b64_tr_b16 v[38:39], v4 offset:26624
  v_mfma_f32_16x16x32_bf16 v[92:95], v[40:43], v[200:203], v[92:95]
  s_add_u32 s48, s48, s56
  s_mul_i32 s56, s29, 384
  s_add_u32 s37, s48, s56
  s_mul_i32 s48, s27, 12
  s_waitcnt lgkmcnt(4)
  ds_read_b64_tr_b16 v[40:41], v3 offset:28672
  v_mfma_f32_16x16x32_bf16 v[80:83], v[24:27], v[132:135], v[80:83]
  s_add_u32 s48, s48, s47
  s_lshl_b32 s48, s48, 3
  s_add_u32 s48, s48, s24
  s_mul_i32 s40, s48, 12288
  ds_read_b64_tr_b16 v[42:43], v3 offset:30720
  v_mfma_f32_16x16x32_bf16 v[88:91], v[24:27], v[204:207], v[88:91]
  s_add_u32 s40, s40, 1048576
  s_lshl_b32 s48, s48, 6
  s_add_u32 s48, s48, 65536
  v_mov_b32 v17, s48
  ds_read_b64_tr_b16 v[24:25], v4 offset:28672
  v_mfma_f32_16x16x32_bf16 v[84:87], v[28:31], v[132:135], v[84:87]
  s_mov_b32 exec_lo, 0x30c30c30
  s_mov_b32 exec_hi, 0x30c30c
  buffer_load_dword v19, v104, s[8:11], s57 offen
  s_mov_b64 exec, -1
  ds_read_b64_tr_b16 v[26:27], v4 offset:30720
  v_mfma_f32_16x16x32_bf16 v[92:95], v[28:31], v[204:207], v[92:95]
  s_add_u32 s46, s29, 2
  s_cmp_ge_u32 s46, 3
  s_cselect_b32 s47, 3, 0
  s_sub_u32 s46, s46, s47
  s_waitcnt vmcnt(8)
  s_barrier
  s_waitcnt lgkmcnt(4)
  ds_read_b64_tr_b16 v[28:29], v3 offset:32768
  v_mfma_f32_16x16x32_bf16 v[80:83], v[32:35], v[136:139], v[80:83]
  s_mul_i32 s47, s28, 3
  s_add_u32 s47, s47, s46
  s_mul_i32 s48, s47, 442368
  s_mul_i32 s56, s24, 9216
  ds_read_b64_tr_b16 v[30:31], v3 offset:34816
  v_mfma_f32_16x16x32_bf16 v[88:91], v[32:35], v[208:211], v[88:91]
  s_add_u32 s48, s48, s56
  s_mul_i32 s56, s29, 384
  s_add_u32 s38, s48, s56
  s_mul_i32 s48, s27, 12
  ds_read_b64_tr_b16 v[32:33], v4 offset:32768
  v_mfma_f32_16x16x32_bf16 v[84:87], v[36:39], v[136:139], v[84:87]
  s_add_u32 m0, s33, 122880
  s_add_u32 s49, s32, 3539072
  buffer_load_dwordx4 v1, s[8:11], s49 offen lds
  ds_read_b64_tr_b16 v[34:35], v4 offset:34816
  v_mfma_f32_16x16x32_bf16 v[92:95], v[36:39], v[208:211], v[92:95]
  s_add_u32 s48, s48, s47
  s_lshl_b32 s48, s48, 3
  s_add_u32 s48, s48, s24
  s_mul_i32 s41, s48, 12288
  s_waitcnt lgkmcnt(4)
  ds_read_b64_tr_b16 v[36:37], v3 offset:36864
  v_mfma_f32_16x16x32_bf16 v[80:83], v[40:43], v[140:143], v[80:83]
  s_add_u32 s41, s41, 1048576
  s_lshl_b32 s48, s48, 6
  s_add_u32 s48, s48, 65536
  v_writelane_b32 v17, s48, 1
  ds_read_b64_tr_b16 v[38:39], v3 offset:38912
  v_mfma_f32_16x16x32_bf16 v[88:91], v[40:43], v[212:215], v[88:91]
  s_mul_i32 s54, s27, 3
  s_add_u32 s54, s54, s29
  s_lshl_b32 s59, s54, 11
  s_lshl_b32 s46, s24, 6
  ds_read_b64_tr_b16 v[40:41], v4 offset:36864
  v_mfma_f32_16x16x32_bf16 v[84:87], v[24:27], v[140:143], v[84:87]
  s_add_u32 s59, s59, s46
  s_add_u32 s59, s59, 163840
  s_lshl_b32 s54, s54, 16
  s_lshl_b32 s46, s24, 11
  ds_read_b64_tr_b16 v[42:43], v4 offset:38912
  v_mfma_f32_16x16x32_bf16 v[92:95], v[24:27], v[212:215], v[92:95]
  s_add_u32 s54, s54, s46
  s_add_u32 s54, s54, 20971520
  s_add_u32 s78, s39, 0
  s_xor_b32 s46, s28, 1
  s_waitcnt lgkmcnt(4)
  ds_read_b64_tr_b16 v[24:25], v3 offset:40960
  v_mfma_f32_16x16x32_bf16 v[80:83], v[28:31], v[144:147], v[80:83]
  s_sub_u32 s46, s46, s28
  s_mul_i32 s46, s46, 294912
  s_add_u32 s75, s78, s46
  s_add_u32 s79, s39, 2048
  ds_read_b64_tr_b16 v[26:27], v3 offset:43008
  v_mfma_f32_16x16x32_bf16 v[88:91], v[28:31], v[216:219], v[88:91]
  s_xor_b32 s46, s28, 2
  s_sub_u32 s46, s46, s28
  s_mul_i32 s46, s46, 294912
  s_add_u32 s62, s79, s46
  ds_read_b64_tr_b16 v[28:29], v4 offset:40960
  v_mfma_f32_16x16x32_bf16 v[84:87], v[32:35], v[144:147], v[84:87]
  s_add_u32 m0, s33, 131072
  s_add_u32 s49, s32, 4128896
  buffer_load_dwordx4 v1, s[8:11], s49 offen lds
  ds_read_b64_tr_b16 v[30:31], v4 offset:43008
  v_mfma_f32_16x16x32_bf16 v[92:95], v[32:35], v[216:219], v[92:95]
  s_add_u32 s74, s39, 4096
  s_xor_b32 s46, s28, 3
  s_sub_u32 s46, s46, s28
  s_mul_i32 s46, s46, 294912
  s_waitcnt lgkmcnt(4)
  ds_read_b64_tr_b16 v[32:33], v3 offset:45056
  v_mfma_f32_16x16x32_bf16 v[80:83], v[36:39], v[148:151], v[80:83]
  s_add_u32 s63, s74, s46
  s_mul_i32 s86, s29, 384
  s_and_b32 s46, s28, 2
  s_lshl_b32 s46, s46, 5
  ds_read_b64_tr_b16 v[34:35], v3 offset:47104
  v_mfma_f32_16x16x32_bf16 v[88:91], v[36:39], v[220:223], v[88:91]
  s_add_u32 s86, s86, s46
  s_lshl_b32 s46, s26, 5
  s_add_u32 s86, s86, s46
  s_lshl_b32 s87, s27, 5
  ds_read_b64_tr_b16 v[36:37], v4 offset:45056
  v_mfma_f32_16x16x32_bf16 v[84:87], v[40:43], v[148:151], v[84:87]
  s_lshl_b32 s47, s25, 3
  s_add_u32 s87, s87, s47
  s_and_b32 s47, s28, 1
  s_add_u32 s87, s87, s47
  ds_read_b64_tr_b16 v[38:39], v4 offset:47104
  v_mfma_f32_16x16x32_bf16 v[92:95], v[40:43], v[220:223], v[92:95]
  s_mul_i32 s87, s87, 4608
  s_add_u32 s87, s87, s86
  s_lshl_b32 s87, s87, 1
  s_mul_i32 s3, s25, 3072
  s_waitcnt lgkmcnt(4)
  ds_read_b64_tr_b16 v[40:41], v5 offset:0
  v_mfma_f32_16x16x32_bf16 v[80:83], v[24:27], v[152:155], v[80:83]
  s_add_u32 s3, s3, s46
  s_add_u32 s3, s3, 147456
  s_mov_b32 s20, s76
  s_mov_b32 s21, s77
  ds_read_b64_tr_b16 v[42:43], v5 offset:2048
  v_mfma_f32_16x16x32_bf16 v[88:91], v[24:27], v[224:227], v[88:91]
  s_mov_b32 s22, 1152
  s_mov_b32 s23, 0x20000
  s_mov_b32 s4, s84
  s_mov_b32 s5, s85
  ds_read_b64_tr_b16 v[24:25], v6 offset:0
  v_mfma_f32_16x16x32_bf16 v[84:87], v[28:31], v[152:155], v[84:87]
  s_add_u32 m0, s33, 139264
  s_add_u32 s49, s32, 4718720
  buffer_load_dwordx4 v1, s[8:11], s49 offen lds
  ds_read_b64_tr_b16 v[26:27], v6 offset:2048
  v_mfma_f32_16x16x32_bf16 v[92:95], v[28:31], v[224:227], v[92:95]
  s_mov_b32 s6, 4718592
  s_mov_b32 s7, 0x20000
  s_lshl_b32 s46, s28, 14
  s_add_u32 s46, s46, s54
  s_waitcnt lgkmcnt(4)
  ds_read_b64_tr_b16 v[28:29], v5 offset:4096
  v_mfma_f32_16x16x32_bf16 v[80:83], v[32:35], v[156:159], v[80:83]
  s_add_u32 s84, s46, 12582912
  s_add_u32 s85, s46, 15728640
  s_add_u32 s88, s46, 18874368
  s_add_u32 s89, s46, 22020096
  ds_read_b64_tr_b16 v[30:31], v5 offset:6144
  v_mfma_f32_16x16x32_bf16 v[88:91], v[32:35], v[228:231], v[88:91]
  s_lshl_b32 s52, s28, 9
  s_add_u32 s52, s52, s59
  s_mov_b32 s53, 0
  v_lshrrev_b32 v47, 1, v0
  ds_read_b64_tr_b16 v[32:33], v6 offset:4096
  v_mfma_f32_16x16x32_bf16 v[84:87], v[36:39], v[156:159], v[84:87]
  s_mov_b32 exec_lo, 0x3ffff
  s_mov_b32 exec_hi, 0x0
  buffer_load_dword v45, v73, s[12:15], s58 offen
  s_mov_b64 exec, -1
  ds_read_b64_tr_b16 v[34:35], v6 offset:6144
  v_mfma_f32_16x16x32_bf16 v[92:95], v[36:39], v[228:231], v[92:95]
  s_mul_i32 s30, s30, 0x9E3779B1
  s_add_u32 s30, s30, 0x7F4A7C15
  s_mul_i32 s31, s30, 0x85EBCA6B
  s_xor_b32 s31, s31, 0x5bd1e995
  s_waitcnt vmcnt(5)
  s_barrier
  s_waitcnt lgkmcnt(4)
  ds_read_b64_tr_b16 v[36:37], v5 offset:8192
  v_mfma_f32_16x16x32_bf16 v[80:83], v[40:43], v[160:163], v[80:83]
  s_andn2_b32 s31, s31, 15
  ds_read_b64_tr_b16 v[38:39], v5 offset:10240
  v_mfma_f32_16x16x32_bf16 v[88:91], v[40:43], v[232:235], v[88:91]
  s_mov_b32 exec_lo, 0x1ff
  s_mov_b32 exec_hi, 0x0
  buffer_load_dword v45, v73, s[20:23], 0 offen
  s_mov_b64 exec, -1
  ds_read_b64_tr_b16 v[40:41], v6 offset:8192
  v_mfma_f32_16x16x32_bf16 v[84:87], v[24:27], v[160:163], v[84:87]
  s_add_u32 m0, s33, 0
  s_add_u32 s49, s32, 256
  buffer_load_dwordx4 v1, s[8:11], s49 offen lds
  ds_read_b64_tr_b16 v[42:43], v6 offset:10240
  v_mfma_f32_16x16x32_bf16 v[92:95], v[24:27], v[232:235], v[92:95]
  s_mov_b32 exec_lo, 0x1
  s_mov_b32 exec_hi, 0x0
  buffer_load_dword v45, v0, s[16:19], s52 offen sc1
  s_mov_b64 exec, -1
  s_waitcnt lgkmcnt(4)
  ds_read_b64_tr_b16 v[24:25], v5 offset:12288
  v_mfma_f32_16x16x32_bf16 v[80:83], v[28:31], v[164:167], v[80:83]
  s_mov_b32 exec_lo, 0x1
  s_mov_b32 exec_hi, 0x0
  buffer_load_dword v45, v0, s[16:19], s55 offen sc1
  s_mov_b64 exec, -1
  ds_read_b64_tr_b16 v[26:27], v5 offset:14336
  v_mfma_f32_16x16x32_bf16 v[88:91], v[28:31], v[236:239], v[88:91]
  ds_read_b64_tr_b16 v[28:29], v6 offset:12288
  v_mfma_f32_16x16x32_bf16 v[84:87], v[32:35], v[164:167], v[84:87]
  ds_read_b64_tr_b16 v[30:31], v6 offset:14336
  v_mfma_f32_16x16x32_bf16 v[92:95], v[32:35], v[236:239], v[92:95]
  s_waitcnt lgkmcnt(4)
  ds_read_b64_tr_b16 v[32:33], v5 offset:16384
  v_mfma_f32_16x16x32_bf16 v[80:83], v[36:39], v[168:171], v[80:83]
  ds_read_b64_tr_b16 v[34:35], v5 offset:18432
  v_mfma_f32_16x16x32_bf16 v[88:91], v[36:39], v[240:243], v[88:91]
  ds_read_b64_tr_b16 v[36:37], v6 offset:16384
  v_mfma_f32_16x16x32_bf16 v[84:87], v[40:43], v[168:171], v[84:87]
  s_add_u32 m0, s33, 8192
  s_add_u32 s49, s32, 590080
  buffer_load_dwordx4 v1, s[8:11], s49 offen lds
  ds_read_b64_tr_b16 v[38:39], v6 offset:18432
  v_mfma_f32_16x16x32_bf16 v[92:95], v[40:43], v[240:243], v[92:95]
  s_waitcnt lgkmcnt(4)
  ds_read_b64_tr_b16 v[40:41], v5 offset:20480
  v_mfma_f32_16x16x32_bf16 v[80:83], v[24:27], v[172:175], v[80:83]
  ds_read_b64_tr_b16 v[42:43], v5 offset:22528
  v_mfma_f32_16x16x32_bf16 v[88:91], v[24:27], v[244:247], v[88:91]
  ds_read_b64_tr_b16 v[24:25], v6 offset:20480
  v_mfma_f32_16x16x32_bf16 v[84:87], v[28:31], v[172:175], v[84:87]
  ds_read_b64_tr_b16 v[26:27], v6 offset:22528
  v_mfma_f32_16x16x32_bf16 v[92:95], v[28:31], v[244:247], v[92:95]
  s_waitcnt lgkmcnt(4)
  ds_read_b64_tr_b16 v[28:29], v5 offset:24576
  v_mfma_f32_16x16x32_bf16 v[80:83], v[32:35], v[176:179], v[80:83]
  ds_read_b64_tr_b16 v[30:31], v5 offset:26624
  v_mfma_f32_16x16x32_bf16 v[88:91], v[32:35], v[248:251], v[88:91]
  ds_read_b64_tr_b16 v[32:33], v6 offset:24576
  v_mfma_f32_16x16x32_bf16 v[84:87], v[36:39], v[176:179], v[84:87]
  s_add_u32 m0, s33, 16384
  s_add_u32 s49, s32, 1179904
  buffer_load_dwordx4 v1, s[8:11], s49 offen lds
  ds_read_b64_tr_b16 v[34:35], v6 offset:26624
  v_mfma_f32_16x16x32_bf16 v[92:95], v[36:39], v[248:251], v[92:95]
  s_waitcnt lgkmcnt(4)
  ds_read_b64_tr_b16 v[36:37], v5 offset:28672
  v_mfma_f32_16x16x32_bf16 v[80:83], v[40:43], v[180:183], v[80:83]
  ds_read_b64_tr_b16 v[38:39], v5 offset:30720
  v_mfma_f32_16x16x32_bf16 v[88:91], v[40:43], v[252:255], v[88:91]
  ds_read_b64_tr_b16 v[40:41], v6 offset:28672
  v_mfma_f32_16x16x32_bf16 v[84:87], v[24:27], v[180:183], v[84:87]
  ds_read_b64_tr_b16 v[42:43], v6 offset:30720
  v_mfma_f32_16x16x32_bf16 v[92:95], v[24:27], v[252:255], v[92:95]
  s_waitcnt lgkmcnt(4)
  ds_read_b64_tr_b16 v[24:25], v5 offset:32768
  v_mfma_f32_16x16x32_bf16 v[96:99], v[28:31], v[112:115], 0
  ds_read_b64_tr_b16 v[26:27], v5 offset:34816
  v_mfma_f32_16x16x32_bf16 v[104:107], v[28:31], v[184:187], 0
  ds_read_b64_tr_b16 v[28:29], v6 offset:32768
  v_mfma_f32_16x16x32_bf16 v[100:103], v[32:35], v[112:115], 0
  s_add_u32 m0, s33, 24576
  s_add_u32 s49, s32, 1769728
  buffer_load_dwordx4 v1, s[8:11], s49 offen lds
  ds_read_b64_tr_b16 v[30:31], v6 offset:34816
  v_mfma_f32_16x16x32_bf16 v[108:111], v[32:35], v[184:187], 0
  s_waitcnt lgkmcnt(4)
  ds_read_b64_tr_b16 v[32:33], v5 offset:36864
  v_mfma_f32_16x16x32_bf16 v[96:99], v[36:39], v[116:119], v[96:99]
  v_mul_f32 v13, v80, v9
  v_mul_f32 v14, v81, v9
  ds_read_b64_tr_b16 v[34:35], v5 offset:38912
  v_mfma_f32_16x16x32_bf16 v[104:107], v[36:39], v[188:191], v[104:107]
  v_exp_f32 v13, v13
  ds_read_b64_tr_b16 v[36:37], v6 offset:36864
  v_mfma_f32_16x16x32_bf16 v[100:103], v[40:43], v[116:119], v[100:103]
  v_mul_f32 v15, v82, v9
  v_mul_f32 v16, v83, v9
  ds_read_b64_tr_b16 v[38:39], v6 offset:38912
  v_mfma_f32_16x16x32_bf16 v[108:111], v[40:43], v[188:191], v[108:111]
  v_exp_f32 v14, v14
  s_waitcnt lgkmcnt(4)
  ds_read_b64_tr_b16 v[40:41], v5 offset:40960
  v_mfma_f32_16x16x32_bf16 v[96:99], v[24:27], v[120:123], v[96:99]
  v_exp_f32 v15, v15
  ds_read_b64_tr_b16 v[42:43], v5 offset:43008
  v_mfma_f32_16x16x32_bf16 v[104:107], v[24:27], v[192:195], v[104:107]
  v_fma_f32 v13, v13, v11, v11
  v_fma_f32 v14, v14, v11, v11
  ds_read_b64_tr_b16 v[24:25], v6 offset:40960
  v_mfma_f32_16x16x32_bf16 v[100:103], v[28:31], v[120:123], v[100:103]
  s_add_u32 m0, s33, 32768
  s_add_u32 s49, s32, 2359552
  buffer_load_dwordx4 v1, s[8:11], s49 offen lds
  ds_read_b64_tr_b16 v[26:27], v6 offset:43008
  v_mfma_f32_16x16x32_bf16 v[108:111], v[28:31], v[192:195], v[108:111]
  v_exp_f32 v16, v16
  s_waitcnt lgkmcnt(4)
  ds_read_b64_tr_b16 v[28:29], v5 offset:45056
  v_mfma_f32_16x16x32_bf16 v[96:99], v[32:35], v[124:127], v[96:99]
  v_rcp_f32 v13, v13
  ds_read_b64_tr_b16 v[30:31], v5 offset:47104
  v_mfma_f32_16x16x32_bf16 v[104:107], v[32:35], v[196:199], v[104:107]
  v_fma_f32 v15, v15, v11, v11
  v_fma_f32 v16, v16, v11, v11
  ds_read_b64_tr_b16 v[32:33], v6 offset:45056
  v_mfma_f32_16x16x32_bf16 v[100:103], v[36:39], v[124:127], v[100:103]
  v_rcp_f32 v14, v14
  ds_read_b64_tr_b16 v[34:35], v6 offset:47104
  v_mfma_f32_16x16x32_bf16 v[108:111], v[36:39], v[196:199], v[108:111]
  v_rcp_f32 v15, v15
  s_waitcnt lgkmcnt(4)
  ds_read_b64_tr_b16 v[36:37], v7 offset:0
  v_mfma_f32_16x16x32_bf16 v[96:99], v[40:43], v[128:131], v[96:99]
  v_mul_f32 v80, v80, v13
  v_mul_f32 v81, v81, v14
  ds_read_b64_tr_b16 v[38:39], v7 offset:2048
  v_mfma_f32_16x16x32_bf16 v[104:107], v[40:43], v[200:203], v[104:107]
  v_rcp_f32 v16, v16
  ds_read_b64_tr_b16 v[40:41], v8 offset:0
  v_mfma_f32_16x16x32_bf16 v[100:103], v[24:27], v[128:131], v[100:103]
  s_add_u32 m0, s33, 40960
  s_add_u32 s49, s32, 2949376
  buffer_load_dwordx4 v1, s[8:11], s49 offen lds
  ds_read_b64_tr_b16 v[42:43], v8 offset:2048
  v_mfma_f32_16x16x32_bf16 v[108:111], v[24:27], v[200:203], v[108:111]
  v_cvt_pk_bf16_f32 v48, v80, v81
  v_mul_f32 v82, v82, v15
  s_waitcnt lgkmcnt(4)
  ds_read_b64_tr_b16 v[24:25], v7 offset:4096
  v_mfma_f32_16x16x32_bf16 v[96:99], v[28:31], v[132:135], v[96:99]
  v_mul_f32 v83, v83, v16
  v_cvt_pk_bf16_f32 v49, v82, v83
  ds_read_b64_tr_b16 v[26:27], v7 offset:6144
  v_mfma_f32_16x16x32_bf16 v[104:107], v[28:31], v[204:207], v[104:107]
  v_mul_f32 v13, v84, v9
  v_mul_f32 v14, v85, v9
  ds_read_b64_tr_b16 v[28:29], v8 offset:4096
  v_mfma_f32_16x16x32_bf16 v[100:103], v[32:35], v[132:135], v[100:103]
  s_mov_b32 exec_lo, 0xfffc0000
  s_mov_b32 exec_hi, 0xf
  buffer_load_dword v45, v73, s[12:15], s58 offen
  s_mov_b64 exec, -1
  ds_read_b64_tr_b16 v[30:31], v8 offset:6144
  v_mfma_f32_16x16x32_bf16 v[108:111], v[32:35], v[204:207], v[108:111]
  v_exp_f32 v13, v13
  s_waitcnt vmcnt(4)
  s_barrier
  s_waitcnt lgkmcnt(4)
  ds_read_b64_tr_b16 v[32:33], v7 offset:8192
  v_mfma_f32_16x16x32_bf16 v[96:99], v[36:39], v[136:139], v[96:99]
  v_mul_f32 v15, v86, v9
  v_mul_f32 v16, v87, v9
  ds_read_b64_tr_b16 v[34:35], v7 offset:10240
  v_mfma_f32_16x16x32_bf16 v[104:107], v[36:39], v[208:211], v[104:107]
  v_exp_f32 v14, v14
  ds_read_b64_tr_b16 v[36:37], v8 offset:8192
  v_mfma_f32_16x16x32_bf16 v[100:103], v[40:43], v[136:139], v[100:103]
  s_add_u32 m0, s33, 49152
  s_add_u32 s49, s32, 3539200
  buffer_load_dwordx4 v1, s[8:11], s49 offen lds
  ds_read_b64_tr_b16 v[38:39], v8 offset:10240
  v_mfma_f32_16x16x32_bf16 v[108:111], v[40:43], v[208:211], v[108:111]
  v_exp_f32 v15, v15
  s_waitcnt lgkmcnt(4)
  ds_read_b64_tr_b16 v[40:41], v7 offset:12288
  v_mfma_f32_16x16x32_bf16 v[96:99], v[24:27], v[140:143], v[96:99]
  v_fma_f32 v13, v13, v11, v11
  v_fma_f32 v14, v14, v11, v11
  ds_read_b64_tr_b16 v[42:43], v7 offset:14336
  v_mfma_f32_16x16x32_bf16 v[104:107], v[24:27], v[212:215], v[104:107]
  v_exp_f32 v16, v16
  ds_read_b64_tr_b16 v[24:25], v8 offset:12288
  v_mfma_f32_16x16x32_bf16 v[100:103], v[28:31], v[140:143], v[100:103]
  v_rcp_f32 v13, v13
  ds_read_b64_tr_b16 v[26:27], v8 offset:14336
  v_mfma_f32_16x16x32_bf16 v[108:111], v[28:31], v[212:215], v[108:111]
  v_fma_f32 v15, v15, v11, v11
  v_fma_f32 v16, v16, v11, v11
  s_waitcnt lgkmcnt(4)
  ds_read_b64_tr_b16 v[28:29], v7 offset:16384
  v_mfma_f32_16x16x32_bf16 v[96:99], v[32:35], v[144:147], v[96:99]
  v_rcp_f32 v14, v14
  ds_read_b64_tr_b16 v[30:31], v7 offset:18432
  v_mfma_f32_16x16x32_bf16 v[104:107], v[32:35], v[216:219], v[104:107]
  v_rcp_f32 v15, v15
  ds_read_b64_tr_b16 v[32:33], v8 offset:16384
  v_mfma_f32_16x16x32_bf16 v[100:103], v[36:39], v[144:147], v[100:103]
  s_add_u32 m0, s33, 57344
  s_add_u32 s49, s32, 4129024
  buffer_load_dwordx4 v1, s[8:11], s49 offen lds
  ds_read_b64_tr_b16 v[34:35], v8 offset:18432
  v_mfma_f32_16x16x32_bf16 v[108:111], v[36:39], v[216:219], v[108:111]
  v_mul_f32 v84, v84, v13
  v_mul_f32 v85, v85, v14
  s_waitcnt lgkmcnt(4)
  ds_read_b64_tr_b16 v[36:37], v7 offset:20480
  v_mfma_f32_16x16x32_bf16 v[96:99], v[40:43], v[148:151], v[96:99]
  v_rcp_f32 v16, v16
  ds_read_b64_tr_b16 v[38:39], v7 offset:22528
  v_mfma_f32_16x16x32_bf16 v[104:107], v[40:43], v[220:223], v[104:107]
  v_cvt_pk_bf16_f32 v50, v84, v85
  v_mul_f32 v86, v86, v15
  ds_read_b64_tr_b16 v[40:41], v8 offset:20480
  v_mfma_f32_16x16x32_bf16 v[100:103], v[24:27], v[148:151], v[100:103]
  v_mul_f32 v87, v87, v16
  v_cvt_pk_bf16_f32 v51, v86, v87
  ds_read_b64_tr_b16 v[42:43], v8 offset:22528
  v_mfma_f32_16x16x32_bf16 v[108:111], v[24:27], v[220:223], v[108:111]
  v_mul_f32 v13, v88, v10
  v_mul_f32 v14, v89, v10
  s_waitcnt lgkmcnt(4)
  ds_read_b64_tr_b16 v[24:25], v7 offset:24576
  v_mfma_f32_16x16x32_bf16 v[96:99], v[28:31], v[152:155], v[96:99]
  v_exp_f32 v13, v13
  ds_read_b64_tr_b16 v[26:27], v7 offset:26624
  v_mfma_f32_16x16x32_bf16 v[104:107], v[28:31], v[224:227], v[104:107]
  v_mul_f32 v15, v90, v10
  v_mul_f32 v16, v91, v10
  ds_read_b64_tr_b16 v[28:29], v8 offset:24576
  v_mfma_f32_16x16x32_bf16 v[100:103], v[32:35], v[152:155], v[100:103]
  s_add_u32 m0, s33, 65536
  s_add_u32 s49, s32, 4718848
  buffer_load_dwordx4 v1, s[8:11], s49 offen lds
  ds_read_b64_tr_b16 v[30:31], v8 offset:26624
  v_mfma_f32_16x16x32_bf16 v[108:111], v[32:35], v[224:227], v[108:111]
  v_exp_f32 v14, v14
  s_waitcnt lgkmcnt(4)
  ds_read_b64_tr_b16 v[32:33], v7 offset:28672
  v_mfma_f32_16x16x32_bf16 v[96:99], v[36:39], v[156:159], v[96:99]
  v_exp_f32 v15, v15
  ds_read_b64_tr_b16 v[34:35], v7 offset:30720
  v_mfma_f32_16x16x32_bf16 v[104:107], v[36:39], v[228:231], v[104:107]
  v_fma_f32 v13, v13, v12, v12
  v_fma_f32 v14, v14, v12, v12
  ds_read_b64_tr_b16 v[36:37], v8 offset:28672
  v_mfma_f32_16x16x32_bf16 v[100:103], v[40:43], v[156:159], v[100:103]
  v_exp_f32 v16, v16
  ds_read_b64_tr_b16 v[38:39], v8 offset:30720
  v_mfma_f32_16x16x32_bf16 v[108:111], v[40:43], v[228:231], v[108:111]
  v_rcp_f32 v13, v13
  s_waitcnt lgkmcnt(4)
  ds_read_b64_tr_b16 v[40:41], v7 offset:32768
  v_mfma_f32_16x16x32_bf16 v[96:99], v[24:27], v[160:163], v[96:99]
  v_fma_f32 v15, v15, v12, v12
  v_fma_f32 v16, v16, v12, v12
  ds_read_b64_tr_b16 v[42:43], v7 offset:34816
  v_mfma_f32_16x16x32_bf16 v[104:107], v[24:27], v[232:235], v[104:107]
  v_rcp_f32 v14, v14
  ds_read_b64_tr_b16 v[24:25], v8 offset:32768
  v_mfma_f32_16x16x32_bf16 v[100:103], v[28:31], v[160:163], v[100:103]
  s_add_u32 m0, s33, 73728
  s_add_u32 s49, s32, 384
  buffer_load_dwordx4 v1, s[8:11], s49 offen lds
  ds_read_b64_tr_b16 v[26:27], v8 offset:34816
  v_mfma_f32_16x16x32_bf16 v[108:111], v[28:31], v[232:235], v[108:111]
  v_rcp_f32 v15, v15
  s_waitcnt lgkmcnt(4)
  ds_read_b64_tr_b16 v[28:29], v7 offset:36864
  v_mfma_f32_16x16x32_bf16 v[96:99], v[32:35], v[164:167], v[96:99]
  v_mul_f32 v88, v88, v13
  v_mul_f32 v89, v89, v14
  ds_read_b64_tr_b16 v[30:31], v7 offset:38912
  v_mfma_f32_16x16x32_bf16 v[104:107], v[32:35], v[236:239], v[104:107]
  v_rcp_f32 v16, v16
  ds_read_b64_tr_b16 v[32:33], v8 offset:36864
  v_mfma_f32_16x16x32_bf16 v[100:103], v[36:39], v[164:167], v[100:103]
  v_cvt_pk_bf16_f32 v52, v88, v89
  v_mul_f32 v90, v90, v15
  ds_read_b64_tr_b16 v[34:35], v8 offset:38912
  v_mfma_f32_16x16x32_bf16 v[108:111], v[36:39], v[236:239], v[108:111]
  v_mul_f32 v91, v91, v16
  v_cvt_pk_bf16_f32 v53, v90, v91
  s_waitcnt lgkmcnt(4)
  ds_read_b64_tr_b16 v[36:37], v7 offset:40960
  v_mfma_f32_16x16x32_bf16 v[96:99], v[40:43], v[168:171], v[96:99]
  v_mul_f32 v13, v92, v10
  v_mul_f32 v14, v93, v10
  ds_read_b64_tr_b16 v[38:39], v7 offset:43008
  v_mfma_f32_16x16x32_bf16 v[104:107], v[40:43], v[240:243], v[104:107]
  v_exp_f32 v13, v13
  ds_read_b64_tr_b16 v[40:41], v8 offset:40960
  v_mfma_f32_16x16x32_bf16 v[100:103], v[24:27], v[168:171], v[100:103]
  s_add_u32 m0, s33, 81920
  s_add_u32 s49, s32, 590208
  buffer_load_dwordx4 v1, s[8:11], s49 offen lds
  ds_read_b64_tr_b16 v[42:43], v8 offset:43008
  v_mfma_f32_16x16x32_bf16 v[108:111], v[24:27], v[240:243], v[108:111]
  v_mul_f32 v15, v94, v10
  v_mul_f32 v16, v95, v10
  s_waitcnt lgkmcnt(4)
  ds_read_b64_tr_b16 v[24:25], v7 offset:45056
  v_mfma_f32_16x16x32_bf16 v[96:99], v[28:31], v[172:175], v[96:99]
  v_exp_f32 v14, v14
  ds_read_b64_tr_b16 v[26:27], v7 offset:47104
  v_mfma_f32_16x16x32_bf16 v[104:107], v[28:31], v[244:247], v[104:107]
  v_exp_f32 v15, v15
  ds_read_b64_tr_b16 v[28:29], v8 offset:45056
  v_mfma_f32_16x16x32_bf16 v[100:103], v[32:35], v[172:175], v[100:103]
  v_fma_f32 v13, v13, v12, v12
  v_fma_f32 v14, v14, v12, v12
  ds_read_b64_tr_b16 v[30:31], v8 offset:47104
  v_mfma_f32_16x16x32_bf16 v[108:111], v[32:35], v[244:247], v[108:111]
  v_exp_f32 v16, v16
  s_waitcnt lgkmcnt(4)
  ds_read_b64_tr_b16 v[32:33], v3 offset:0
  v_mfma_f32_16x16x32_bf16 v[96:99], v[36:39], v[176:179], v[96:99]
  v_rcp_f32 v13, v13
  ds_read_b64_tr_b16 v[34:35], v3 offset:2048
  v_mfma_f32_16x16x32_bf16 v[104:107], v[36:39], v[248:251], v[104:107]
  v_fma_f32 v15, v15, v12, v12
  v_fma_f32 v16, v16, v12, v12
  ds_read_b64_tr_b16 v[36:37], v4 offset:0
  v_mfma_f32_16x16x32_bf16 v[100:103], v[40:43], v[176:179], v[100:103]
  s_add_u32 m0, s33, 90112
  s_add_u32 s49, s32, 1180032
  buffer_load_dwordx4 v1, s[8:11], s49 offen lds
  ds_read_b64_tr_b16 v[38:39], v4 offset:2048
  v_mfma_f32_16x16x32_bf16 v[108:111], v[40:43], v[248:251], v[108:111]
  v_rcp_f32 v14, v14
  s_waitcnt lgkmcnt(4)
  ds_read_b64_tr_b16 v[40:41], v3 offset:4096
  v_mfma_f32_16x16x32_bf16 v[96:99], v[24:27], v[180:183], v[96:99]
  v_rcp_f32 v15, v15
  ds_read_b64_tr_b16 v[42:43], v3 offset:6144
  v_mfma_f32_16x16x32_bf16 v[104:107], v[24:27], v[252:255], v[104:107]
  v_mul_f32 v92, v92, v13
  v_mul_f32 v93, v93, v14
  ds_read_b64_tr_b16 v[24:25], v4 offset:4096
  v_mfma_f32_16x16x32_bf16 v[100:103], v[28:31], v[180:183], v[100:103]
  s_mov_b32 exec_lo, 0x0
  s_mov_b32 exec_hi, 0x3ffff0
  buffer_load_dword v45, v73, s[12:15], s58 offen
  s_mov_b64 exec, -1
  ds_read_b64_tr_b16 v[26:27], v4 offset:6144
  v_mfma_f32_16x16x32_bf16 v[108:111], v[28:31], v[252:255], v[108:111]
  v_rcp_f32 v16, v16
  s_waitcnt vmcnt(4)
  s_barrier
  v_cvt_pk_bf16_f32 v54, v92, v93
  v_mul_f32 v94, v94, v15
  v_mul_f32 v95, v95, v16
  v_cvt_pk_bf16_f32 v55, v94, v95
  s_waitcnt lgkmcnt(4)
  ds_read_b64_tr_b16 v[28:29], v3 offset:8192
  v_mfma_f32_16x16x32_bf16 v[80:83], v[32:35], v[112:115], 0
  ds_read_b64_tr_b16 v[30:31], v3 offset:10240
  v_mfma_f32_16x16x32_bf16 v[88:91], v[32:35], v[184:187], 0
  ds_read_b64_tr_b16 v[32:33], v4 offset:8192
  v_mfma_f32_16x16x32_bf16 v[84:87], v[36:39], v[112:115], 0
  s_add_u32 m0, s33, 98304
  s_add_u32 s49, s32, 1769856
  buffer_load_dwordx4 v1, s[8:11], s49 offen lds
  ds_read_b64_tr_b16 v[34:35], v4 offset:10240
  v_mfma_f32_16x16x32_bf16 v[92:95], v[36:39], v[184:187], 0
  s_waitcnt lgkmcnt(4)
  ds_read_b64_tr_b16 v[36:37], v3 offset:12288
  v_mfma_f32_16x16x32_bf16 v[80:83], v[40:43], v[116:119], v[80:83]
  v_mul_f32 v13, v96, v9
  v_mul_f32 v14, v97, v9
  ds_read_b64_tr_b16 v[38:39], v3 offset:14336
  v_mfma_f32_16x16x32_bf16 v[88:91], v[40:43], v[188:191], v[88:91]
  v_exp_f32 v13, v13
  ds_read_b64_tr_b16 v[40:41], v4 offset:12288
  v_mfma_f32_16x16x32_bf16 v[84:87], v[24:27], v[116:119], v[84:87]
  v_mul_f32 v15, v98, v9
  v_mul_f32 v16, v99, v9
  ds_read_b64_tr_b16 v[42:43], v4 offset:14336
  v_mfma_f32_16x16x32_bf16 v[92:95], v[24:27], v[188:191], v[92:95]
  v_exp_f32 v14, v14
  s_waitcnt lgkmcnt(4)
  ds_read_b64_tr_b16 v[24:25], v3 offset:16384
  v_mfma_f32_16x16x32_bf16 v[80:83], v[28:31], v[120:123], v[80:83]
  v_exp_f32 v15, v15
  ds_read_b64_tr_b16 v[26:27], v3 offset:18432
  v_mfma_f32_16x16x32_bf16 v[88:91], v[28:31], v[192:195], v[88:91]
  v_fma_f32 v13, v13, v11, v11
  v_fma_f32 v14, v14, v11, v11
  ds_read_b64_tr_b16 v[28:29], v4 offset:16384
  v_mfma_f32_16x16x32_bf16 v[84:87], v[32:35], v[120:123], v[84:87]
  s_add_u32 m0, s33, 106496
  s_add_u32 s49, s32, 2359680
  buffer_load_dwordx4 v1, s[8:11], s49 offen lds
  ds_read_b64_tr_b16 v[30:31], v4 offset:18432
  v_mfma_f32_16x16x32_bf16 v[92:95], v[32:35], v[192:195], v[92:95]
  v_exp_f32 v16, v16
  s_waitcnt lgkmcnt(4)
  ds_read_b64_tr_b16 v[32:33], v3 offset:20480
  v_mfma_f32_16x16x32_bf16 v[80:83], v[36:39], v[124:127], v[80:83]
  v_rcp_f32 v13, v13
  ds_read_b64_tr_b16 v[34:35], v3 offset:22528
  v_mfma_f32_16x16x32_bf16 v[88:91], v[36:39], v[196:199], v[88:91]
  v_fma_f32 v15, v15, v11, v11
  v_fma_f32 v16, v16, v11, v11
  ds_read_b64_tr_b16 v[36:37], v4 offset:20480
  v_mfma_f32_16x16x32_bf16 v[84:87], v[40:43], v[124:127], v[84:87]
  v_rcp_f32 v14, v14
  ds_read_b64_tr_b16 v[38:39], v4 offset:22528
  v_mfma_f32_16x16x32_bf16 v[92:95], v[40:43], v[196:199], v[92:95]
  v_rcp_f32 v15, v15
  s_waitcnt lgkmcnt(4)
  ds_read_b64_tr_b16 v[40:41], v3 offset:24576
  v_mfma_f32_16x16x32_bf16 v[80:83], v[24:27], v[128:131], v[80:83]
  v_mul_f32 v96, v96, v13
  v_mul_f32 v97, v97, v14
  ds_read_b64_tr_b16 v[42:43], v3 offset:26624
  v_mfma_f32_16x16x32_bf16 v[88:91], v[24:27], v[200:203], v[88:91]
  v_rcp_f32 v16, v16
  ds_read_b64_tr_b16 v[24:25], v4 offset:24576
  v_mfma_f32_16x16x32_bf16 v[84:87], v[28:31], v[128:131], v[84:87]
  s_add_u32 m0, s33, 114688
  s_add_u32 s49, s32, 2949504
  buffer_load_dwordx4 v1, s[8:11], s49 offen lds
  ds_read_b64_tr_b16 v[26:27], v4 offset:26624
  v_mfma_f32_16x16x32_bf16 v[92:95], v[28:31], v[200:203], v[92:95]
  v_cvt_pk_bf16_f32 v56, v96, v97
  v_mul_f32 v98, v98, v15
  s_waitcnt lgkmcnt(4)
  ds_read_b64_tr_b16 v[28:29], v3 offset:28672
  v_mfma_f32_16x16x32_bf16 v[80:83], v[32:35], v[132:135], v[80:83]
  v_mul_f32 v99, v99, v16
  v_cvt_pk_bf16_f32 v57, v98, v99
  ds_read_b64_tr_b16 v[30:31], v3 offset:30720
  v_mfma_f32_16x16x32_bf16 v[88:91], v[32:35], v[204:207], v[88:91]
  v_mul_f32 v13, v100, v9
  v_mul_f32 v14, v101, v9
  ds_read_b64_tr_b16 v[32:33], v4 offset:28672
  v_mfma_f32_16x16x32_bf16 v[84:87], v[36:39], v[132:135], v[84:87]
  s_mov_b64 exec, 0x1ff
  global_load_dword v45, v44, s[70:71]
  global_load_dword v45, v44, s[72:73]
  s_mov_b64 exec, -1
  ds_read_b64_tr_b16 v[34:35], v4 offset:30720
  v_mfma_f32_16x16x32_bf16 v[92:95], v[36:39], v[204:207], v[92:95]
  v_exp_f32 v13, v13
  s_waitcnt lgkmcnt(4)
  ds_read_b64_tr_b16 v[36:37], v3 offset:32768
  v_mfma_f32_16x16x32_bf16 v[80:83], v[40:43], v[136:139], v[80:83]
  v_mul_f32 v15, v102, v9
  v_mul_f32 v16, v103, v9
  ds_read_b64_tr_b16 v[38:39], v3 offset:34816
  v_mfma_f32_16x16x32_bf16 v[88:91], v[40:43], v[208:211], v[88:91]
  v_exp_f32 v14, v14
  ds_read_b64_tr_b16 v[40:41], v4 offset:32768
  v_mfma_f32_16x16x32_bf16 v[84:87], v[24:27], v[136:139], v[84:87]
  s_add_u32 m0, s33, 122880
  s_add_u32 s49, s32, 3539328
  buffer_load_dwordx4 v1, s[8:11], s49 offen lds
  ds_read_b64_tr_b16 v[42:43], v4 offset:34816
  v_mfma_f32_16x16x32_bf16 v[92:95], v[24:27], v[208:211], v[92:95]
  v_exp_f32 v15, v15
  s_waitcnt lgkmcnt(4)
  ds_read_b64_tr_b16 v[24:25], v3 offset:36864
  v_mfma_f32_16x16x32_bf16 v[80:83], v[28:31], v[140:143], v[80:83]
  v_fma_f32 v13, v13, v11, v11
  v_fma_f32 v14, v14, v11, v11
  ds_read_b64_tr_b16 v[26:27], v3 offset:38912
  v_mfma_f32_16x16x32_bf16 v[88:91], v[28:31], v[212:215], v[88:91]
  v_exp_f32 v16, v16
  ds_read_b64_tr_b16 v[28:29], v4 offset:36864
  v_mfma_f32_16x16x32_bf16 v[84:87], v[32:35], v[140:143], v[84:87]
  v_rcp_f32 v13, v13
  ds_read_b64_tr_b16 v[30:31], v4 offset:38912
  v_mfma_f32_16x16x32_bf16 v[92:95], v[32:35], v[212:215], v[92:95]
  v_fma_f32 v15, v15, v11, v11
  v_fma_f32 v16, v16, v11, v11
  s_waitcnt lgkmcnt(4)
  ds_read_b64_tr_b16 v[32:33], v3 offset:40960
  v_mfma_f32_16x16x32_bf16 v[80:83], v[36:39], v[144:147], v[80:83]
  v_rcp_f32 v14, v14
  ds_read_b64_tr_b16 v[34:35], v3 offset:43008
  v_mfma_f32_16x16x32_bf16 v[88:91], v[36:39], v[216:219], v[88:91]
  v_rcp_f32 v15, v15
  ds_read_b64_tr_b16 v[36:37], v4 offset:40960
  v_mfma_f32_16x16x32_bf16 v[84:87], v[40:43], v[144:147], v[84:87]
  s_add_u32 m0, s33, 131072
  s_add_u32 s49, s32, 4129152
  buffer_load_dwordx4 v1, s[8:11], s49 offen lds
  ds_read_b64_tr_b16 v[38:39], v4 offset:43008
  v_mfma_f32_16x16x32_bf16 v[92:95], v[40:43], v[216:219], v[92:95]
  v_mul_f32 v100, v100, v13
  v_mul_f32 v101, v101, v14
  s_waitcnt lgkmcnt(4)
  ds_read_b64_tr_b16 v[40:41], v3 offset:45056
  v_mfma_f32_16x16x32_bf16 v[80:83], v[24:27], v[148:151], v[80:83]
  v_rcp_f32 v16, v16
  ds_read_b64_tr_b16 v[42:43], v3 offset:47104
  v_mfma_f32_16x16x32_bf16 v[88:91], v[24:27], v[220:223], v[88:91]
  v_cvt_pk_bf16_f32 v58, v100, v101
  v_mul_f32 v102, v102, v15
  ds_read_b64_tr_b16 v[24:25], v4 offset:45056
  v_mfma_f32_16x16x32_bf16 v[84:87], v[28:31], v[148:151], v[84:87]
  v_mul_f32 v103, v103, v16
  v_cvt_pk_bf16_f32 v59, v102, v103
  ds_read_b64_tr_b16 v[26:27], v4 offset:47104
  v_mfma_f32_16x16x32_bf16 v[92:95], v[28:31], v[220:223], v[92:95]
  v_mul_f32 v13, v104, v10
  v_mul_f32 v14, v105, v10
  s_waitcnt lgkmcnt(4)
  ds_read_b64_tr_b16 v[28:29], v5 offset:0
  v_mfma_f32_16x16x32_bf16 v[80:83], v[32:35], v[152:155], v[80:83]
  v_exp_f32 v13, v13
  ds_read_b64_tr_b16 v[30:31], v5 offset:2048
  v_mfma_f32_16x16x32_bf16 v[88:91], v[32:35], v[224:227], v[88:91]
  v_mul_f32 v15, v106, v10
  v_mul_f32 v16, v107, v10
  ds_read_b64_tr_b16 v[32:33], v6 offset:0
  v_mfma_f32_16x16x32_bf16 v[84:87], v[36:39], v[152:155], v[84:87]
  s_add_u32 m0, s33, 139264
  s_add_u32 s49, s32, 4718976
  buffer_load_dwordx4 v1, s[8:11], s49 offen lds
  ds_read_b64_tr_b16 v[34:35], v6 offset:2048
  v_mfma_f32_16x16x32_bf16 v[92:95], v[36:39], v[224:227], v[92:95]
  v_exp_f32 v14, v14
  s_waitcnt lgkmcnt(4)
  ds_read_b64_tr_b16 v[36:37], v5 offset:4096
  v_mfma_f32_16x16x32_bf16 v[80:83], v[40:43], v[156:159], v[80:83]
  v_exp_f32 v15, v15
  ds_read_b64_tr_b16 v[38:39], v5 offset:6144
  v_mfma_f32_16x16x32_bf16 v[88:91], v[40:43], v[228:231], v[88:91]
  v_fma_f32 v13, v13, v12, v12
  v_fma_f32 v14, v14, v12, v12
  ds_read_b64_tr_b16 v[40:41], v6 offset:4096
  v_mfma_f32_16x16x32_bf16 v[84:87], v[24:27], v[156:159], v[84:87]
  v_exp_f32 v16, v16
  ds_read_b64_tr_b16 v[42:43], v6 offset:6144
  v_mfma_f32_16x16x32_bf16 v[92:95], v[24:27], v[228:231], v[92:95]
  v_rcp_f32 v13, v13
  s_waitcnt vmcnt(5)
  s_barrier
  s_waitcnt lgkmcnt(4)
  ds_read_b64_tr_b16 v[24:25], v5 offset:8192
  v_mfma_f32_16x16x32_bf16 v[80:83], v[28:31], v[160:163], v[80:83]
  v_fma_f32 v15, v15, v12, v12
  v_fma_f32 v16, v16, v12, v12
  ds_read_b64_tr_b16 v[26:27], v5 offset:10240
  v_mfma_f32_16x16x32_bf16 v[88:91], v[28:31], v[232:235], v[88:91]
  v_rcp_f32 v14, v14
  ds_read_b64_tr_b16 v[28:29], v6 offset:8192
  v_mfma_f32_16x16x32_bf16 v[84:87], v[32:35], v[160:163], v[84:87]
  s_add_u32 m0, s33, 0
  s_add_u32 s49, s32, 512
  buffer_load_dwordx4 v1, s[8:11], s49 offen lds
  ds_read_b64_tr_b16 v[30:31], v6 offset:10240
  v_mfma_f32_16x16x32_bf16 v[92:95], v[32:35], v[232:235], v[92:95]
  v_rcp_f32 v15, v15
  s_waitcnt lgkmcnt(4)
  ds_read_b64_tr_b16 v[32:33], v5 offset:12288
  v_mfma_f32_16x16x32_bf16 v[80:83], v[36:39], v[164:167], v[80:83]
  v_mul_f32 v104, v104, v13
  v_mul_f32 v105, v105, v14
  ds_read_b64_tr_b16 v[34:35], v5 offset:14336
  v_mfma_f32_16x16x32_bf16 v[88:91], v[36:39], v[236:239], v[88:91]
  v_rcp_f32 v16, v16
  ds_read_b64_tr_b16 v[36:37], v6 offset:12288
  v_mfma_f32_16x16x32_bf16 v[84:87], v[40:43], v[164:167], v[84:87]
  v_cvt_pk_bf16_f32 v60, v104, v105
  v_mul_f32 v106, v106, v15
  ds_read_b64_tr_b16 v[38:39], v6 offset:14336
  v_mfma_f32_16x16x32_bf16 v[92:95], v[40:43], v[236:239], v[92:95]
  v_mul_f32 v107, v107, v16
  v_cvt_pk_bf16_f32 v61, v106, v107
  s_waitcnt lgkmcnt(4)
  ds_read_b64_tr_b16 v[40:41], v5 offset:16384
  v_mfma_f32_16x16x32_bf16 v[80:83], v[24:27], v[168:171], v[80:83]
  v_mul_f32 v13, v108, v10
  v_mul_f32 v14, v109, v10
  ds_read_b64_tr_b16 v[42:43], v5 offset:18432
  v_mfma_f32_16x16x32_bf16 v[88:91], v[24:27], v[240:243], v[88:91]
  v_exp_f32 v13, v13
  ds_read_b64_tr_b16 v[24:25], v6 offset:16384
  v_mfma_f32_16x16x32_bf16 v[84:87], v[28:31], v[168:171], v[84:87]
  s_add_u32 m0, s33, 8192
  s_add_u32 s49, s32, 590336
  buffer_load_dwordx4 v1, s[8:11], s49 offen lds
  ds_read_b64_tr_b16 v[26:27], v6 offset:18432
  v_mfma_f32_16x16x32_bf16 v[92:95], v[28:31], v[240:243], v[92:95]
  v_mul_f32 v15, v110, v10
  v_mul_f32 v16, v111, v10
  s_waitcnt lgkmcnt(4)
  ds_read_b64_tr_b16 v[28:29], v5 offset:20480
  v_mfma_f32_16x16x32_bf16 v[80:83], v[32:35], v[172:175], v[80:83]
  v_exp_f32 v14, v14
  ds_read_b64_tr_b16 v[30:31], v5 offset:22528
  v_mfma_f32_16x16x32_bf16 v[88:91], v[32:35], v[244:247], v[88:91]
  v_exp_f32 v15, v15
  ds_read_b64_tr_b16 v[32:33], v6 offset:20480
  v_mfma_f32_16x16x32_bf16 v[84:87], v[36:39], v[172:175], v[84:87]
  v_fma_f32 v13, v13, v12, v12
  v_fma_f32 v14, v14, v12, v12
  ds_read_b64_tr_b16 v[34:35], v6 offset:22528
  v_mfma_f32_16x16x32_bf16 v[92:95], v[36:39], v[244:247], v[92:95]
  v_exp_f32 v16, v16
  s_waitcnt lgkmcnt(4)
  ds_read_b64_tr_b16 v[36:37], v5 offset:24576
  v_mfma_f32_16x16x32_bf16 v[80:83], v[40:43], v[176:179], v[80:83]
  v_rcp_f32 v13, v13
  ds_read_b64_tr_b16 v[38:39], v5 offset:26624
  v_mfma_f32_16x16x32_bf16 v[88:91], v[40:43], v[248:251], v[88:91]
  v_fma_f32 v15, v15, v12, v12
  v_fma_f32 v16, v16, v12, v12
  ds_read_b64_tr_b16 v[40:41], v6 offset:24576
  v_mfma_f32_16x16x32_bf16 v[84:87], v[24:27], v[176:179], v[84:87]
  s_add_u32 m0, s33, 16384
  s_add_u32 s49, s32, 1180160
  buffer_load_dwordx4 v1, s[8:11], s49 offen lds
  ds_read_b64_tr_b16 v[42:43], v6 offset:26624
  v_mfma_f32_16x16x32_bf16 v[92:95], v[24:27], v[248:251], v[92:95]
  v_rcp_f32 v14, v14
  s_waitcnt lgkmcnt(4)
  ds_read_b64_tr_b16 v[24:25], v5 offset:28672
  v_mfma_f32_16x16x32_bf16 v[80:83], v[28:31], v[180:183], v[80:83]
  v_rcp_f32 v15, v15
  ds_read_b64_tr_b16 v[26:27], v5 offset:30720
  v_mfma_f32_16x16x32_bf16 v[88:91], v[28:31], v[252:255], v[88:91]
  v_mul_f32 v108, v108, v13
  v_mul_f32 v109, v109, v14
  ds_read_b64_tr_b16 v[28:29], v6 offset:28672
  v_mfma_f32_16x16x32_bf16 v[84:87], v[32:35], v[180:183], v[84:87]
  v_rcp_f32 v16, v16
  ds_read_b64_tr_b16 v[30:31], v6 offset:30720
  v_mfma_f32_16x16x32_bf16 v[92:95], v[32:35], v[252:255], v[92:95]
  v_cvt_pk_bf16_f32 v62, v108, v109
  v_mul_f32 v110, v110, v15
  v_mul_f32 v111, v111, v16
  v_cvt_pk_bf16_f32 v63, v110, v111
  s_waitcnt lgkmcnt(4)
  ds_read_b64_tr_b16 v[32:33], v5 offset:32768
  v_mfma_f32_16x16x32_bf16 v[96:99], v[36:39], v[112:115], 0
  ds_read_b64_tr_b16 v[34:35], v5 offset:34816
  v_mfma_f32_16x16x32_bf16 v[104:107], v[36:39], v[184:187], 0
  ds_read_b64_tr_b16 v[36:37], v6 offset:32768
  v_mfma_f32_16x16x32_bf16 v[100:103], v[40:43], v[112:115], 0
  s_add_u32 m0, s33, 24576
  s_add_u32 s49, s32, 1769984
  buffer_load_dwordx4 v1, s[8:11], s49 offen lds
  ds_read_b64_tr_b16 v[38:39], v6 offset:34816
  v_mfma_f32_16x16x32_bf16 v[108:111], v[40:43], v[184:187], 0
  s_waitcnt lgkmcnt(4)
  ds_read_b64_tr_b16 v[40:41], v5 offset:36864
  v_mfma_f32_16x16x32_bf16 v[96:99], v[24:27], v[116:119], v[96:99]
  v_mul_f32 v13, v80, v9
  v_mul_f32 v14, v81, v9
  ds_read_b64_tr_b16 v[42:43], v5 offset:38912
  v_mfma_f32_16x16x32_bf16 v[104:107], v[24:27], v[188:191], v[104:107]
  v_exp_f32 v13, v13
  ds_read_b64_tr_b16 v[24:25], v6 offset:36864
  v_mfma_f32_16x16x32_bf16 v[100:103], v[28:31], v[116:119], v[100:103]
  v_mul_f32 v15, v82, v9
  v_mul_f32 v16, v83, v9
  ds_read_b64_tr_b16 v[26:27], v6 offset:38912
  v_mfma_f32_16x16x32_bf16 v[108:111], v[28:31], v[188:191], v[108:111]
  v_exp_f32 v14, v14
  s_waitcnt lgkmcnt(4)
  ds_read_b64_tr_b16 v[28:29], v5 offset:40960
  v_mfma_f32_16x16x32_bf16 v[96:99], v[32:35], v[120:123], v[96:99]
  v_exp_f32 v15, v15
  ds_read_b64_tr_b16 v[30:31], v5 offset:43008
  v_mfma_f32_16x16x32_bf16 v[104:107], v[32:35], v[192:195], v[104:107]
  v_fma_f32 v13, v13, v11, v11
  v_fma_f32 v14, v14, v11, v11
  ds_read_b64_tr_b16 v[32:33], v6 offset:40960
  v_mfma_f32_16x16x32_bf16 v[100:103], v[36:39], v[120:123], v[100:103]
  s_add_u32 m0, s33, 32768
  s_add_u32 s49, s32, 2359808
  buffer_load_dwordx4 v1, s[8:11], s49 offen lds
  ds_read_b64_tr_b16 v[34:35], v6 offset:43008
  v_mfma_f32_16x16x32_bf16 v[108:111], v[36:39], v[192:195], v[108:111]
  v_exp_f32 v16, v16
  s_waitcnt lgkmcnt(4)
  ds_read_b64_tr_b16 v[36:37], v5 offset:45056
  v_mfma_f32_16x16x32_bf16 v[96:99], v[40:43], v[124:127], v[96:99]
  v_rcp_f32 v13, v13
  ds_read_b64_tr_b16 v[38:39], v5 offset:47104
  v_mfma_f32_16x16x32_bf16 v[104:107], v[40:43], v[196:199], v[104:107]
  v_fma_f32 v15, v15, v11, v11
  v_fma_f32 v16, v16, v11, v11
  ds_read_b64_tr_b16 v[40:41], v6 offset:45056
  v_mfma_f32_16x16x32_bf16 v[100:103], v[24:27], v[124:127], v[100:103]
  v_rcp_f32 v14, v14
  ds_read_b64_tr_b16 v[42:43], v6 offset:47104
  v_mfma_f32_16x16x32_bf16 v[108:111], v[24:27], v[196:199], v[108:111]
  v_rcp_f32 v15, v15
  s_waitcnt lgkmcnt(4)
  ds_read_b64_tr_b16 v[24:25], v7 offset:0
  v_mfma_f32_16x16x32_bf16 v[96:99], v[28:31], v[128:131], v[96:99]
  v_mul_f32 v80, v80, v13
  v_mul_f32 v81, v81, v14
  ds_read_b64_tr_b16 v[26:27], v7 offset:2048
  v_mfma_f32_16x16x32_bf16 v[104:107], v[28:31], v[200:203], v[104:107]
  v_rcp_f32 v16, v16
  ds_read_b64_tr_b16 v[28:29], v8 offset:0
  v_mfma_f32_16x16x32_bf16 v[100:103], v[32:35], v[128:131], v[100:103]
  s_add_u32 m0, s33, 40960
  s_add_u32 s49, s32, 2949632
  buffer_load_dwordx4 v1, s[8:11], s49 offen lds
  ds_read_b64_tr_b16 v[30:31], v8 offset:2048
  v_mfma_f32_16x16x32_bf16 v[108:111], v[32:35], v[200:203], v[108:111]
  v_cvt_pk_bf16_f32 v64, v80, v81
  v_mul_f32 v82, v82, v15
  s_waitcnt lgkmcnt(4)
  ds_read_b64_tr_b16 v[32:33], v7 offset:4096
  v_mfma_f32_16x16x32_bf16 v[96:99], v[36:39], v[132:135], v[96:99]
  v_mul_f32 v83, v83, v16
  v_cvt_pk_bf16_f32 v65, v82, v83
  ds_read_b64_tr_b16 v[34:35], v7 offset:6144
  v_mfma_f32_16x16x32_bf16 v[104:107], v[36:39], v[204:207], v[104:107]
  v_mul_f32 v13, v84, v9
  v_mul_f32 v14, v85, v9
  ds_read_b64_tr_b16 v[36:37], v8 offset:4096
  v_mfma_f32_16x16x32_bf16 v[100:103], v[40:43], v[132:135], v[100:103]
  v_exp_f32 v13, v13
  ds_read_b64_tr_b16 v[38:39], v8 offset:6144
  v_mfma_f32_16x16x32_bf16 v[108:111], v[40:43], v[204:207], v[108:111]
  v_mul_f32 v15, v86, v9
  v_mul_f32 v16, v87, v9
  s_waitcnt vmcnt(3)
  s_barrier
  s_waitcnt lgkmcnt(4)
  ds_read_b64_tr_b16 v[40:41], v7 offset:8192
  v_mfma_f32_16x16x32_bf16 v[96:99], v[24:27], v[136:139], v[96:99]
  v_exp_f32 v14, v14
  ds_read_b64_tr_b16 v[42:43], v7 offset:10240
  v_mfma_f32_16x16x32_bf16 v[104:107], v[24:27], v[208:211], v[104:107]
  v_exp_f32 v15, v15
  ds_read_b64_tr_b16 v[24:25], v8 offset:8192
  v_mfma_f32_16x16x32_bf16 v[100:103], v[28:31], v[136:139], v[100:103]
  s_add_u32 m0, s33, 49152
  s_add_u32 s49, s32, 3539456
  buffer_load_dwordx4 v1, s[8:11], s49 offen lds
  ds_read_b64_tr_b16 v[26:27], v8 offset:10240
  v_mfma_f32_16x16x32_bf16 v[108:111], v[28:31], v[208:211], v[108:111]
  v_fma_f32 v13, v13, v11, v11
  v_fma_f32 v14, v14, v11, v11
  s_waitcnt lgkmcnt(4)
  ds_read_b64_tr_b16 v[28:29], v7 offset:12288
  v_mfma_f32_16x16x32_bf16 v[96:99], v[32:35], v[140:143], v[96:99]
  v_exp_f32 v16, v16
  ds_read_b64_tr_b16 v[30:31], v7 offset:14336
  v_mfma_f32_16x16x32_bf16 v[104:107], v[32:35], v[212:215], v[104:107]
  v_rcp_f32 v13, v13
  ds_read_b64_tr_b16 v[32:33], v8 offset:12288
  v_mfma_f32_16x16x32_bf16 v[100:103], v[36:39], v[140:143], v[100:103]
  s_add_u32 s48, s39, 0
  buffer_store_dwordx4 v[48:51], v0, s[16:19], s48 offen offset:0 sc1
  ds_read_b64_tr_b16 v[34:35], v8 offset:14336
  v_mfma_f32_16x16x32_bf16 v[108:111], v[36:39], v[212:215], v[108:111]
  v_fma_f32 v15, v15, v11, v11
  v_fma_f32 v16, v16, v11, v11
  s_waitcnt lgkmcnt(4)
  ds_read_b64_tr_b16 v[36:37], v7 offset:16384
  v_mfma_f32_16x16x32_bf16 v[96:99], v[40:43], v[144:147], v[96:99]
  v_rcp_f32 v14, v14
  ds_read_b64_tr_b16 v[38:39], v7 offset:18432
  v_mfma_f32_16x16x32_bf16 v[104:107], v[40:43], v[216:219], v[104:107]
  v_rcp_f32 v15, v15
  ds_read_b64_tr_b16 v[40:41], v8 offset:16384
  v_mfma_f32_16x16x32_bf16 v[100:103], v[24:27], v[144:147], v[100:103]
  s_add_u32 m0, s33, 57344
  s_add_u32 s49, s32, 4129280
  buffer_load_dwordx4 v1, s[8:11], s49 offen lds
  ds_read_b64_tr_b16 v[42:43], v8 offset:18432
  v_mfma_f32_16x16x32_bf16 v[108:111], v[24:27], v[216:219], v[108:111]
  v_mul_f32 v84, v84, v13
  v_mul_f32 v85, v85, v14
  s_waitcnt lgkmcnt(4)
  ds_read_b64_tr_b16 v[24:25], v7 offset:20480
  v_mfma_f32_16x16x32_bf16 v[96:99], v[28:31], v[148:151], v[96:99]
  v_rcp_f32 v16, v16
  ds_read_b64_tr_b16 v[26:27], v7 offset:22528
  v_mfma_f32_16x16x32_bf16 v[104:107], v[28:31], v[220:223], v[104:107]
  v_cvt_pk_bf16_f32 v66, v84, v85
  v_mul_f32 v86, v86, v15
  ds_read_b64_tr_b16 v[28:29], v8 offset:20480
  v_mfma_f32_16x16x32_bf16 v[100:103], v[32:35], v[148:151], v[100:103]
  s_add_u32 s48, s39, 0
  buffer_store_dwordx4 v[52:55], v0, s[16:19], s48 offen offset:1024 sc1
  ds_read_b64_tr_b16 v[30:31], v8 offset:22528
  v_mfma_f32_16x16x32_bf16 v[108:111], v[32:35], v[220:223], v[108:111]
  v_mul_f32 v87, v87, v16
  v_cvt_pk_bf16_f32 v67, v86, v87
  s_waitcnt lgkmcnt(4)
  ds_read_b64_tr_b16 v[32:33], v7 offset:24576
  v_mfma_f32_16x16x32_bf16 v[96:99], v[36:39], v[152:155], v[96:99]
  v_mul_f32 v13, v88, v10
  v_mul_f32 v14, v89, v10
  ds_read_b64_tr_b16 v[34:35], v7 offset:26624
  v_mfma_f32_16x16x32_bf16 v[104:107], v[36:39], v[224:227], v[104:107]
  v_exp_f32 v13, v13
  ds_read_b64_tr_b16 v[36:37], v8 offset:24576
  v_mfma_f32_16x16x32_bf16 v[100:103], v[40:43], v[152:155], v[100:103]
  s_add_u32 m0, s33, 65536
  s_add_u32 s49, s32, 4719104
  buffer_load_dwordx4 v1, s[8:11], s49 offen lds
  ds_read_b64_tr_b16 v[38:39], v8 offset:26624
  v_mfma_f32_16x16x32_bf16 v[108:111], v[40:43], v[224:227], v[108:111]
  v_mul_f32 v15, v90, v10
  v_mul_f32 v16, v91, v10
  s_waitcnt lgkmcnt(4)
  ds_read_b64_tr_b16 v[40:41], v7 offset:28672
  v_mfma_f32_16x16x32_bf16 v[96:99], v[24:27], v[156:159], v[96:99]
  v_exp_f32 v14, v14
  ds_read_b64_tr_b16 v[42:43], v7 offset:30720
  v_mfma_f32_16x16x32_bf16 v[104:107], v[24:27], v[228:231], v[104:107]
  v_exp_f32 v15, v15
  ds_read_b64_tr_b16 v[24:25], v8 offset:28672
  v_mfma_f32_16x16x32_bf16 v[100:103], v[28:31], v[156:159], v[100:103]
  v_fma_f32 v13, v13, v12, v12
  v_fma_f32 v14, v14, v12, v12
  ds_read_b64_tr_b16 v[26:27], v8 offset:30720
  v_mfma_f32_16x16x32_bf16 v[108:111], v[28:31], v[228:231], v[108:111]
  v_exp_f32 v16, v16
  s_waitcnt lgkmcnt(4)
  ds_read_b64_tr_b16 v[28:29], v7 offset:32768
  v_mfma_f32_16x16x32_bf16 v[96:99], v[32:35], v[160:163], v[96:99]
  v_rcp_f32 v13, v13
  ds_read_b64_tr_b16 v[30:31], v7 offset:34816
  v_mfma_f32_16x16x32_bf16 v[104:107], v[32:35], v[232:235], v[104:107]
  v_fma_f32 v15, v15, v12, v12
  v_fma_f32 v16, v16, v12, v12
  ds_read_b64_tr_b16 v[32:33], v8 offset:32768
  v_mfma_f32_16x16x32_bf16 v[100:103], v[36:39], v[160:163], v[100:103]
  s_add_u32 m0, s33, 73728
  s_add_u32 s49, s32, 640
  buffer_load_dwordx4 v1, s[8:11], s49 offen lds
  ds_read_b64_tr_b16 v[34:35], v8 offset:34816
  v_mfma_f32_16x16x32_bf16 v[108:111], v[36:39], v[232:235], v[108:111]
  v_rcp_f32 v14, v14
  s_waitcnt lgkmcnt(4)
  ds_read_b64_tr_b16 v[36:37], v7 offset:36864
  v_mfma_f32_16x16x32_bf16 v[96:99], v[40:43], v[164:167], v[96:99]
  v_rcp_f32 v15, v15
  ds_read_b64_tr_b16 v[38:39], v7 offset:38912
  v_mfma_f32_16x16x32_bf16 v[104:107], v[40:43], v[236:239], v[104:107]
  v_mul_f32 v88, v88, v13
  v_mul_f32 v89, v89, v14
  ds_read_b64_tr_b16 v[40:41], v8 offset:36864
  v_mfma_f32_16x16x32_bf16 v[100:103], v[24:27], v[164:167], v[100:103]
  s_add_u32 s48, s39, 2048
  buffer_store_dwordx4 v[56:59], v0, s[16:19], s48 offen offset:0 sc1
  ds_read_b64_tr_b16 v[42:43], v8 offset:38912
  v_mfma_f32_16x16x32_bf16 v[108:111], v[24:27], v[236:239], v[108:111]
  v_rcp_f32 v16, v16
  s_waitcnt lgkmcnt(4)
  ds_read_b64_tr_b16 v[24:25], v7 offset:40960
  v_mfma_f32_16x16x32_bf16 v[96:99], v[28:31], v[168:171], v[96:99]
  v_cvt_pk_bf16_f32 v68, v88, v89
  v_mul_f32 v90, v90, v15
  ds_read_b64_tr_b16 v[26:27], v7 offset:43008
  v_mfma_f32_16x16x32_bf16 v[104:107], v[28:31], v[240:243], v[104:107]
  v_mul_f32 v91, v91, v16
  v_cvt_pk_bf16_f32 v69, v90, v91
  ds_read_b64_tr_b16 v[28:29], v8 offset:40960
  v_mfma_f32_16x16x32_bf16 v[100:103], v[32:35], v[168:171], v[100:103]
  s_add_u32 m0, s33, 81920
  s_add_u32 s49, s32, 590464
  buffer_load_dwordx4 v1, s[8:11], s49 offen lds
  ds_read_b64_tr_b16 v[30:31], v8 offset:43008
  v_mfma_f32_16x16x32_bf16 v[108:111], v[32:35], v[240:243], v[108:111]
  v_mul_f32 v13, v92, v10
  v_mul_f32 v14, v93, v10
  s_waitcnt lgkmcnt(4)
  ds_read_b64_tr_b16 v[32:33], v7 offset:45056
  v_mfma_f32_16x16x32_bf16 v[96:99], v[36:39], v[172:175], v[96:99]
  v_exp_f32 v13, v13
  ds_read_b64_tr_b16 v[34:35], v7 offset:47104
  v_mfma_f32_16x16x32_bf16 v[104:107], v[36:39], v[244:247], v[104:107]
  v_mul_f32 v15, v94, v10
  v_mul_f32 v16, v95, v10
  ds_read_b64_tr_b16 v[36:37], v8 offset:45056
  v_mfma_f32_16x16x32_bf16 v[100:103], v[40:43], v[172:175], v[100:103]
  s_add_u32 s48, s39, 2048
  buffer_store_dwordx4 v[60:63], v0, s[16:19], s48 offen offset:1024 sc1
  ds_read_b64_tr_b16 v[38:39], v8 offset:47104
  v_mfma_f32_16x16x32_bf16 v[108:111], v[40:43], v[244:247], v[108:111]
  v_exp_f32 v14, v14
  s_waitcnt lgkmcnt(4)
  ds_read_b64_tr_b16 v[40:41], v3 offset:0
  v_mfma_f32_16x16x32_bf16 v[96:99], v[24:27], v[176:179], v[96:99]
  v_exp_f32 v15, v15
  ds_read_b64_tr_b16 v[42:43], v3 offset:2048
  v_mfma_f32_16x16x32_bf16 v[104:107], v[24:27], v[248:251], v[104:107]
  v_fma_f32 v13, v13, v12, v12
  v_fma_f32 v14, v14, v12, v12
  ds_read_b64_tr_b16 v[24:25], v4 offset:0
  v_mfma_f32_16x16x32_bf16 v[100:103], v[28:31], v[176:179], v[100:103]
  s_add_u32 m0, s33, 90112
  s_add_u32 s49, s32, 1180288
  buffer_load_dwordx4 v1, s[8:11], s49 offen lds
  ds_read_b64_tr_b16 v[26:27], v4 offset:2048
  v_mfma_f32_16x16x32_bf16 v[108:111], v[28:31], v[248:251], v[108:111]
  v_exp_f32 v16, v16
  s_waitcnt lgkmcnt(4)
  ds_read_b64_tr_b16 v[28:29], v3 offset:4096
  v_mfma_f32_16x16x32_bf16 v[96:99], v[32:35], v[180:183], v[96:99]
  v_rcp_f32 v13, v13
  ds_read_b64_tr_b16 v[30:31], v3 offset:6144
  v_mfma_f32_16x16x32_bf16 v[104:107], v[32:35], v[252:255], v[104:107]
  v_fma_f32 v15, v15, v12, v12
  v_fma_f32 v16, v16, v12, v12
  ds_read_b64_tr_b16 v[32:33], v4 offset:4096
  v_mfma_f32_16x16x32_bf16 v[100:103], v[36:39], v[180:183], v[100:103]
  v_rcp_f32 v14, v14
  ds_read_b64_tr_b16 v[34:35], v4 offset:6144
  v_mfma_f32_16x16x32_bf16 v[108:111], v[36:39], v[252:255], v[108:111]
  v_rcp_f32 v15, v15
  s_waitcnt vmcnt(5)
  s_barrier
  v_mul_f32 v92, v92, v13
  v_mul_f32 v93, v93, v14
  v_rcp_f32 v16, v16
  v_cvt_pk_bf16_f32 v70, v92, v93
  v_mul_f32 v94, v94, v15
  v_mul_f32 v95, v95, v16
  v_cvt_pk_bf16_f32 v71, v94, v95
  s_waitcnt lgkmcnt(4)
  ds_read_b64_tr_b16 v[36:37], v3 offset:8192
  v_mfma_f32_16x16x32_bf16 v[80:83], v[40:43], v[112:115], 0
  ds_read_b64_tr_b16 v[38:39], v3 offset:10240
  v_mfma_f32_16x16x32_bf16 v[88:91], v[40:43], v[184:187], 0
  ds_read_b64_tr_b16 v[40:41], v4 offset:8192
  v_mfma_f32_16x16x32_bf16 v[84:87], v[24:27], v[112:115], 0
  s_add_u32 m0, s33, 98304
  s_add_u32 s49, s32, 1770112
  buffer_load_dwordx4 v1, s[8:11], s49 offen lds
  ds_read_b64_tr_b16 v[42:43], v4 offset:10240
  v_mfma_f32_16x16x32_bf16 v[92:95], v[24:27], v[184:187], 0
  s_waitcnt lgkmcnt(4)
  ds_read_b64_tr_b16 v[24:25], v3 offset:12288
  v_mfma_f32_16x16x32_bf16 v[80:83], v[28:31], v[116:119], v[80:83]
  v_mul_f32 v13, v96, v9
  v_mul_f32 v14, v97, v9
  ds_read_b64_tr_b16 v[26:27], v3 offset:14336
  v_mfma_f32_16x16x32_bf16 v[88:91], v[28:31], v[188:191], v[88:91]
  v_exp_f32 v13, v13
  ds_read_b64_tr_b16 v[28:29], v4 offset:12288
  v_mfma_f32_16x16x32_bf16 v[84:87], v[32:35], v[116:119], v[84:87]
  s_add_u32 s48, s39, 4096
  buffer_store_dwordx4 v[64:67], v0, s[16:19], s48 offen offset:0 sc1
  ds_read_b64_tr_b16 v[30:31], v4 offset:14336
  v_mfma_f32_16x16x32_bf16 v[92:95], v[32:35], v[188:191], v[92:95]
  v_mul_f32 v15, v98, v9
  v_mul_f32 v16, v99, v9
  s_waitcnt lgkmcnt(4)
  ds_read_b64_tr_b16 v[32:33], v3 offset:16384
  v_mfma_f32_16x16x32_bf16 v[80:83], v[36:39], v[120:123], v[80:83]
  v_exp_f32 v14, v14
  ds_read_b64_tr_b16 v[34:35], v3 offset:18432
  v_mfma_f32_16x16x32_bf16 v[88:91], v[36:39], v[192:195], v[88:91]
  v_exp_f32 v15, v15
  ds_read_b64_tr_b16 v[36:37], v4 offset:16384
  v_mfma_f32_16x16x32_bf16 v[84:87], v[40:43], v[120:123], v[84:87]
  s_add_u32 m0, s33, 106496
  s_add_u32 s49, s32, 2359936
  buffer_load_dwordx4 v1, s[8:11], s49 offen lds
  ds_read_b64_tr_b16 v[38:39], v4 offset:18432
  v_mfma_f32_16x16x32_bf16 v[92:95], v[40:43], v[192:195], v[92:95]
  v_fma_f32 v13, v13, v11, v11
  v_fma_f32 v14, v14, v11, v11
  s_waitcnt lgkmcnt(4)
  ds_read_b64_tr_b16 v[40:41], v3 offset:20480
  v_mfma_f32_16x16x32_bf16 v[80:83], v[24:27], v[124:127], v[80:83]
  v_exp_f32 v16, v16
  ds_read_b64_tr_b16 v[42:43], v3 offset:22528
  v_mfma_f32_16x16x32_bf16 v[88:91], v[24:27], v[196:199], v[88:91]
  v_rcp_f32 v13, v13
  ds_read_b64_tr_b16 v[24:25], v4 offset:20480
  v_mfma_f32_16x16x32_bf16 v[84:87], v[28:31], v[124:127], v[84:87]
  s_add_u32 s48, s39, 4096
  buffer_store_dwordx4 v[68:71], v0, s[16:19], s48 offen offset:1024 sc1
  ds_read_b64_tr_b16 v[26:27], v4 offset:22528
  v_mfma_f32_16x16x32_bf16 v[92:95], v[28:31], v[196:199], v[92:95]
  v_fma_f32 v15, v15, v11, v11
  v_fma_f32 v16, v16, v11, v11
  s_waitcnt lgkmcnt(4)
  ds_read_b64_tr_b16 v[28:29], v3 offset:24576
  v_mfma_f32_16x16x32_bf16 v[80:83], v[32:35], v[128:131], v[80:83]
  v_rcp_f32 v14, v14
  ds_read_b64_tr_b16 v[30:31], v3 offset:26624
  v_mfma_f32_16x16x32_bf16 v[88:91], v[32:35], v[200:203], v[88:91]
  v_rcp_f32 v15, v15
  ds_read_b64_tr_b16 v[32:33], v4 offset:24576
  v_mfma_f32_16x16x32_bf16 v[84:87], v[36:39], v[128:131], v[84:87]
  s_add_u32 m0, s33, 114688
  s_add_u32 s49, s32, 2949760
  buffer_load_dwordx4 v1, s[8:11], s49 offen lds
  ds_read_b64_tr_b16 v[34:35], v4 offset:26624
  v_mfma_f32_16x16x32_bf16 v[92:95], v[36:39], v[200:203], v[92:95]
  v_mul_f32 v96, v96, v13
  v_mul_f32 v97, v97, v14
  s_waitcnt lgkmcnt(4)
  ds_read_b64_tr_b16 v[36:37], v3 offset:28672
  v_mfma_f32_16x16x32_bf16 v[80:83], v[40:43], v[132:135], v[80:83]
  v_rcp_f32 v16, v16
  ds_read_b64_tr_b16 v[38:39], v3 offset:30720
  v_mfma_f32_16x16x32_bf16 v[88:91], v[40:43], v[204:207], v[88:91]
  v_cvt_pk_bf16_f32 v72, v96, v97
  v_mul_f32 v98, v98, v15
  ds_read_b64_tr_b16 v[40:41], v4 offset:28672
  v_mfma_f32_16x16x32_bf16 v[84:87], v[24:27], v[132:135], v[84:87]
  v_mul_f32 v99, v99, v16
  v_cvt_pk_bf16_f32 v73, v98, v99
  ds_read_b64_tr_b16 v[42:43], v4 offset:30720
  v_mfma_f32_16x16x32_bf16 v[92:95], v[24:27], v[204:207], v[92:95]
  v_mul_f32 v13, v100, v9
  v_mul_f32 v14, v101, v9
  s_waitcnt lgkmcnt(4)
  ds_read_b64_tr_b16 v[24:25], v3 offset:32768
  v_mfma_f32_16x16x32_bf16 v[80:83], v[28:31], v[136:139], v[80:83]
  v_exp_f32 v13, v13
  ds_read_b64_tr_b16 v[26:27], v3 offset:34816
  v_mfma_f32_16x16x32_bf16 v[88:91], v[28:31], v[208:211], v[88:91]
  v_mul_f32 v15, v102, v9
  v_mul_f32 v16, v103, v9
  ds_read_b64_tr_b16 v[28:29], v4 offset:32768
  v_mfma_f32_16x16x32_bf16 v[84:87], v[32:35], v[136:139], v[84:87]
  s_add_u32 m0, s33, 122880
  s_add_u32 s49, s32, 3539584
  buffer_load_dwordx4 v1, s[8:11], s49 offen lds
  ds_read_b64_tr_b16 v[30:31], v4 offset:34816
  v_mfma_f32_16x16x32_bf16 v[92:95], v[32:35], v[208:211], v[92:95]
  v_exp_f32 v14, v14
  s_waitcnt lgkmcnt(4)
  ds_read_b64_tr_b16 v[32:33], v3 offset:36864
  v_mfma_f32_16x16x32_bf16 v[80:83], v[36:39], v[140:143], v[80:83]
  v_exp_f32 v15, v15
  ds_read_b64_tr_b16 v[34:35], v3 offset:38912
  v_mfma_f32_16x16x32_bf16 v[88:91], v[36:39], v[212:215], v[88:91]
  v_fma_f32 v13, v13, v11, v11
  v_fma_f32 v14, v14, v11, v11
  ds_read_b64_tr_b16 v[36:37], v4 offset:36864
  v_mfma_f32_16x16x32_bf16 v[84:87], v[40:43], v[140:143], v[84:87]
  v_exp_f32 v16, v16
  ds_read_b64_tr_b16 v[38:39], v4 offset:38912
  v_mfma_f32_16x16x32_bf16 v[92:95], v[40:43], v[212:215], v[92:95]
  v_rcp_f32 v13, v13
  s_waitcnt lgkmcnt(4)
  ds_read_b64_tr_b16 v[40:41], v3 offset:40960
  v_mfma_f32_16x16x32_bf16 v[80:83], v[24:27], v[144:147], v[80:83]
  v_fma_f32 v15, v15, v11, v11
  v_fma_f32 v16, v16, v11, v11
  ds_read_b64_tr_b16 v[42:43], v3 offset:43008
  v_mfma_f32_16x16x32_bf16 v[88:91], v[24:27], v[216:219], v[88:91]
  v_rcp_f32 v14, v14
  ds_read_b64_tr_b16 v[24:25], v4 offset:40960
  v_mfma_f32_16x16x32_bf16 v[84:87], v[28:31], v[144:147], v[84:87]
  s_add_u32 m0, s33, 131072
  s_add_u32 s49, s32, 4129408
  buffer_load_dwordx4 v1, s[8:11], s49 offen lds
  ds_read_b64_tr_b16 v[26:27], v4 offset:43008
  v_mfma_f32_16x16x32_bf16 v[92:95], v[28:31], v[216:219], v[92:95]
  v_rcp_f32 v15, v15
  s_waitcnt lgkmcnt(4)
  ds_read_b64_tr_b16 v[28:29], v3 offset:45056
  v_mfma_f32_16x16x32_bf16 v[80:83], v[32:35], v[148:151], v[80:83]
  v_mul_f32 v100, v100, v13
  v_mul_f32 v101, v101, v14
  ds_read_b64_tr_b16 v[30:31], v3 offset:47104
  v_mfma_f32_16x16x32_bf16 v[88:91], v[32:35], v[220:223], v[88:91]
  v_rcp_f32 v16, v16
  ds_read_b64_tr_b16 v[32:33], v4 offset:45056
  v_mfma_f32_16x16x32_bf16 v[84:87], v[36:39], v[148:151], v[84:87]
  v_cvt_pk_bf16_f32 v74, v100, v101
  v_mul_f32 v102, v102, v15
  ds_read_b64_tr_b16 v[34:35], v4 offset:47104
  v_mfma_f32_16x16x32_bf16 v[92:95], v[36:39], v[220:223], v[92:95]
  v_mul_f32 v103, v103, v16
  v_cvt_pk_bf16_f32 v75, v102, v103
  s_waitcnt lgkmcnt(4)
  ds_read_b64_tr_b16 v[36:37], v5 offset:0
  v_mfma_f32_16x16x32_bf16 v[80:83], v[40:43], v[152:155], v[80:83]
  v_mul_f32 v13, v104, v10
  v_mul_f32 v14, v105, v10
  ds_read_b64_tr_b16 v[38:39], v5 offset:2048
  v_mfma_f32_16x16x32_bf16 v[88:91], v[40:43], v[224:227], v[88:91]
  v_exp_f32 v13, v13
  ds_read_b64_tr_b16 v[40:41], v6 offset:0
  v_mfma_f32_16x16x32_bf16 v[84:87], v[24:27], v[152:155], v[84:87]
  s_add_u32 m0, s33, 139264
  s_add_u32 s49, s32, 4719232
  buffer_load_dwordx4 v1, s[8:11], s49 offen lds
  ds_read_b64_tr_b16 v[42:43], v6 offset:2048
  v_mfma_f32_16x16x32_bf16 v[92:95], v[24:27], v[224:227], v[92:95]
  v_mul_f32 v15, v106, v10
  v_mul_f32 v16, v107, v10
  s_waitcnt lgkmcnt(4)
  ds_read_b64_tr_b16 v[24:25], v5 offset:4096
  v_mfma_f32_16x16x32_bf16 v[80:83], v[28:31], v[156:159], v[80:83]
  v_exp_f32 v14, v14
  ds_read_b64_tr_b16 v[26:27], v5 offset:6144
  v_mfma_f32_16x16x32_bf16 v[88:91], v[28:31], v[228:231], v[88:91]
  v_exp_f32 v15, v15
  ds_read_b64_tr_b16 v[28:29], v6 offset:4096
  v_mfma_f32_16x16x32_bf16 v[84:87], v[32:35], v[156:159], v[84:87]
  v_fma_f32 v13, v13, v12, v12
  v_fma_f32 v14, v14, v12, v12
  ds_read_b64_tr_b16 v[30:31], v6 offset:6144
  v_mfma_f32_16x16x32_bf16 v[92:95], v[32:35], v[228:231], v[92:95]
  v_exp_f32 v16, v16
  s_waitcnt vmcnt(3)
  s_barrier
  s_waitcnt lgkmcnt(4)
  ds_read_b64_tr_b16 v[32:33], v5 offset:8192
  v_mfma_f32_16x16x32_bf16 v[80:83], v[36:39], v[160:163], v[80:83]
  v_rcp_f32 v13, v13
  ds_read_b64_tr_b16 v[34:35], v5 offset:10240
  v_mfma_f32_16x16x32_bf16 v[88:91], v[36:39], v[232:235], v[88:91]
  v_fma_f32 v15, v15, v12, v12
  v_fma_f32 v16, v16, v12, v12
  ds_read_b64_tr_b16 v[36:37], v6 offset:8192
  v_mfma_f32_16x16x32_bf16 v[84:87], v[40:43], v[160:163], v[84:87]
  s_add_u32 m0, s35, 0
  s_add_u32 s45, s36, 0
  v_rcp_f32 v14, v14
  ds_read_b64_tr_b16 v[38:39], v6 offset:10240
  v_mfma_f32_16x16x32_bf16 v[92:95], v[40:43], v[232:235], v[92:95]
  buffer_load_dwordx4 v2, s[12:15], s45 offen offset:0 lds
  s_waitcnt lgkmcnt(4)
  ds_read_b64_tr_b16 v[40:41], v5 offset:12288
  v_mfma_f32_16x16x32_bf16 v[80:83], v[24:27], v[164:167], v[80:83]
  v_rcp_f32 v15, v15
  ds_read_b64_tr_b16 v[42:43], v5 offset:14336
  v_mfma_f32_16x16x32_bf16 v[88:91], v[24:27], v[236:239], v[88:91]
  v_mul_f32 v104, v104, v13
  v_mul_f32 v105, v105, v14
  ds_read_b64_tr_b16 v[24:25], v6 offset:12288
  v_mfma_f32_16x16x32_bf16 v[84:87], v[28:31], v[164:167], v[84:87]
  s_add_u32 s48, s39, 6144
  buffer_store_dwordx4 v[72:75], v0, s[16:19], s48 offen offset:0 sc1
  ds_read_b64_tr_b16 v[26:27], v6 offset:14336
  v_mfma_f32_16x16x32_bf16 v[92:95], v[28:31], v[236:239], v[92:95]
  v_rcp_f32 v16, v16
  s_waitcnt lgkmcnt(4)
  ds_read_b64_tr_b16 v[28:29], v5 offset:16384
  v_mfma_f32_16x16x32_bf16 v[80:83], v[32:35], v[168:171], v[80:83]
  v_cvt_pk_bf16_f32 v76, v104, v105
  v_mul_f32 v106, v106, v15
  ds_read_b64_tr_b16 v[30:31], v5 offset:18432
  v_mfma_f32_16x16x32_bf16 v[88:91], v[32:35], v[240:243], v[88:91]
  v_mul_f32 v107, v107, v16
  v_cvt_pk_bf16_f32 v77, v106, v107
  ds_read_b64_tr_b16 v[32:33], v6 offset:16384
  v_mfma_f32_16x16x32_bf16 v[84:87], v[36:39], v[168:171], v[84:87]
  s_add_u32 m0, s35, 896
  v_mul_f32 v13, v108, v10
  v_mul_f32 v14, v109, v10
  ds_read_b64_tr_b16 v[34:35], v6 offset:18432
  v_mfma_f32_16x16x32_bf16 v[92:95], v[36:39], v[240:243], v[92:95]
  buffer_load_dwordx4 v2, s[12:15], s45 offen offset:128 lds
  s_waitcnt lgkmcnt(4)
  ds_read_b64_tr_b16 v[36:37], v5 offset:20480
  v_mfma_f32_16x16x32_bf16 v[80:83], v[40:43], v[172:175], v[80:83]
  v_exp_f32 v13, v13
  ds_read_b64_tr_b16 v[38:39], v5 offset:22528
  v_mfma_f32_16x16x32_bf16 v[88:91], v[40:43], v[244:247], v[88:91]
  v_mul_f32 v15, v110, v10
  v_mul_f32 v16, v111, v10
  ds_read_b64_tr_b16 v[40:41], v6 offset:20480
  v_mfma_f32_16x16x32_bf16 v[84:87], v[24:27], v[172:175], v[84:87]
  v_exp_f32 v14, v14
  ds_read_b64_tr_b16 v[42:43], v6 offset:22528
  v_mfma_f32_16x16x32_bf16 v[92:95], v[24:27], v[244:247], v[92:95]
  v_exp_f32 v15, v15
  s_waitcnt lgkmcnt(4)
  ds_read_b64_tr_b16 v[24:25], v5 offset:24576
  v_mfma_f32_16x16x32_bf16 v[80:83], v[28:31], v[176:179], v[80:83]
  v_fma_f32 v13, v13, v12, v12
  v_fma_f32 v14, v14, v12, v12
  ds_read_b64_tr_b16 v[26:27], v5 offset:26624
  v_mfma_f32_16x16x32_bf16 v[88:91], v[28:31], v[248:251], v[88:91]
  v_exp_f32 v16, v16
  ds_read_b64_tr_b16 v[28:29], v6 offset:24576
  v_mfma_f32_16x16x32_bf16 v[84:87], v[32:35], v[176:179], v[84:87]
  s_add_u32 m0, s35, 1792
  v_rcp_f32 v13, v13
  ds_read_b64_tr_b16 v[30:31], v6 offset:26624
  v_mfma_f32_16x16x32_bf16 v[92:95], v[32:35], v[248:251], v[92:95]
  buffer_load_dwordx4 v2, s[12:15], s45 offen offset:256 lds
  s_waitcnt lgkmcnt(4)
  ds_read_b64_tr_b16 v[32:33], v5 offset:28672
  v_mfma_f32_16x16x32_bf16 v[80:83], v[36:39], v[180:183], v[80:83]
  v_fma_f32 v15, v15, v12, v12
  v_fma_f32 v16, v16, v12, v12
  ds_read_b64_tr_b16 v[34:35], v5 offset:30720
  v_mfma_f32_16x16x32_bf16 v[88:91], v[36:39], v[252:255], v[88:91]
  v_rcp_f32 v14, v14
  ds_read_b64_tr_b16 v[36:37], v6 offset:28672
  v_mfma_f32_16x16x32_bf16 v[84:87], v[40:43], v[180:183], v[84:87]
  v_rcp_f32 v15, v15
  ds_read_b64_tr_b16 v[38:39], v6 offset:30720
  v_mfma_f32_16x16x32_bf16 v[92:95], v[40:43], v[252:255], v[92:95]
  v_mul_f32 v108, v108, v13
  v_mul_f32 v109, v109, v14
  s_add_u32 s48, s31, 3
  v_mov_b32 v18, s30
  v_mov_b32 v19, s48
  s_mov_b64 exec, 1
  buffer_store_dwordx2 v[18:19], v0, s[16:19], s55 offen sc1
  s_mov_b64 exec, -1
  v_rcp_f32 v16, v16
  v_cvt_pk_bf16_f32 v78, v108, v109
  v_mul_f32 v110, v110, v15
  v_mul_f32 v111, v111, v16
  v_cvt_pk_bf16_f32 v79, v110, v111
  s_waitcnt lgkmcnt(4)
  ds_read_b64_tr_b16 v[40:41], v5 offset:32768
  v_mfma_f32_16x16x32_bf16 v[96:99], v[24:27], v[112:115], 0
  ds_read_b64_tr_b16 v[42:43], v5 offset:34816
  v_mfma_f32_16x16x32_bf16 v[104:107], v[24:27], v[184:187], 0
  ds_read_b64_tr_b16 v[24:25], v6 offset:32768
  v_mfma_f32_16x16x32_bf16 v[100:103], v[28:31], v[112:115], 0
  s_add_u32 m0, s35, 24576
  s_add_u32 s45, s36, 73728
  ds_read_b64_tr_b16 v[26:27], v6 offset:34816
  v_mfma_f32_16x16x32_bf16 v[108:111], v[28:31], v[184:187], 0
  buffer_load_dwordx4 v2, s[12:15], s45 offen offset:0 lds
  s_waitcnt lgkmcnt(4)
  ds_read_b64_tr_b16 v[28:29], v5 offset:36864
  v_mfma_f32_16x16x32_bf16 v[96:99], v[32:35], v[116:119], v[96:99]
  v_mul_f32 v13, v80, v9
  v_mul_f32 v14, v81, v9
  ds_read_b64_tr_b16 v[30:31], v5 offset:38912
  v_mfma_f32_16x16x32_bf16 v[104:107], v[32:35], v[188:191], v[104:107]
  v_exp_f32 v13, v13
  ds_read_b64_tr_b16 v[32:33], v6 offset:36864
  v_mfma_f32_16x16x32_bf16 v[100:103], v[36:39], v[116:119], v[100:103]
  s_add_u32 s48, s39, 6144
  buffer_store_dwordx4 v[76:79], v0, s[16:19], s48 offen offset:1024 sc1
  ds_read_b64_tr_b16 v[34:35], v6 offset:38912
  v_mfma_f32_16x16x32_bf16 v[108:111], v[36:39], v[188:191], v[108:111]
  v_mul_f32 v15, v82, v9
  v_mul_f32 v16, v83, v9
  s_waitcnt lgkmcnt(4)
  ds_read_b64_tr_b16 v[36:37], v5 offset:40960
  v_mfma_f32_16x16x32_bf16 v[96:99], v[40:43], v[120:123], v[96:99]
  v_exp_f32 v14, v14
  ds_read_b64_tr_b16 v[38:39], v5 offset:43008
  v_mfma_f32_16x16x32_bf16 v[104:107], v[40:43], v[192:195], v[104:107]
  v_exp_f32 v15, v15
  ds_read_b64_tr_b16 v[40:41], v6 offset:40960
  v_mfma_f32_16x16x32_bf16 v[100:103], v[24:27], v[120:123], v[100:103]
  s_add_u32 m0, s35, 25472
  v_fma_f32 v13, v13, v11, v11
  v_fma_f32 v14, v14, v11, v11
  ds_read_b64_tr_b16 v[42:43], v6 offset:43008
  v_mfma_f32_16x16x32_bf16 v[108:111], v[24:27], v[192:195], v[108:111]
  buffer_load_dwordx4 v2, s[12:15], s45 offen offset:128 lds
  s_waitcnt lgkmcnt(4)
  ds_read_b64_tr_b16 v[24:25], v5 offset:45056
  v_mfma_f32_16x16x32_bf16 v[96:99], v[28:31], v[124:127], v[96:99]
  v_exp_f32 v16, v16
  ds_read_b64_tr_b16 v[26:27], v5 offset:47104
  v_mfma_f32_16x16x32_bf16 v[104:107], v[28:31], v[196:199], v[104:107]
  v_rcp_f32 v13, v13
  ds_read_b64_tr_b16 v[28:29], v6 offset:45056
  v_mfma_f32_16x16x32_bf16 v[100:103], v[32:35], v[124:127], v[100:103]
  v_fma_f32 v15, v15, v11, v11
  v_fma_f32 v16, v16, v11, v11
  ds_read_b64_tr_b16 v[30:31], v6 offset:47104
  v_mfma_f32_16x16x32_bf16 v[108:111], v[32:35], v[196:199], v[108:111]
  v_rcp_f32 v14, v14
  s_waitcnt lgkmcnt(4)
  ds_read_b64_tr_b16 v[32:33], v7 offset:0
  v_mfma_f32_16x16x32_bf16 v[96:99], v[36:39], v[128:131], v[96:99]
  v_rcp_f32 v15, v15
  ds_read_b64_tr_b16 v[34:35], v7 offset:2048
  v_mfma_f32_16x16x32_bf16 v[104:107], v[36:39], v[200:203], v[104:107]
  v_mul_f32 v80, v80, v13
  v_mul_f32 v81, v81, v14
  ds_read_b64_tr_b16 v[36:37], v8 offset:0
  v_mfma_f32_16x16x32_bf16 v[100:103], v[40:43], v[128:131], v[100:103]
  s_add_u32 m0, s35, 26368
  v_rcp_f32 v16, v16
  ds_read_b64_tr_b16 v[38:39], v8 offset:2048
  v_mfma_f32_16x16x32_bf16 v[108:111], v[40:43], v[200:203], v[108:111]
  buffer_load_dwordx4 v2, s[12:15], s45 offen offset:256 lds
  s_waitcnt lgkmcnt(4)
  ds_read_b64_tr_b16 v[40:41], v7 offset:4096
  v_mfma_f32_16x16x32_bf16 v[96:99], v[24:27], v[132:135], v[96:99]
  v_cvt_pk_bf16_f32 v80, v80, v81
  v_mul_f32 v82, v82, v15
  ds_read_b64_tr_b16 v[42:43], v7 offset:6144
  v_mfma_f32_16x16x32_bf16 v[104:107], v[24:27], v[204:207], v[104:107]
  v_mul_f32 v83, v83, v16
  v_cvt_pk_bf16_f32 v81, v82, v83
  ds_read_b64_tr_b16 v[24:25], v8 offset:4096
  v_mfma_f32_16x16x32_bf16 v[100:103], v[28:31], v[132:135], v[100:103]
  v_mul_f32 v13, v84, v9
  v_mul_f32 v14, v85, v9
  ds_read_b64_tr_b16 v[26:27], v8 offset:6144
  v_mfma_f32_16x16x32_bf16 v[108:111], v[28:31], v[204:207], v[108:111]
  v_exp_f32 v13, v13
  s_waitcnt vmcnt(5)
  s_barrier
  s_waitcnt lgkmcnt(4)
  ds_read_b64_tr_b16 v[28:29], v7 offset:8192
  v_mfma_f32_16x16x32_bf16 v[96:99], v[32:35], v[136:139], v[96:99]
  v_mul_f32 v15, v86, v9
  v_mul_f32 v16, v87, v9
  ds_read_b64_tr_b16 v[30:31], v7 offset:10240
  v_mfma_f32_16x16x32_bf16 v[104:107], v[32:35], v[208:211], v[104:107]
  v_exp_f32 v14, v14
  ds_read_b64_tr_b16 v[32:33], v8 offset:8192
  v_mfma_f32_16x16x32_bf16 v[100:103], v[36:39], v[136:139], v[100:103]
  s_add_u32 m0, s35, 49152
  s_add_u32 s45, s36, 147456
  v_exp_f32 v15, v15
  ds_read_b64_tr_b16 v[34:35], v8 offset:10240
  v_mfma_f32_16x16x32_bf16 v[108:111], v[36:39], v[208:211], v[108:111]
  buffer_load_dwordx4 v2, s[12:15], s45 offen offset:0 lds
  s_waitcnt lgkmcnt(4)
  ds_read_b64_tr_b16 v[36:37], v7 offset:12288
  v_mfma_f32_16x16x32_bf16 v[96:99], v[40:43], v[140:143], v[96:99]
  v_fma_f32 v13, v13, v11, v11
  v_fma_f32 v14, v14, v11, v11
  ds_read_b64_tr_b16 v[38:39], v7 offset:14336
  v_mfma_f32_16x16x32_bf16 v[104:107], v[40:43], v[212:215], v[104:107]
  v_exp_f32 v16, v16
  ds_read_b64_tr_b16 v[40:41], v8 offset:12288
  v_mfma_f32_16x16x32_bf16 v[100:103], v[24:27], v[140:143], v[100:103]
  v_rcp_f32 v13, v13
  ds_read_b64_tr_b16 v[42:43], v8 offset:14336
  v_mfma_f32_16x16x32_bf16 v[108:111], v[24:27], v[212:215], v[108:111]
  v_fma_f32 v15, v15, v11, v11
  v_fma_f32 v16, v16, v11, v11
  s_waitcnt lgkmcnt(4)
  ds_read_b64_tr_b16 v[24:25], v7 offset:16384
  v_mfma_f32_16x16x32_bf16 v[96:99], v[28:31], v[144:147], v[96:99]
  v_rcp_f32 v14, v14
  ds_read_b64_tr_b16 v[26:27], v7 offset:18432
  v_mfma_f32_16x16x32_bf16 v[104:107], v[28:31], v[216:219], v[104:107]
  v_rcp_f32 v15, v15
  ds_read_b64_tr_b16 v[28:29], v8 offset:16384
  v_mfma_f32_16x16x32_bf16 v[100:103], v[32:35], v[144:147], v[100:103]
  s_add_u32 m0, s35, 50048
  v_mul_f32 v84, v84, v13
  v_mul_f32 v85, v85, v14
  ds_read_b64_tr_b16 v[30:31], v8 offset:18432
  v_mfma_f32_16x16x32_bf16 v[108:111], v[32:35], v[216:219], v[108:111]
  buffer_load_dwordx4 v2, s[12:15], s45 offen offset:128 lds
  s_waitcnt lgkmcnt(4)
  ds_read_b64_tr_b16 v[32:33], v7 offset:20480
  v_mfma_f32_16x16x32_bf16 v[96:99], v[36:39], v[148:151], v[96:99]
  v_rcp_f32 v16, v16
  ds_read_b64_tr_b16 v[34:35], v7 offset:22528
  v_mfma_f32_16x16x32_bf16 v[104:107], v[36:39], v[220:223], v[104:107]
  v_cvt_pk_bf16_f32 v82, v84, v85
  v_mul_f32 v86, v86, v15
  ds_read_b64_tr_b16 v[36:37], v8 offset:20480
  v_mfma_f32_16x16x32_bf16 v[100:103], v[40:43], v[148:151], v[100:103]
  v_mul_f32 v87, v87, v16
  v_cvt_pk_bf16_f32 v83, v86, v87
  ds_read_b64_tr_b16 v[38:39], v8 offset:22528
  v_mfma_f32_16x16x32_bf16 v[108:111], v[40:43], v[220:223], v[108:111]
  v_mul_f32 v13, v88, v10
  v_mul_f32 v14, v89, v10
  s_waitcnt lgkmcnt(4)
  ds_read_b64_tr_b16 v[40:41], v7 offset:24576
  v_mfma_f32_16x16x32_bf16 v[96:99], v[24:27], v[152:155], v[96:99]
  v_exp_f32 v13, v13
  ds_read_b64_tr_b16 v[42:43], v7 offset:26624
  v_mfma_f32_16x16x32_bf16 v[104:107], v[24:27], v[224:227], v[104:107]
  v_mul_f32 v15, v90, v10
  v_mul_f32 v16, v91, v10
  ds_read_b64_tr_b16 v[24:25], v8 offset:24576
  v_mfma_f32_16x16x32_bf16 v[100:103], v[28:31], v[152:155], v[100:103]
  s_add_u32 m0, s35, 50944
  v_exp_f32 v14, v14
  ds_read_b64_tr_b16 v[26:27], v8 offset:26624
  v_mfma_f32_16x16x32_bf16 v[108:111], v[28:31], v[224:227], v[108:111]
  buffer_load_dwordx4 v2, s[12:15], s45 offen offset:256 lds
  s_waitcnt lgkmcnt(4)
  ds_read_b64_tr_b16 v[28:29], v7 offset:28672
  v_mfma_f32_16x16x32_bf16 v[96:99], v[32:35], v[156:159], v[96:99]
  v_exp_f32 v15, v15
  ds_read_b64_tr_b16 v[30:31], v7 offset:30720
  v_mfma_f32_16x16x32_bf16 v[104:107], v[32:35], v[228:231], v[104:107]
  v_fma_f32 v13, v13, v12, v12
  v_fma_f32 v14, v14, v12, v12
  ds_read_b64_tr_b16 v[32:33], v8 offset:28672
  v_mfma_f32_16x16x32_bf16 v[100:103], v[36:39], v[156:159], v[100:103]
  v_exp_f32 v16, v16
  ds_read_b64_tr_b16 v[34:35], v8 offset:30720
  v_mfma_f32_16x16x32_bf16 v[108:111], v[36:39], v[228:231], v[108:111]
  v_rcp_f32 v13, v13
  s_mov_b64 exec, 3
  buffer_load_dwordx2 v[18:19], v17, s[16:19], 0 offen sc1
  s_mov_b64 exec, -1
  s_waitcnt lgkmcnt(4)
  ds_read_b64_tr_b16 v[36:37], v7 offset:32768
  v_mfma_f32_16x16x32_bf16 v[96:99], v[40:43], v[160:163], v[96:99]
  v_fma_f32 v15, v15, v12, v12
  v_fma_f32 v16, v16, v12, v12
  ds_read_b64_tr_b16 v[38:39], v7 offset:34816
  v_mfma_f32_16x16x32_bf16 v[104:107], v[40:43], v[232:235], v[104:107]
  v_rcp_f32 v14, v14
  ds_read_b64_tr_b16 v[40:41], v8 offset:32768
  v_mfma_f32_16x16x32_bf16 v[100:103], v[24:27], v[160:163], v[100:103]
  s_add_u32 m0, s35, 73728
  s_add_u32 s45, s36, 221184
  v_rcp_f32 v15, v15
  ds_read_b64_tr_b16 v[42:43], v8 offset:34816
  v_mfma_f32_16x16x32_bf16 v[108:111], v[24:27], v[232:235], v[108:111]
  buffer_load_dwordx4 v2, s[12:15], s45 offen offset:0 lds
  s_waitcnt lgkmcnt(4)
  ds_read_b64_tr_b16 v[24:25], v7 offset:36864
  v_mfma_f32_16x16x32_bf16 v[96:99], v[28:31], v[164:167], v[96:99]
  v_mul_f32 v88, v88, v13
  v_mul_f32 v89, v89, v14
  ds_read_b64_tr_b16 v[26:27], v7 offset:38912
  v_mfma_f32_16x16x32_bf16 v[104:107], v[28:31], v[236:239], v[104:107]
  v_rcp_f32 v16, v16
  ds_read_b64_tr_b16 v[28:29], v8 offset:36864
  v_mfma_f32_16x16x32_bf16 v[100:103], v[32:35], v[164:167], v[100:103]
  s_add_u32 s48, s39, 8192
  buffer_store_dwordx4 v[80:83], v0, s[16:19], s48 offen offset:0 sc1
  ds_read_b64_tr_b16 v[30:31], v8 offset:38912
  v_mfma_f32_16x16x32_bf16 v[108:111], v[32:35], v[236:239], v[108:111]
  v_cvt_pk_bf16_f32 v84, v88, v89
  v_mul_f32 v90, v90, v15
  s_waitcnt lgkmcnt(4)
  ds_read_b64_tr_b16 v[32:33], v7 offset:40960
  v_mfma_f32_16x16x32_bf16 v[96:99], v[36:39], v[168:171], v[96:99]
  v_mul_f32 v91, v91, v16
  v_cvt_pk_bf16_f32 v85, v90, v91
  ds_read_b64_tr_b16 v[34:35], v7 offset:43008
  v_mfma_f32_16x16x32_bf16 v[104:107], v[36:39], v[240:243], v[104:107]
  v_mul_f32 v13, v92, v10
  v_mul_f32 v14, v93, v10
  ds_read_b64_tr_b16 v[36:37], v8 offset:40960
  v_mfma_f32_16x16x32_bf16 v[100:103], v[40:43], v[168:171], v[100:103]
  s_add_u32 m0, s35, 74624
  v_exp_f32 v13, v13
  ds_read_b64_tr_b16 v[38:39], v8 offset:43008
  v_mfma_f32_16x16x32_bf16 v[108:111], v[40:43], v[240:243], v[108:111]
  buffer_load_dwordx4 v2, s[12:15], s45 offen offset:128 lds
  s_waitcnt lgkmcnt(4)
  ds_read_b64_tr_b16 v[40:41], v7 offset:45056
  v_mfma_f32_16x16x32_bf16 v[96:99], v[24:27], v[172:175], v[96:99]
  v_mul_f32 v15, v94, v10
  v_mul_f32 v16, v95, v10
  ds_read_b64_tr_b16 v[42:43], v7 offset:47104
  v_mfma_f32_16x16x32_bf16 v[104:107], v[24:27], v[244:247], v[104:107]
  v_exp_f32 v14, v14
  ds_read_b64_tr_b16 v[24:25], v8 offset:45056
  v_mfma_f32_16x16x32_bf16 v[100:103], v[28:31], v[172:175], v[100:103]
  v_exp_f32 v15, v15
  ds_read_b64_tr_b16 v[26:27], v8 offset:47104
  v_mfma_f32_16x16x32_bf16 v[108:111], v[28:31], v[244:247], v[108:111]
  v_fma_f32 v13, v13, v12, v12
  v_fma_f32 v14, v14, v12, v12
  s_waitcnt lgkmcnt(4)
  ds_read_b64_tr_b16 v[28:29], v20 offset:0
  v_mfma_f32_16x16x32_bf16 v[96:99], v[32:35], v[176:179], v[96:99]
  v_exp_f32 v16, v16
  ds_read_b64_tr_b16 v[30:31], v20 offset:6144
  v_mfma_f32_16x16x32_bf16 v[104:107], v[32:35], v[248:251], v[104:107]
  v_rcp_f32 v13, v13
  ds_read_b64_tr_b16 v[32:33], v21 offset:0
  v_mfma_f32_16x16x32_bf16 v[100:103], v[36:39], v[176:179], v[100:103]
  s_add_u32 m0, s35, 75520
  v_fma_f32 v15, v15, v12, v12
  v_fma_f32 v16, v16, v12, v12
  ds_read_b64_tr_b16 v[34:35], v21 offset:6144
  v_mfma_f32_16x16x32_bf16 v[108:111], v[36:39], v[248:251], v[108:111]
  buffer_load_dwordx4 v2, s[12:15], s45 offen offset:256 lds
  s_waitcnt lgkmcnt(4)
  ds_read_b64_tr_b16 v[36:37], v22 offset:0
  v_mfma_f32_16x16x32_bf16 v[96:99], v[40:43], v[180:183], v[96:99]
  v_rcp_f32 v14, v14
  ds_read_b64_tr_b16 v[38:39], v22 offset:6144
  v_mfma_f32_16x16x32_bf16 v[104:107], v[40:43], v[252:255], v[104:107]
  v_rcp_f32 v15, v15
  ds_read_b64_tr_b16 v[40:41], v23 offset:0
  v_mfma_f32_16x16x32_bf16 v[100:103], v[24:27], v[180:183], v[100:103]
  v_mul_f32 v92, v92, v13
  v_mul_f32 v93, v93, v14
  ds_read_b64_tr_b16 v[42:43], v23 offset:6144
  v_mfma_f32_16x16x32_bf16 v[108:111], v[24:27], v[252:255], v[108:111]
  v_rcp_f32 v16, v16
  s_waitcnt vmcnt(8)
  s_waitcnt vmcnt(4)
  v_subrev_u32 v19, s31, v19
  v_cmp_eq_u32 vcc, s30, v18
  v_subrev_u32 v19, 3, v19
  v_cmp_gt_u32 s[46:47], 13, v19
  s_nop 0
  s_and_b32 s46, s46, vcc_lo
  s_and_b32 s46, s46, 3
  s_cmp_eq_u32 s46, 3
  s_cbranch_scc0 L_slow_r_5
L_back_r_5:
  s_barrier
  v_cvt_pk_bf16_f32 v86, v92, v93
  v_mul_f32 v94, v94, v15
  v_mul_f32 v95, v95, v16
  v_cvt_pk_bf16_f32 v87, v94, v95
  s_waitcnt lgkmcnt(4)
  ds_read_b64_tr_b16 v[24:25], v20 offset:1024
  v_mfma_f32_16x16x32_bf16 v[112:115], v[28:31], v[48:51], 0
  ds_read_b64_tr_b16 v[26:27], v20 offset:7168
  v_mfma_f32_16x16x32_bf16 v[116:119], v[28:31], v[52:55], 0
  ds_read_b64_tr_b16 v[28:29], v21 offset:1024
  v_mfma_f32_16x16x32_bf16 v[120:123], v[32:35], v[48:51], 0
  s_add_u32 m0, s35, 98304
  s_add_u32 s45, s36, 294912
  ds_read_b64_tr_b16 v[30:31], v21 offset:7168
  v_mfma_f32_16x16x32_bf16 v[124:127], v[32:35], v[52:55], 0
  buffer_load_dwordx4 v2, s[12:15], s45 offen offset:0 lds
  s_waitcnt lgkmcnt(4)
  ds_read_b64_tr_b16 v[32:33], v22 offset:1024
  v_mfma_f32_16x16x32_bf16 v[128:131], v[36:39], v[48:51], 0
  v_add_u32 v3, 49152, v20
  v_add_u32 v4, 49152, v21
  ds_read_b64_tr_b16 v[34:35], v22 offset:7168
  v_mfma_f32_16x16x32_bf16 v[132:135], v[36:39], v[52:55], 0
  v_add_u32 v5, 49152, v22
  v_add_u32 v6, 49152, v23
  ds_read_b64_tr_b16 v[36:37], v23 offset:1024
  v_mfma_f32_16x16x32_bf16 v[136:139], v[40:43], v[48:51], 0
  s_add_u32 s44, s40, 0
  buffer_load_dwordx4 v[208:211], v0, s[16:19], s44 offen offset:0 sc1
  ds_read_b64_tr_b16 v[38:39], v23 offset:7168
  v_mfma_f32_16x16x32_bf16 v[140:143], v[40:43], v[52:55], 0
  v_add_u32 v7, 98304, v20
  v_add_u32 v8, 98304, v21
  s_waitcnt lgkmcnt(4)
  ds_read_b64_tr_b16 v[40:41], v20 offset:2048
  v_mfma_f32_16x16x32_bf16 v[144:147], v[24:27], v[48:51], 0
  v_add_u32 v44, 98304, v22
  v_add_u32 v45, 98304, v23
  ds_read_b64_tr_b16 v[42:43], v20 offset:8192
  v_mfma_f32_16x16x32_bf16 v[148:151], v[24:27], v[52:55], 0
  v_mul_f32 v13, v96, v9
  v_mul_f32 v14, v97, v9
  ds_read_b64_tr_b16 v[24:25], v21 offset:2048
  v_mfma_f32_16x16x32_bf16 v[152:155], v[28:31], v[48:51], 0
  s_add_u32 m0, s35, 99200
  v_exp_f32 v13, v13
  ds_read_b64_tr_b16 v[26:27], v21 offset:8192
  v_mfma_f32_16x16x32_bf16 v[156:159], v[28:31], v[52:55], 0
  buffer_load_dwordx4 v2, s[12:15], s45 offen offset:128 lds
  s_waitcnt lgkmcnt(4)
  ds_read_b64_tr_b16 v[28:29], v22 offset:2048
  v_mfma_f32_16x16x32_bf16 v[160:163], v[32:35], v[48:51], 0
  s_add_u32 s48, s39, 8192
  buffer_store_dwordx4 v[84:87], v0, s[16:19], s48 offen offset:1024 sc1
  ds_read_b64_tr_b16 v[30:31], v22 offset:8192
  v_mfma_f32_16x16x32_bf16 v[164:167], v[32:35], v[52:55], 0
  v_mul_f32 v15, v98, v9
  v_mul_f32 v16, v99, v9
  ds_read_b64_tr_b16 v[32:33], v23 offset:2048
  v_mfma_f32_16x16x32_bf16 v[168:171], v[36:39], v[48:51], 0
  buffer_load_dwordx4 v[212:215], v0, s[16:19], s44 offen offset:1024 sc1
  ds_read_b64_tr_b16 v[34:35], v23 offset:8192
  v_mfma_f32_16x16x32_bf16 v[172:175], v[36:39], v[52:55], 0
  v_exp_f32 v14, v14
  s_waitcnt lgkmcnt(4)
  ds_read_b64_tr_b16 v[36:37], v20 offset:24576
  v_mfma_f32_16x16x32_bf16 v[176:179], v[40:43], v[48:51], 0
  v_exp_f32 v15, v15
  ds_read_b64_tr_b16 v[38:39], v20 offset:30720
  v_mfma_f32_16x16x32_bf16 v[180:183], v[40:43], v[52:55], 0
  v_fma_f32 v13, v13, v11, v11
  v_fma_f32 v14, v14, v11, v11
  ds_read_b64_tr_b16 v[40:41], v21 offset:24576
  v_mfma_f32_16x16x32_bf16 v[184:187], v[24:27], v[48:51], 0
  s_add_u32 m0, s35, 100096
  v_exp_f32 v16, v16
  ds_read_b64_tr_b16 v[42:43], v21 offset:30720
  v_mfma_f32_16x16x32_bf16 v[188:191], v[24:27], v[52:55], 0
  buffer_load_dwordx4 v2, s[12:15], s45 offen offset:256 lds
  s_waitcnt lgkmcnt(4)
  ds_read_b64_tr_b16 v[24:25], v22 offset:24576
  v_mfma_f32_16x16x32_bf16 v[192:195], v[28:31], v[48:51], 0
  v_rcp_f32 v13, v13
  ds_read_b64_tr_b16 v[26:27], v22 offset:30720
  v_mfma_f32_16x16x32_bf16 v[196:199], v[28:31], v[52:55], 0
  v_fma_f32 v15, v15, v11, v11
  v_fma_f32 v16, v16, v11, v11
  ds_read_b64_tr_b16 v[28:29], v23 offset:24576
  v_mfma_f32_16x16x32_bf16 v[200:203], v[32:35], v[48:51], 0
  v_rcp_f32 v14, v14
  ds_read_b64_tr_b16 v[30:31], v23 offset:30720
  v_mfma_f32_16x16x32_bf16 v[204:207], v[32:35], v[52:55], 0
  v_rcp_f32 v15, v15
  s_barrier
  s_waitcnt lgkmcnt(4)
  ds_read_b64_tr_b16 v[32:33], v20 offset:25600
  v_mfma_f32_16x16x32_bf16 v[112:115], v[36:39], v[56:59], v[112:115]
  v_mul_f32 v96, v96, v13
  v_mul_f32 v97, v97, v14
  ds_read_b64_tr_b16 v[34:35], v20 offset:31744
  v_mfma_f32_16x16x32_bf16 v[116:119], v[36:39], v[60:63], v[116:119]
  v_rcp_f32 v16, v16
  ds_read_b64_tr_b16 v[36:37], v21 offset:25600
  v_mfma_f32_16x16x32_bf16 v[120:123], v[40:43], v[56:59], v[120:123]
  s_add_u32 m0, s35, 122880
  s_add_u32 s45, s36, 368640
  v_cvt_pk_bf16_f32 v88, v96, v97
  v_mul_f32 v98, v98, v15
  ds_read_b64_tr_b16 v[38:39], v21 offset:31744
  v_mfma_f32_16x16x32_bf16 v[124:127], v[40:43], v[60:63], v[124:127]
  buffer_load_dwordx4 v2, s[12:15], s45 offen offset:0 lds
  s_waitcnt lgkmcnt(4)
  ds_read_b64_tr_b16 v[40:41], v22 offset:25600
  v_mfma_f32_16x16x32_bf16 v[128:131], v[24:27], v[56:59], v[128:131]
  v_mul_f32 v99, v99, v16
  v_cvt_pk_bf16_f32 v89, v98, v99
  ds_read_b64_tr_b16 v[42:43], v22 offset:31744
  v_mfma_f32_16x16x32_bf16 v[132:135], v[24:27], v[60:63], v[132:135]
  v_mul_f32 v13, v100, v9
  v_mul_f32 v14, v101, v9
  ds_read_b64_tr_b16 v[24:25], v23 offset:25600
  v_mfma_f32_16x16x32_bf16 v[136:139], v[28:31], v[56:59], v[136:139]
  s_add_u32 s44, s40, 2048
  buffer_load_dwordx4 v[216:219], v0, s[16:19], s44 offen offset:0 sc1
  ds_read_b64_tr_b16 v[26:27], v23 offset:31744
  v_mfma_f32_16x16x32_bf16 v[140:143], v[28:31], v[60:63], v[140:143]
  v_exp_f32 v13, v13
  s_waitcnt lgkmcnt(4)
  ds_read_b64_tr_b16 v[28:29], v20 offset:26624
  v_mfma_f32_16x16x32_bf16 v[144:147], v[32:35], v[56:59], v[144:147]
  v_mul_f32 v15, v102, v9
  v_mul_f32 v16, v103, v9
  ds_read_b64_tr_b16 v[30:31], v20 offset:32768
  v_mfma_f32_16x16x32_bf16 v[148:151], v[32:35], v[60:63], v[148:151]
  v_exp_f32 v14, v14
  ds_read_b64_tr_b16 v[32:33], v21 offset:26624
  v_mfma_f32_16x16x32_bf16 v[152:155], v[36:39], v[56:59], v[152:155]
  s_add_u32 m0, s35, 123776
  v_exp_f32 v15, v15
  ds_read_b64_tr_b16 v[34:35], v21 offset:32768
  v_mfma_f32_16x16x32_bf16 v[156:159], v[36:39], v[60:63], v[156:159]
  buffer_load_dwordx4 v2, s[12:15], s45 offen offset:128 lds
  s_waitcnt lgkmcnt(4)
  ds_read_b64_tr_b16 v[36:37], v22 offset:26624
  v_mfma_f32_16x16x32_bf16 v[160:163], v[40:43], v[56:59], v[160:163]
  v_fma_f32 v13, v13, v11, v11
  v_fma_f32 v14, v14, v11, v11
  ds_read_b64_tr_b16 v[38:39], v22 offset:32768
  v_mfma_f32_16x16x32_bf16 v[164:167], v[40:43], v[60:63], v[164:167]
  v_exp_f32 v16, v16
  ds_read_b64_tr_b16 v[40:41], v23 offset:26624
  v_mfma_f32_16x16x32_bf16 v[168:171], v[24:27], v[56:59], v[168:171]
  buffer_load_dwordx4 v[220:223], v0, s[16:19], s44 offen offset:1024 sc1
  ds_read_b64_tr_b16 v[42:43], v23 offset:32768
  v_mfma_f32_16x16x32_bf16 v[172:175], v[24:27], v[60:63], v[172:175]
  v_rcp_f32 v13, v13
  s_waitcnt lgkmcnt(4)
  ds_read_b64_tr_b16 v[24:25], v3 offset:0
  v_mfma_f32_16x16x32_bf16 v[176:179], v[28:31], v[56:59], v[176:179]
  v_fma_f32 v15, v15, v11, v11
  v_fma_f32 v16, v16, v11, v11
  ds_read_b64_tr_b16 v[26:27], v3 offset:6144
  v_mfma_f32_16x16x32_bf16 v[180:183], v[28:31], v[60:63], v[180:183]
  v_rcp_f32 v14, v14
  ds_read_b64_tr_b16 v[28:29], v4 offset:0
  v_mfma_f32_16x16x32_bf16 v[184:187], v[32:35], v[56:59], v[184:187]
  s_add_u32 m0, s35, 124672
  v_rcp_f32 v15, v15
  ds_read_b64_tr_b16 v[30:31], v4 offset:6144
  v_mfma_f32_16x16x32_bf16 v[188:191], v[32:35], v[60:63], v[188:191]
  buffer_load_dwordx4 v2, s[12:15], s45 offen offset:256 lds
  s_waitcnt lgkmcnt(4)
  ds_read_b64_tr_b16 v[32:33], v5 offset:0
  v_mfma_f32_16x16x32_bf16 v[192:195], v[36:39], v[56:59], v[192:195]
  v_mul_f32 v100, v100, v13
  v_mul_f32 v101, v101, v14
  ds_read_b64_tr_b16 v[34:35], v5 offset:6144
  v_mfma_f32_16x16x32_bf16 v[196:199], v[36:39], v[60:63], v[196:199]
  v_rcp_f32 v16, v16
  ds_read_b64_tr_b16 v[36:37], v6 offset:0
  v_mfma_f32_16x16x32_bf16 v[200:203], v[40:43], v[56:59], v[200:203]
  v_cvt_pk_bf16_f32 v90, v100, v101
  v_mul_f32 v102, v102, v15
  ds_read_b64_tr_b16 v[38:39], v6 offset:6144
  v_mfma_f32_16x16x32_bf16 v[204:207], v[40:43], v[60:63], v[204:207]
  v_mul_f32 v103, v103, v16
  v_cvt_pk_bf16_f32 v91, v102, v103
  s_waitcnt vmcnt(11)
  s_barrier
  s_waitcnt lgkmcnt(4)
  ds_read_b64_tr_b16 v[40:41], v3 offset:1024
  v_mfma_f32_16x16x32_bf16 v[112:115], v[24:27], v[64:67], v[112:115]
  v_mul_f32 v13, v104, v10
  v_mul_f32 v14, v105, v10
  ds_read_b64_tr_b16 v[42:43], v3 offset:7168
  v_mfma_f32_16x16x32_bf16 v[116:119], v[24:27], v[68:71], v[116:119]
  v_exp_f32 v13, v13
  ds_read_b64_tr_b16 v[24:25], v4 offset:1024
  v_mfma_f32_16x16x32_bf16 v[120:123], v[28:31], v[64:67], v[120:123]
  s_add_u32 m0, s35, 0
  s_add_u32 s49, s37, 0
  buffer_load_dwordx4 v2, s[12:15], s49 offen offset:0 lds
  ds_read_b64_tr_b16 v[26:27], v4 offset:7168
  v_mfma_f32_16x16x32_bf16 v[124:127], v[28:31], v[68:71], v[124:127]
  v_mul_f32 v15, v106, v10
  v_mul_f32 v16, v107, v10
  s_waitcnt lgkmcnt(4)
  ds_read_b64_tr_b16 v[28:29], v5 offset:1024
  v_mfma_f32_16x16x32_bf16 v[128:131], v[32:35], v[64:67], v[128:131]
  v_exp_f32 v14, v14
  ds_read_b64_tr_b16 v[30:31], v5 offset:7168
  v_mfma_f32_16x16x32_bf16 v[132:135], v[32:35], v[68:71], v[132:135]
  v_exp_f32 v15, v15
  ds_read_b64_tr_b16 v[32:33], v6 offset:1024
  v_mfma_f32_16x16x32_bf16 v[136:139], v[36:39], v[64:67], v[136:139]
  s_add_u32 s44, s40, 4096
  buffer_load_dwordx4 v[224:227], v0, s[16:19], s44 offen offset:0 sc1
  ds_read_b64_tr_b16 v[34:35], v6 offset:7168
  v_mfma_f32_16x16x32_bf16 v[140:143], v[36:39], v[68:71], v[140:143]
  v_fma_f32 v13, v13, v12, v12
  v_fma_f32 v14, v14, v12, v12
  s_waitcnt lgkmcnt(4)
  ds_read_b64_tr_b16 v[36:37], v3 offset:2048
  v_mfma_f32_16x16x32_bf16 v[144:147], v[40:43], v[64:67], v[144:147]
  v_exp_f32 v16, v16
  ds_read_b64_tr_b16 v[38:39], v3 offset:8192
  v_mfma_f32_16x16x32_bf16 v[148:151], v[40:43], v[68:71], v[148:151]
  v_rcp_f32 v13, v13
  ds_read_b64_tr_b16 v[40:41], v4 offset:2048
  v_mfma_f32_16x16x32_bf16 v[152:155], v[24:27], v[64:67], v[152:155]
  s_add_u32 s49, s37, 72704
  buffer_load_dwordx4 v2, s[12:15], s49 offen offset:1024 lds
  ds_read_b64_tr_b16 v[42:43], v4 offset:8192
  v_mfma_f32_16x16x32_bf16 v[156:159], v[24:27], v[68:71], v[156:159]
  v_fma_f32 v15, v15, v12, v12
  v_fma_f32 v16, v16, v12, v12
  s_waitcnt lgkmcnt(4)
  ds_read_b64_tr_b16 v[24:25], v5 offset:2048
  v_mfma_f32_16x16x32_bf16 v[160:163], v[28:31], v[64:67], v[160:163]
  s_add_u32 s48, s39, 10240
  buffer_store_dwordx4 v[88:91], v0, s[16:19], s48 offen offset:0 sc1
  ds_read_b64_tr_b16 v[26:27], v5 offset:8192
  v_mfma_f32_16x16x32_bf16 v[164:167], v[28:31], v[68:71], v[164:167]
  v_rcp_f32 v14, v14
  ds_read_b64_tr_b16 v[28:29], v6 offset:2048
  v_mfma_f32_16x16x32_bf16 v[168:171], v[32:35], v[64:67], v[168:171]
  buffer_load_dwordx4 v[228:231], v0, s[16:19], s44 offen offset:1024 sc1
  ds_read_b64_tr_b16 v[30:31], v6 offset:8192
  v_mfma_f32_16x16x32_bf16 v[172:175], v[32:35], v[68:71], v[172:175]
  v_rcp_f32 v15, v15
  s_waitcnt lgkmcnt(4)
  ds_read_b64_tr_b16 v[32:33], v3 offset:24576
  v_mfma_f32_16x16x32_bf16 v[176:179], v[36:39], v[64:67], v[176:179]
  v_mul_f32 v104, v104, v13
  v_mul_f32 v105, v105, v14
  ds_read_b64_tr_b16 v[34:35], v3 offset:30720
  v_mfma_f32_16x16x32_bf16 v[180:183], v[36:39], v[68:71], v[180:183]
  v_rcp_f32 v16, v16
  ds_read_b64_tr_b16 v[36:37], v4 offset:24576
  v_mfma_f32_16x16x32_bf16 v[184:187], v[40:43], v[64:67], v[184:187]
  s_add_u32 s49, s37, 145408
  buffer_load_dwordx4 v2, s[12:15], s49 offen offset:2048 lds
  ds_read_b64_tr_b16 v[38:39], v4 offset:30720
  v_mfma_f32_16x16x32_bf16 v[188:191], v[40:43], v[68:71], v[188:191]
  v_cvt_pk_bf16_f32 v92, v104, v105
  v_mul_f32 v106, v106, v15
  s_waitcnt lgkmcnt(4)
  ds_read_b64_tr_b16 v[40:41], v5 offset:24576
  v_mfma_f32_16x16x32_bf16 v[192:195], v[24:27], v[64:67], v[192:195]
  v_mul_f32 v107, v107, v16
  v_cvt_pk_bf16_f32 v93, v106, v107
  ds_read_b64_tr_b16 v[42:43], v5 offset:30720
  v_mfma_f32_16x16x32_bf16 v[196:199], v[24:27], v[68:71], v[196:199]
  v_mul_f32 v13, v108, v10
  v_mul_f32 v14, v109, v10
  ds_read_b64_tr_b16 v[24:25], v6 offset:24576
  v_mfma_f32_16x16x32_bf16 v[200:203], v[28:31], v[64:67], v[200:203]
  v_exp_f32 v13, v13
  ds_read_b64_tr_b16 v[26:27], v6 offset:30720
  v_mfma_f32_16x16x32_bf16 v[204:207], v[28:31], v[68:71], v[204:207]
  v_mul_f32 v15, v110, v10
  v_mul_f32 v16, v111, v10
  s_waitcnt vmcnt(11)
  s_add_u32 s48, s31, 5
  v_mov_b32 v18, s30
  v_mov_b32 v19, s48
  s_mov_b64 exec, 1
  buffer_store_dwordx2 v[18:19], v0, s[16:19], s55 offen sc1
  s_mov_b64 exec, -1
  s_barrier
  s_waitcnt lgkmcnt(4)
  ds_read_b64_tr_b16 v[28:29], v3 offset:25600
  v_mfma_f32_16x16x32_bf16 v[112:115], v[32:35], v[72:75], v[112:115]
  s_add_u32 s44, s41, 0
  buffer_load_dwordx4 v[232:235], v0, s[16:19], s44 offen offset:0 sc1
  ds_read_b64_tr_b16 v[30:31], v3 offset:31744
  v_mfma_f32_16x16x32_bf16 v[116:119], v[32:35], v[76:79], v[116:119]
  v_exp_f32 v14, v14
  ds_read_b64_tr_b16 v[32:33], v4 offset:25600
  v_mfma_f32_16x16x32_bf16 v[120:123], v[36:39], v[72:75], v[120:123]
  s_add_u32 m0, s35, 24576
  s_add_u32 s49, s37, 128
  buffer_load_dwordx4 v2, s[12:15], s49 offen offset:0 lds
  ds_read_b64_tr_b16 v[34:35], v4 offset:31744
  v_mfma_f32_16x16x32_bf16 v[124:127], v[36:39], v[76:79], v[124:127]
  v_exp_f32 v15, v15
  s_waitcnt lgkmcnt(4)
  ds_read_b64_tr_b16 v[36:37], v5 offset:25600
  v_mfma_f32_16x16x32_bf16 v[128:131], v[40:43], v[72:75], v[128:131]
  v_fma_f32 v13, v13, v12, v12
  v_fma_f32 v14, v14, v12, v12
  ds_read_b64_tr_b16 v[38:39], v5 offset:31744
  v_mfma_f32_16x16x32_bf16 v[132:135], v[40:43], v[76:79], v[132:135]
  v_exp_f32 v16, v16
  ds_read_b64_tr_b16 v[40:41], v6 offset:25600
  v_mfma_f32_16x16x32_bf16 v[136:139], v[24:27], v[72:75], v[136:139]
  buffer_load_dwordx4 v[236:239], v0, s[16:19], s44 offen offset:1024 sc1
  ds_read_b64_tr_b16 v[42:43], v6 offset:31744
  v_mfma_f32_16x16x32_bf16 v[140:143], v[24:27], v[76:79], v[140:143]
  v_rcp_f32 v13, v13
  s_waitcnt lgkmcnt(4)
  ds_read_b64_tr_b16 v[24:25], v3 offset:26624
  v_mfma_f32_16x16x32_bf16 v[144:147], v[28:31], v[72:75], v[144:147]
  v_fma_f32 v15, v15, v12, v12
  v_fma_f32 v16, v16, v12, v12
  ds_read_b64_tr_b16 v[26:27], v3 offset:32768
  v_mfma_f32_16x16x32_bf16 v[148:151], v[28:31], v[76:79], v[148:151]
  v_rcp_f32 v14, v14
  ds_read_b64_tr_b16 v[28:29], v4 offset:26624
  v_mfma_f32_16x16x32_bf16 v[152:155], v[32:35], v[72:75], v[152:155]
  s_add_u32 s49, s37, 72832
  buffer_load_dwordx4 v2, s[12:15], s49 offen offset:1024 lds
  ds_read_b64_tr_b16 v[30:31], v4 offset:32768
  v_mfma_f32_16x16x32_bf16 v[156:159], v[32:35], v[76:79], v[156:159]
  v_rcp_f32 v15, v15
  s_waitcnt lgkmcnt(4)
  ds_read_b64_tr_b16 v[32:33], v5 offset:26624
  v_mfma_f32_16x16x32_bf16 v[160:163], v[36:39], v[72:75], v[160:163]
  v_mul_f32 v108, v108, v13
  v_mul_f32 v109, v109, v14
  ds_read_b64_tr_b16 v[34:35], v5 offset:32768
  v_mfma_f32_16x16x32_bf16 v[164:167], v[36:39], v[76:79], v[164:167]
  v_rcp_f32 v16, v16
  ds_read_b64_tr_b16 v[36:37], v6 offset:26624
  v_mfma_f32_16x16x32_bf16 v[168:171], v[40:43], v[72:75], v[168:171]
  s_add_u32 s44, s41, 2048
  buffer_load_dwordx4 v[240:243], v0, s[16:19], s44 offen offset:0 sc1
  ds_read_b64_tr_b16 v[38:39], v6 offset:32768
  v_mfma_f32_16x16x32_bf16 v[172:175], v[40:43], v[76:79], v[172:175]
  v_cvt_pk_bf16_f32 v94, v108, v109
  v_mul_f32 v110, v110, v15
  s_waitcnt lgkmcnt(4)
  ds_read_b64_tr_b16 v[40:41], v7 offset:0
  v_mfma_f32_16x16x32_bf16 v[176:179], v[24:27], v[72:75], v[176:179]
  v_mul_f32 v111, v111, v16
  v_cvt_pk_bf16_f32 v95, v110, v111
  ds_read_b64_tr_b16 v[42:43], v7 offset:6144
  v_mfma_f32_16x16x32_bf16 v[180:183], v[24:27], v[76:79], v[180:183]
  ds_read_b64_tr_b16 v[24:25], v8 offset:0
  v_mfma_f32_16x16x32_bf16 v[184:187], v[28:31], v[72:75], v[184:187]
  s_add_u32 s49, s37, 145536
  buffer_load_dwordx4 v2, s[12:15], s49 offen offset:2048 lds
  ds_read_b64_tr_b16 v[26:27], v8 offset:6144
  v_mfma_f32_16x16x32_bf16 v[188:191], v[28:31], v[76:79], v[188:191]
  s_waitcnt lgkmcnt(4)
  ds_read_b64_tr_b16 v[28:29], v44 offset:0
  v_mfma_f32_16x16x32_bf16 v[192:195], v[32:35], v[72:75], v[192:195]
  ds_read_b64_tr_b16 v[30:31], v44 offset:6144
  v_mfma_f32_16x16x32_bf16 v[196:199], v[32:35], v[76:79], v[196:199]
  ds_read_b64_tr_b16 v[32:33], v45 offset:0
  v_mfma_f32_16x16x32_bf16 v[200:203], v[36:39], v[72:75], v[200:203]
  s_add_u32 s48, s39, 10240
  buffer_store_dwordx4 v[92:95], v0, s[16:19], s48 offen offset:1024 sc1
  ds_read_b64_tr_b16 v[34:35], v45 offset:6144
  v_mfma_f32_16x16x32_bf16 v[204:207], v[36:39], v[76:79], v[204:207]
  s_waitcnt vmcnt(14)
  s_barrier
  s_waitcnt lgkmcnt(4)
  ds_read_b64_tr_b16 v[36:37], v7 offset:1024
  v_mfma_f32_16x16x32_bf16 v[112:115], v[40:43], v[80:83], v[112:115]
  buffer_load_dwordx4 v[244:247], v0, s[16:19], s44 offen offset:1024 sc1
  ds_read_b64_tr_b16 v[38:39], v7 offset:7168
  v_mfma_f32_16x16x32_bf16 v[116:119], v[40:43], v[84:87], v[116:119]
  ds_read_b64_tr_b16 v[40:41], v8 offset:1024
  v_mfma_f32_16x16x32_bf16 v[120:123], v[24:27], v[80:83], v[120:123]
  s_add_u32 m0, s35, 49152
  s_add_u32 s49, s38, 0
  buffer_load_dwordx4 v2, s[12:15], s49 offen offset:0 lds
  ds_read_b64_tr_b16 v[42:43], v8 offset:7168
  v_mfma_f32_16x16x32_bf16 v[124:127], v[24:27], v[84:87], v[124:127]
  s_waitcnt lgkmcnt(4)
  ds_read_b64_tr_b16 v[24:25], v44 offset:1024
  v_mfma_f32_16x16x32_bf16 v[128:131], v[28:31], v[80:83], v[128:131]
  ds_read_b64_tr_b16 v[26:27], v44 offset:7168
  v_mfma_f32_16x16x32_bf16 v[132:135], v[28:31], v[84:87], v[132:135]
  ds_read_b64_tr_b16 v[28:29], v45 offset:1024
  v_mfma_f32_16x16x32_bf16 v[136:139], v[32:35], v[80:83], v[136:139]
  s_add_u32 s44, s41, 4096
  buffer_load_dwordx4 v[248:251], v0, s[16:19], s44 offen offset:0 sc1
  ds_read_b64_tr_b16 v[30:31], v45 offset:7168
  v_mfma_f32_16x16x32_bf16 v[140:143], v[32:35], v[84:87], v[140:143]
  s_waitcnt lgkmcnt(4)
  ds_read_b64_tr_b16 v[32:33], v7 offset:2048
  v_mfma_f32_16x16x32_bf16 v[144:147], v[36:39], v[80:83], v[144:147]
  ds_read_b64_tr_b16 v[34:35], v7 offset:8192
  v_mfma_f32_16x16x32_bf16 v[148:151], v[36:39], v[84:87], v[148:151]
  ds_read_b64_tr_b16 v[36:37], v8 offset:2048
  v_mfma_f32_16x16x32_bf16 v[152:155], v[40:43], v[80:83], v[152:155]
  s_add_u32 s49, s38, 72704
  buffer_load_dwordx4 v2, s[12:15], s49 offen offset:1024 lds
  ds_read_b64_tr_b16 v[38:39], v8 offset:8192
  v_mfma_f32_16x16x32_bf16 v[156:159], v[40:43], v[84:87], v[156:159]
  s_waitcnt lgkmcnt(4)
  ds_read_b64_tr_b16 v[40:41], v44 offset:2048
  v_mfma_f32_16x16x32_bf16 v[160:163], v[24:27], v[80:83], v[160:163]
  ds_read_b64_tr_b16 v[42:43], v44 offset:8192
  v_mfma_f32_16x16x32_bf16 v[164:167], v[24:27], v[84:87], v[164:167]
  ds_read_b64_tr_b16 v[24:25], v45 offset:2048
  v_mfma_f32_16x16x32_bf16 v[168:171], v[28:31], v[80:83], v[168:171]
  buffer_load_dwordx4 v[252:255], v0, s[16:19], s44 offen offset:1024 sc1
  ds_read_b64_tr_b16 v[26:27], v45 offset:8192
  v_mfma_f32_16x16x32_bf16 v[172:175], v[28:31], v[84:87], v[172:175]
  s_waitcnt lgkmcnt(4)
  ds_read_b64_tr_b16 v[28:29], v7 offset:24576
  v_mfma_f32_16x16x32_bf16 v[176:179], v[32:35], v[80:83], v[176:179]
  ds_read_b64_tr_b16 v[30:31], v7 offset:30720
  v_mfma_f32_16x16x32_bf16 v[180:183], v[32:35], v[84:87], v[180:183]
  ds_read_b64_tr_b16 v[32:33], v8 offset:24576
  v_mfma_f32_16x16x32_bf16 v[184:187], v[36:39], v[80:83], v[184:187]
  s_add_u32 s49, s38, 145408
  buffer_load_dwordx4 v2, s[12:15], s49 offen offset:2048 lds
  ds_read_b64_tr_b16 v[34:35], v8 offset:30720
  v_mfma_f32_16x16x32_bf16 v[188:191], v[36:39], v[84:87], v[188:191]
  s_waitcnt lgkmcnt(4)
  ds_read_b64_tr_b16 v[36:37], v44 offset:24576
  v_mfma_f32_16x16x32_bf16 v[192:195], v[40:43], v[80:83], v[192:195]
  ds_read_b64_tr_b16 v[38:39], v44 offset:30720
  v_mfma_f32_16x16x32_bf16 v[196:199], v[40:43], v[84:87], v[196:199]
  ds_read_b64_tr_b16 v[40:41], v45 offset:24576
  v_mfma_f32_16x16x32_bf16 v[200:203], v[24:27], v[80:83], v[200:203]
  ds_read_b64_tr_b16 v[42:43], v45 offset:30720
  v_mfma_f32_16x16x32_bf16 v[204:207], v[24:27], v[84:87], v[204:207]
  s_waitcnt vmcnt(14)
  s_barrier
  s_mov_b64 exec, 3
  buffer_load_dwordx2 v[18:19], v17, s[16:19], 0 offen sc1
  s_mov_b64 exec, -1
  s_waitcnt lgkmcnt(4)
  ds_read_b64_tr_b16 v[24:25], v7 offset:25600
  v_mfma_f32_16x16x32_bf16 v[112:115], v[28:31], v[88:91], v[112:115]
  ds_read_b64_tr_b16 v[26:27], v7 offset:31744
  v_mfma_f32_16x16x32_bf16 v[116:119], v[28:31], v[92:95], v[116:119]
  ds_read_b64_tr_b16 v[28:29], v8 offset:25600
  v_mfma_f32_16x16x32_bf16 v[120:123], v[32:35], v[88:91], v[120:123]
  s_add_u32 m0, s35, 73728
  s_add_u32 s49, s38, 128
  buffer_load_dwordx4 v2, s[12:15], s49 offen offset:0 lds
  ds_read_b64_tr_b16 v[30:31], v8 offset:31744
  v_mfma_f32_16x16x32_bf16 v[124:127], v[32:35], v[92:95], v[124:127]
  s_waitcnt lgkmcnt(4)
  ds_read_b64_tr_b16 v[32:33], v44 offset:25600
  v_mfma_f32_16x16x32_bf16 v[128:131], v[36:39], v[88:91], v[128:131]
  ds_read_b64_tr_b16 v[34:35], v44 offset:31744
  v_mfma_f32_16x16x32_bf16 v[132:135], v[36:39], v[92:95], v[132:135]
  ds_read_b64_tr_b16 v[36:37], v45 offset:25600
  v_mfma_f32_16x16x32_bf16 v[136:139], v[40:43], v[88:91], v[136:139]
  ds_read_b64_tr_b16 v[38:39], v45 offset:31744
  v_mfma_f32_16x16x32_bf16 v[140:143], v[40:43], v[92:95], v[140:143]
  s_waitcnt lgkmcnt(4)
  ds_read_b64_tr_b16 v[40:41], v7 offset:26624
  v_mfma_f32_16x16x32_bf16 v[144:147], v[24:27], v[88:91], v[144:147]
  ds_read_b64_tr_b16 v[42:43], v7 offset:32768
  v_mfma_f32_16x16x32_bf16 v[148:151], v[24:27], v[92:95], v[148:151]
  ds_read_b64_tr_b16 v[24:25], v8 offset:26624
  v_mfma_f32_16x16x32_bf16 v[152:155], v[28:31], v[88:91], v[152:155]
  s_add_u32 s49, s38, 72832
  buffer_load_dwordx4 v2, s[12:15], s49 offen offset:1024 lds
  ds_read_b64_tr_b16 v[26:27], v8 offset:32768
  v_mfma_f32_16x16x32_bf16 v[156:159], v[28:31], v[92:95], v[156:159]
  s_waitcnt lgkmcnt(4)
  ds_read_b64_tr_b16 v[28:29], v44 offset:26624
  v_mfma_f32_16x16x32_bf16 v[160:163], v[32:35], v[88:91], v[160:163]
  ds_read_b64_tr_b16 v[30:31], v44 offset:32768
  v_mfma_f32_16x16x32_bf16 v[164:167], v[32:35], v[92:95], v[164:167]
  ds_read_b64_tr_b16 v[32:33], v45 offset:26624
  v_mfma_f32_16x16x32_bf16 v[168:171], v[36:39], v[88:91], v[168:171]
  ds_read_b64_tr_b16 v[34:35], v45 offset:32768
  v_mfma_f32_16x16x32_bf16 v[172:175], v[36:39], v[92:95], v[172:175]
  s_waitcnt lgkmcnt(4)
  ds_read_b64_tr_b16 v[36:37], v20 offset:0
  v_mfma_f32_16x16x32_bf16 v[176:179], v[40:43], v[88:91], v[176:179]
  ds_read_b64_tr_b16 v[38:39], v20 offset:6144
  v_mfma_f32_16x16x32_bf16 v[180:183], v[40:43], v[92:95], v[180:183]
  ds_read_b64_tr_b16 v[40:41], v21 offset:0
  v_mfma_f32_16x16x32_bf16 v[184:187], v[24:27], v[88:91], v[184:187]
  s_add_u32 s49, s38, 145536
  buffer_load_dwordx4 v2, s[12:15], s49 offen offset:2048 lds
  ds_read_b64_tr_b16 v[42:43], v21 offset:6144
  v_mfma_f32_16x16x32_bf16 v[188:191], v[24:27], v[92:95], v[188:191]
  s_waitcnt lgkmcnt(4)
  ds_read_b64_tr_b16 v[24:25], v22 offset:0
  v_mfma_f32_16x16x32_bf16 v[192:195], v[28:31], v[88:91], v[192:195]
  ds_read_b64_tr_b16 v[26:27], v22 offset:6144
  v_mfma_f32_16x16x32_bf16 v[196:199], v[28:31], v[92:95], v[196:199]
  ds_read_b64_tr_b16 v[28:29], v23 offset:0
  v_mfma_f32_16x16x32_bf16 v[200:203], v[32:35], v[88:91], v[200:203]
  ds_read_b64_tr_b16 v[30:31], v23 offset:6144
  v_mfma_f32_16x16x32_bf16 v[204:207], v[32:35], v[92:95], v[204:207]
  s_waitcnt vmcnt(11)
  s_waitcnt vmcnt(3)
  v_subrev_u32 v19, s31, v19
  v_cmp_eq_u32 vcc, s30, v18
  v_subrev_u32 v19, 5, v19
  v_cmp_gt_u32 s[46:47], 11, v19
  s_nop 0
  s_and_b32 s46, s46, vcc_lo
  s_and_b32 s46, s46, 3
  s_cmp_eq_u32 s46, 3
  s_cbranch_scc0 L_slow_r_6
L_back_r_6:
  s_add_u32 s48, s31, 6
  v_mov_b32 v18, s30
  v_mov_b32 v19, s48
  s_mov_b64 exec, 1
  buffer_store_dwordx2 v[18:19], v0, s[16:19], s55 offen sc1
  s_mov_b64 exec, -1
  s_barrier
  s_waitcnt lgkmcnt(4)
  ds_read_b64_tr_b16 v[32:33], v20 offset:1024
  v_mfma_f32_16x16x32_bf16 v[112:115], v[36:39], v[208:211], v[112:115]
  s_add_u32 s44, s40, 6144
  buffer_load_dwordx4 v[48:51], v0, s[16:19], s44 offen offset:0 sc1
  ds_read_b64_tr_b16 v[34:35], v20 offset:7168
  v_mfma_f32_16x16x32_bf16 v[116:119], v[36:39], v[212:215], v[116:119]
  ds_read_b64_tr_b16 v[36:37], v21 offset:1024
  v_mfma_f32_16x16x32_bf16 v[120:123], v[40:43], v[208:211], v[120:123]
  s_add_u32 m0, s35, 98304
  s_add_u32 s49, s37, 221184
  buffer_load_dwordx4 v2, s[12:15], s49 offen offset:0 lds
  ds_read_b64_tr_b16 v[38:39], v21 offset:7168
  v_mfma_f32_16x16x32_bf16 v[124:127], v[40:43], v[212:215], v[124:127]
  s_waitcnt lgkmcnt(4)
  ds_read_b64_tr_b16 v[40:41], v22 offset:1024
  v_mfma_f32_16x16x32_bf16 v[128:131], v[24:27], v[208:211], v[128:131]
  ds_read_b64_tr_b16 v[42:43], v22 offset:7168
  v_mfma_f32_16x16x32_bf16 v[132:135], v[24:27], v[212:215], v[132:135]
  ds_read_b64_tr_b16 v[24:25], v23 offset:1024
  v_mfma_f32_16x16x32_bf16 v[136:139], v[28:31], v[208:211], v[136:139]
  buffer_load_dwordx4 v[52:55], v0, s[16:19], s44 offen offset:1024 sc1
  ds_read_b64_tr_b16 v[26:27], v23 offset:7168
  v_mfma_f32_16x16x32_bf16 v[140:143], v[28:31], v[212:215], v[140:143]
  s_waitcnt lgkmcnt(4)
  ds_read_b64_tr_b16 v[28:29], v20 offset:2048
  v_mfma_f32_16x16x32_bf16 v[112:115], v[32:35], v[216:219], v[112:115]
  ds_read_b64_tr_b16 v[30:31], v20 offset:8192
  v_mfma_f32_16x16x32_bf16 v[116:119], v[32:35], v[220:223], v[116:119]
  ds_read_b64_tr_b16 v[32:33], v21 offset:2048
  v_mfma_f32_16x16x32_bf16 v[120:123], v[36:39], v[216:219], v[120:123]
  s_add_u32 s49, s37, 293888
  buffer_load_dwordx4 v2, s[12:15], s49 offen offset:1024 lds
  ds_read_b64_tr_b16 v[34:35], v21 offset:8192
  v_mfma_f32_16x16x32_bf16 v[124:127], v[36:39], v[220:223], v[124:127]
  s_waitcnt lgkmcnt(4)
  ds_read_b64_tr_b16 v[36:37], v22 offset:2048
  v_mfma_f32_16x16x32_bf16 v[128:131], v[40:43], v[216:219], v[128:131]
  ds_read_b64_tr_b16 v[38:39], v22 offset:8192
  v_mfma_f32_16x16x32_bf16 v[132:135], v[40:43], v[220:223], v[132:135]
  ds_read_b64_tr_b16 v[40:41], v23 offset:2048
  v_mfma_f32_16x16x32_bf16 v[136:139], v[24:27], v[216:219], v[136:139]
  s_add_u32 s44, s40, 8192
  buffer_load_dwordx4 v[56:59], v0, s[16:19], s44 offen offset:0 sc1
  ds_read_b64_tr_b16 v[42:43], v23 offset:8192
  v_mfma_f32_16x16x32_bf16 v[140:143], v[24:27], v[220:223], v[140:143]
  s_waitcnt lgkmcnt(4)
  ds_read_b64_tr_b16 v[24:25], v20 offset:24576
  v_mfma_f32_16x16x32_bf16 v[112:115], v[28:31], v[224:227], v[112:115]
  ds_read_b64_tr_b16 v[26:27], v20 offset:30720
  v_mfma_f32_16x16x32_bf16 v[116:119], v[28:31], v[228:231], v[116:119]
  ds_read_b64_tr_b16 v[28:29], v21 offset:24576
  v_mfma_f32_16x16x32_bf16 v[120:123], v[32:35], v[224:227], v[120:123]
  s_add_u32 s49, s38, 219136
  buffer_load_dwordx4 v2, s[12:15], s49 offen offset:2048 lds
  ds_read_b64_tr_b16 v[30:31], v21 offset:30720
  v_mfma_f32_16x16x32_bf16 v[124:127], v[32:35], v[228:231], v[124:127]
  s_waitcnt lgkmcnt(4)
  ds_read_b64_tr_b16 v[32:33], v22 offset:24576
  v_mfma_f32_16x16x32_bf16 v[128:131], v[36:39], v[224:227], v[128:131]
  ds_read_b64_tr_b16 v[34:35], v22 offset:30720
  v_mfma_f32_16x16x32_bf16 v[132:135], v[36:39], v[228:231], v[132:135]
  ds_read_b64_tr_b16 v[36:37], v23 offset:24576
  v_mfma_f32_16x16x32_bf16 v[136:139], v[40:43], v[224:227], v[136:139]
  ds_read_b64_tr_b16 v[38:39], v23 offset:30720
  v_mfma_f32_16x16x32_bf16 v[140:143], v[40:43], v[228:231], v[140:143]
  s_barrier
  s_waitcnt lgkmcnt(4)
  ds_read_b64_tr_b16 v[40:41], v20 offset:25600
  v_mfma_f32_16x16x32_bf16 v[144:147], v[24:27], v[208:211], v[144:147]
  buffer_load_dwordx4 v[60:63], v0, s[16:19], s44 offen offset:1024 sc1
  ds_read_b64_tr_b16 v[42:43], v20 offset:31744
  v_mfma_f32_16x16x32_bf16 v[148:151], v[24:27], v[212:215], v[148:151]
  ds_read_b64_tr_b16 v[24:25], v21 offset:25600
  v_mfma_f32_16x16x32_bf16 v[152:155], v[28:31], v[208:211], v[152:155]
  s_add_u32 m0, s35, 122880
  s_add_u32 s49, s38, 294912
  buffer_load_dwordx4 v2, s[12:15], s49 offen offset:0 lds
  ds_read_b64_tr_b16 v[26:27], v21 offset:31744
  v_mfma_f32_16x16x32_bf16 v[156:159], v[28:31], v[212:215], v[156:159]
  s_waitcnt lgkmcnt(4)
  ds_read_b64_tr_b16 v[28:29], v22 offset:25600
  v_mfma_f32_16x16x32_bf16 v[160:163], v[32:35], v[208:211], v[160:163]
  ds_read_b64_tr_b16 v[30:31], v22 offset:31744
  v_mfma_f32_16x16x32_bf16 v[164:167], v[32:35], v[212:215], v[164:167]
  ds_read_b64_tr_b16 v[32:33], v23 offset:25600
  v_mfma_f32_16x16x32_bf16 v[168:171], v[36:39], v[208:211], v[168:171]
  s_add_u32 s44, s41, 6144
  buffer_load_dwordx4 v[64:67], v0, s[16:19], s44 offen offset:0 sc1
  ds_read_b64_tr_b16 v[34:35], v23 offset:31744
  v_mfma_f32_16x16x32_bf16 v[172:175], v[36:39], v[212:215], v[172:175]
  s_waitcnt lgkmcnt(4)
  ds_read_b64_tr_b16 v[36:37], v20 offset:26624
  v_mfma_f32_16x16x32_bf16 v[144:147], v[40:43], v[216:219], v[144:147]
  ds_read_b64_tr_b16 v[38:39], v20 offset:32768
  v_mfma_f32_16x16x32_bf16 v[148:151], v[40:43], v[220:223], v[148:151]
  ds_read_b64_tr_b16 v[40:41], v21 offset:26624
  v_mfma_f32_16x16x32_bf16 v[152:155], v[24:27], v[216:219], v[152:155]
  s_add_u32 s49, s37, 367616
  buffer_load_dwordx4 v2, s[12:15], s49 offen offset:1024 lds
  ds_read_b64_tr_b16 v[42:43], v21 offset:32768
  v_mfma_f32_16x16x32_bf16 v[156:159], v[24:27], v[220:223], v[156:159]
  s_waitcnt lgkmcnt(4)
  ds_read_b64_tr_b16 v[24:25], v22 offset:26624
  v_mfma_f32_16x16x32_bf16 v[160:163], v[28:31], v[216:219], v[160:163]
  ds_read_b64_tr_b16 v[26:27], v22 offset:32768
  v_mfma_f32_16x16x32_bf16 v[164:167], v[28:31], v[220:223], v[164:167]
  ds_read_b64_tr_b16 v[28:29], v23 offset:26624
  v_mfma_f32_16x16x32_bf16 v[168:171], v[32:35], v[216:219], v[168:171]
  buffer_load_dwordx4 v[68:71], v0, s[16:19], s44 offen offset:1024 sc1
  ds_read_b64_tr_b16 v[30:31], v23 offset:32768
  v_mfma_f32_16x16x32_bf16 v[172:175], v[32:35], v[220:223], v[172:175]
  s_waitcnt lgkmcnt(4)
  ds_read_b64_tr_b16 v[32:33], v3 offset:0
  v_mfma_f32_16x16x32_bf16 v[144:147], v[36:39], v[224:227], v[144:147]
  ds_read_b64_tr_b16 v[34:35], v3 offset:6144
  v_mfma_f32_16x16x32_bf16 v[148:151], v[36:39], v[228:231], v[148:151]
  ds_read_b64_tr_b16 v[36:37], v4 offset:0
  v_mfma_f32_16x16x32_bf16 v[152:155], v[40:43], v[224:227], v[152:155]
  s_add_u32 s49, s38, 366592
  buffer_load_dwordx4 v2, s[12:15], s49 offen offset:2048 lds
  ds_read_b64_tr_b16 v[38:39], v4 offset:6144
  v_mfma_f32_16x16x32_bf16 v[156:159], v[40:43], v[228:231], v[156:159]
  s_waitcnt lgkmcnt(4)
  ds_read_b64_tr_b16 v[40:41], v5 offset:0
  v_mfma_f32_16x16x32_bf16 v[160:163], v[24:27], v[224:227], v[160:163]
  ds_read_b64_tr_b16 v[42:43], v5 offset:6144
  v_mfma_f32_16x16x32_bf16 v[164:167], v[24:27], v[228:231], v[164:167]
  ds_read_b64_tr_b16 v[24:25], v6 offset:0
  v_mfma_f32_16x16x32_bf16 v[168:171], v[28:31], v[224:227], v[168:171]
  ds_read_b64_tr_b16 v[26:27], v6 offset:6144
  v_mfma_f32_16x16x32_bf16 v[172:175], v[28:31], v[228:231], v[172:175]
  s_waitcnt vmcnt(13)
  s_barrier
  s_mov_b64 exec, 3
  buffer_load_dwordx2 v[18:19], v17, s[16:19], 0 offen sc1
  s_mov_b64 exec, -1
  s_waitcnt lgkmcnt(4)
  ds_read_b64_tr_b16 v[28:29], v3 offset:1024
  v_mfma_f32_16x16x32_bf16 v[112:115], v[32:35], v[232:235], v[112:115]
  ds_read_b64_tr_b16 v[30:31], v3 offset:7168
  v_mfma_f32_16x16x32_bf16 v[116:119], v[32:35], v[236:239], v[116:119]
  ds_read_b64_tr_b16 v[32:33], v4 offset:1024
  v_mfma_f32_16x16x32_bf16 v[120:123], v[36:39], v[232:235], v[120:123]
  s_add_u32 m0, s35, 0
  s_add_u32 s49, s37, 221312
  buffer_load_dwordx4 v2, s[12:15], s49 offen offset:0 lds
  ds_read_b64_tr_b16 v[34:35], v4 offset:7168
  v_mfma_f32_16x16x32_bf16 v[124:127], v[36:39], v[236:239], v[124:127]
  s_waitcnt lgkmcnt(4)
  ds_read_b64_tr_b16 v[36:37], v5 offset:1024
  v_mfma_f32_16x16x32_bf16 v[128:131], v[40:43], v[232:235], v[128:131]
  ds_read_b64_tr_b16 v[38:39], v5 offset:7168
  v_mfma_f32_16x16x32_bf16 v[132:135], v[40:43], v[236:239], v[132:135]
  ds_read_b64_tr_b16 v[40:41], v6 offset:1024
  v_mfma_f32_16x16x32_bf16 v[136:139], v[24:27], v[232:235], v[136:139]
  s_add_u32 s44, s41, 8192
  buffer_load_dwordx4 v[72:75], v0, s[16:19], s44 offen offset:0 sc1
  ds_read_b64_tr_b16 v[42:43], v6 offset:7168
  v_mfma_f32_16x16x32_bf16 v[140:143], v[24:27], v[236:239], v[140:143]
  s_waitcnt lgkmcnt(4)
  ds_read_b64_tr_b16 v[24:25], v3 offset:2048
  v_mfma_f32_16x16x32_bf16 v[112:115], v[28:31], v[240:243], v[112:115]
  ds_read_b64_tr_b16 v[26:27], v3 offset:8192
  v_mfma_f32_16x16x32_bf16 v[116:119], v[28:31], v[244:247], v[116:119]
  ds_read_b64_tr_b16 v[28:29], v4 offset:2048
  v_mfma_f32_16x16x32_bf16 v[120:123], v[32:35], v[240:243], v[120:123]
  s_add_u32 s49, s37, 294016
  buffer_load_dwordx4 v2, s[12:15], s49 offen offset:1024 lds
  ds_read_b64_tr_b16 v[30:31], v4 offset:8192
  v_mfma_f32_16x16x32_bf16 v[124:127], v[32:35], v[244:247], v[124:127]
  s_waitcnt lgkmcnt(4)
  ds_read_b64_tr_b16 v[32:33], v5 offset:2048
  v_mfma_f32_16x16x32_bf16 v[128:131], v[36:39], v[240:243], v[128:131]
  ds_read_b64_tr_b16 v[34:35], v5 offset:8192
  v_mfma_f32_16x16x32_bf16 v[132:135], v[36:39], v[244:247], v[132:135]
  ds_read_b64_tr_b16 v[36:37], v6 offset:2048
  v_mfma_f32_16x16x32_bf16 v[136:139], v[40:43], v[240:243], v[136:139]
  buffer_load_dwordx4 v[76:79], v0, s[16:19], s44 offen offset:1024 sc1
  ds_read_b64_tr_b16 v[38:39], v6 offset:8192
  v_mfma_f32_16x16x32_bf16 v[140:143], v[40:43], v[244:247], v[140:143]
  s_waitcnt lgkmcnt(4)
  ds_read_b64_tr_b16 v[40:41], v3 offset:24576
  v_mfma_f32_16x16x32_bf16 v[112:115], v[24:27], v[248:251], v[112:115]
  ds_read_b64_tr_b16 v[42:43], v3 offset:30720
  v_mfma_f32_16x16x32_bf16 v[116:119], v[24:27], v[252:255], v[116:119]
  ds_read_b64_tr_b16 v[24:25], v4 offset:24576
  v_mfma_f32_16x16x32_bf16 v[120:123], v[28:31], v[248:251], v[120:123]
  s_add_u32 s49, s38, 219264
  buffer_load_dwordx4 v2, s[12:15], s49 offen offset:2048 lds
  ds_read_b64_tr_b16 v[26:27], v4 offset:30720
  v_mfma_f32_16x16x32_bf16 v[124:127], v[28:31], v[252:255], v[124:127]
  s_waitcnt lgkmcnt(4)
  ds_read_b64_tr_b16 v[28:29], v5 offset:24576
  v_mfma_f32_16x16x32_bf16 v[128:131], v[32:35], v[248:251], v[128:131]
  ds_read_b64_tr_b16 v[30:31], v5 offset:30720
  v_mfma_f32_16x16x32_bf16 v[132:135], v[32:35], v[252:255], v[132:135]
  ds_read_b64_tr_b16 v[32:33], v6 offset:24576
  v_mfma_f32_16x16x32_bf16 v[136:139], v[36:39], v[248:251], v[136:139]
  ds_read_b64_tr_b16 v[34:35], v6 offset:30720
  v_mfma_f32_16x16x32_bf16 v[140:143], v[36:39], v[252:255], v[140:143]
  s_waitcnt vmcnt(12)
  s_waitcnt vmcnt(5)
  v_subrev_u32 v19, s31, v19
  v_cmp_eq_u32 vcc, s30, v18
  v_subrev_u32 v19, 6, v19
  v_cmp_gt_u32 s[46:47], 10, v19
  s_nop 0
  s_and_b32 s46, s46, vcc_lo
  s_and_b32 s46, s46, 3
  s_cmp_eq_u32 s46, 3
  s_cbranch_scc0 L_slow_r_7
L_back_r_7:
  s_barrier
  s_waitcnt lgkmcnt(4)
  ds_read_b64_tr_b16 v[36:37], v3 offset:25600
  v_mfma_f32_16x16x32_bf16 v[144:147], v[40:43], v[232:235], v[144:147]
  s_add_u32 s44, s40, 10240
  buffer_load_dwordx4 v[80:83], v0, s[16:19], s44 offen offset:0 sc1
  ds_read_b64_tr_b16 v[38:39], v3 offset:31744
  v_mfma_f32_16x16x32_bf16 v[148:151], v[40:43], v[236:239], v[148:151]
  ds_read_b64_tr_b16 v[40:41], v4 offset:25600
  v_mfma_f32_16x16x32_bf16 v[152:155], v[24:27], v[232:235], v[152:155]
  s_add_u32 m0, s35, 24576
  s_add_u32 s49, s38, 295040
  buffer_load_dwordx4 v2, s[12:15], s49 offen offset:0 lds
  ds_read_b64_tr_b16 v[42:43], v4 offset:31744
  v_mfma_f32_16x16x32_bf16 v[156:159], v[24:27], v[236:239], v[156:159]
  s_waitcnt lgkmcnt(4)
  ds_read_b64_tr_b16 v[24:25], v5 offset:25600
  v_mfma_f32_16x16x32_bf16 v[160:163], v[28:31], v[232:235], v[160:163]
  buffer_load_dwordx4 v[84:87], v0, s[16:19], s44 offen offset:1024 sc1
  ds_read_b64_tr_b16 v[26:27], v5 offset:31744
  v_mfma_f32_16x16x32_bf16 v[164:167], v[28:31], v[236:239], v[164:167]
  ds_read_b64_tr_b16 v[28:29], v6 offset:25600
  v_mfma_f32_16x16x32_bf16 v[168:171], v[32:35], v[232:235], v[168:171]
  s_add_u32 s44, s41, 10240
  buffer_load_dwordx4 v[88:91], v0, s[16:19], s44 offen offset:0 sc1
  ds_read_b64_tr_b16 v[30:31], v6 offset:31744
  v_mfma_f32_16x16x32_bf16 v[172:175], v[32:35], v[236:239], v[172:175]
  s_waitcnt lgkmcnt(4)
  ds_read_b64_tr_b16 v[32:33], v3 offset:26624
  v_mfma_f32_16x16x32_bf16 v[144:147], v[36:39], v[240:243], v[144:147]
  buffer_load_dwordx4 v[92:95], v0, s[16:19], s44 offen offset:1024 sc1
  ds_read_b64_tr_b16 v[34:35], v3 offset:32768
  v_mfma_f32_16x16x32_bf16 v[148:151], v[36:39], v[244:247], v[148:151]
  ds_read_b64_tr_b16 v[36:37], v4 offset:26624
  v_mfma_f32_16x16x32_bf16 v[152:155], v[40:43], v[240:243], v[152:155]
  s_add_u32 s49, s37, 367744
  buffer_load_dwordx4 v2, s[12:15], s49 offen offset:1024 lds
  ds_read_b64_tr_b16 v[38:39], v4 offset:32768
  v_mfma_f32_16x16x32_bf16 v[156:159], v[40:43], v[244:247], v[156:159]
  s_waitcnt lgkmcnt(4)
  ds_read_b64_tr_b16 v[40:41], v5 offset:26624
  v_mfma_f32_16x16x32_bf16 v[160:163], v[24:27], v[240:243], v[160:163]
  ds_read_b64_tr_b16 v[42:43], v5 offset:32768
  v_mfma_f32_16x16x32_bf16 v[164:167], v[24:27], v[244:247], v[164:167]
  ds_read_b64_tr_b16 v[24:25], v6 offset:26624
  v_mfma_f32_16x16x32_bf16 v[168:171], v[28:31], v[240:243], v[168:171]
  ds_read_b64_tr_b16 v[26:27], v6 offset:32768
  v_mfma_f32_16x16x32_bf16 v[172:175], v[28:31], v[244:247], v[172:175]
  s_waitcnt lgkmcnt(4)
  ds_read_b64_tr_b16 v[28:29], v7 offset:0
  v_mfma_f32_16x16x32_bf16 v[144:147], v[32:35], v[248:251], v[144:147]
  ds_read_b64_tr_b16 v[30:31], v7 offset:6144
  v_mfma_f32_16x16x32_bf16 v[148:151], v[32:35], v[252:255], v[148:151]
  ds_read_b64_tr_b16 v[32:33], v8 offset:0
  v_mfma_f32_16x16x32_bf16 v[152:155], v[36:39], v[248:251], v[152:155]
  s_add_u32 s49, s38, 366720
  buffer_load_dwordx4 v2, s[12:15], s49 offen offset:2048 lds
  ds_read_b64_tr_b16 v[34:35], v8 offset:6144
  v_mfma_f32_16x16x32_bf16 v[156:159], v[36:39], v[252:255], v[156:159]
  s_waitcnt lgkmcnt(4)
  ds_read_b64_tr_b16 v[36:37], v44 offset:0
  v_mfma_f32_16x16x32_bf16 v[160:163], v[40:43], v[248:251], v[160:163]
  ds_read_b64_tr_b16 v[38:39], v44 offset:6144
  v_mfma_f32_16x16x32_bf16 v[164:167], v[40:43], v[252:255], v[164:167]
  ds_read_b64_tr_b16 v[40:41], v45 offset:0
  v_mfma_f32_16x16x32_bf16 v[168:171], v[24:27], v[248:251], v[168:171]
  ds_read_b64_tr_b16 v[42:43], v45 offset:6144
  v_mfma_f32_16x16x32_bf16 v[172:175], v[24:27], v[252:255], v[172:175]
  s_barrier
  s_waitcnt lgkmcnt(4)
  ds_read_b64_tr_b16 v[24:25], v7 offset:1024
  v_mfma_f32_16x16x32_bf16 v[112:115], v[28:31], v[48:51], v[112:115]
  v_lshrrev_b32 v12, 2, v0
  ds_read_b64_tr_b16 v[26:27], v7 offset:7168
  v_mfma_f32_16x16x32_bf16 v[116:119], v[28:31], v[52:55], v[116:119]
  v_sub_u32 v12, v0, v12
  ds_read_b64_tr_b16 v[28:29], v8 offset:1024
  v_mfma_f32_16x16x32_bf16 v[120:123], v[32:35], v[48:51], v[120:123]
  s_add_u32 m0, s35, 49152
  s_add_u32 s49, s37, 256
  buffer_load_dwordx4 v2, s[12:15], s49 offen offset:0 lds
  ds_read_b64_tr_b16 v[30:31], v8 offset:7168
  v_mfma_f32_16x16x32_bf16 v[124:127], v[32:35], v[52:55], v[124:127]
  s_waitcnt lgkmcnt(4)
  ds_read_b64_tr_b16 v[32:33], v44 offset:1024
  v_mfma_f32_16x16x32_bf16 v[128:131], v[36:39], v[48:51], v[128:131]
  s_add_u32 s46, s35, 73728
  v_add_u32 v1, s46, v0
  s_xor_b32 s47, s24, 4
  s_mul_i32 s47, s47, 3072
  s_add_u32 s47, s47, 73728
  v_add_u32 v9, s47, v0
  ds_read_b64_tr_b16 v[34:35], v44 offset:7168
  v_mfma_f32_16x16x32_bf16 v[132:135], v[36:39], v[52:55], v[132:135]
  v_lshrrev_b32 v13, 5, v0
  ds_read_b64_tr_b16 v[36:37], v45 offset:1024
  v_mfma_f32_16x16x32_bf16 v[136:139], v[40:43], v[48:51], v[136:139]
  v_and_b32 v13, 24, v13
  ds_read_b64_tr_b16 v[38:39], v45 offset:7168
  v_mfma_f32_16x16x32_bf16 v[140:143], v[40:43], v[52:55], v[140:143]
  s_waitcnt lgkmcnt(4)
  ds_read_b64_tr_b16 v[40:41], v7 offset:2048
  v_mfma_f32_16x16x32_bf16 v[112:115], v[24:27], v[56:59], v[112:115]
  ds_read_b64_tr_b16 v[42:43], v7 offset:8192
  v_mfma_f32_16x16x32_bf16 v[116:119], v[24:27], v[60:63], v[116:119]
  ds_read_b64_tr_b16 v[24:25], v8 offset:2048
  v_mfma_f32_16x16x32_bf16 v[120:123], v[28:31], v[56:59], v[120:123]
  s_add_u32 s49, s37, 72960
  buffer_load_dwordx4 v2, s[12:15], s49 offen offset:1024 lds
  ds_read_b64_tr_b16 v[26:27], v8 offset:8192
  v_mfma_f32_16x16x32_bf16 v[124:127], v[28:31], v[60:63], v[124:127]
  s_waitcnt lgkmcnt(4)
  ds_read_b64_tr_b16 v[28:29], v44 offset:2048
  v_mfma_f32_16x16x32_bf16 v[128:131], v[32:35], v[56:59], v[128:131]
  ds_read_b64_tr_b16 v[30:31], v44 offset:8192
  v_mfma_f32_16x16x32_bf16 v[132:135], v[32:35], v[60:63], v[132:135]
  ds_read_b64_tr_b16 v[32:33], v45 offset:2048
  v_mfma_f32_16x16x32_bf16 v[136:139], v[36:39], v[56:59], v[136:139]
  ds_read_b64_tr_b16 v[34:35], v45 offset:8192
  v_mfma_f32_16x16x32_bf16 v[140:143], v[36:39], v[60:63], v[140:143]
  s_waitcnt lgkmcnt(4)
  ds_read_b64_tr_b16 v[36:37], v7 offset:24576
  v_mfma_f32_16x16x32_bf16 v[112:115], v[40:43], v[64:67], v[112:115]
  ds_read_b64_tr_b16 v[38:39], v7 offset:30720
  v_mfma_f32_16x16x32_bf16 v[116:119], v[40:43], v[68:71], v[116:119]
  ds_read_b64_tr_b16 v[40:41], v8 offset:24576
  v_mfma_f32_16x16x32_bf16 v[120:123], v[24:27], v[64:67], v[120:123]
  s_add_u32 s49, s37, 145664
  buffer_load_dwordx4 v2, s[12:15], s49 offen offset:2048 lds
  ds_read_b64_tr_b16 v[42:43], v8 offset:30720
  v_mfma_f32_16x16x32_bf16 v[124:127], v[24:27], v[68:71], v[124:127]
  s_waitcnt lgkmcnt(4)
  ds_read_b64_tr_b16 v[24:25], v44 offset:24576
  v_mfma_f32_16x16x32_bf16 v[128:131], v[28:31], v[64:67], v[128:131]
  s_mov_b32 exec_lo, 0xf0
  s_mov_b32 exec_hi, 0x0
  buffer_load_dwordx2 v[18:19], v47, s[16:19], s52 offen sc1
  s_mov_b64 exec, -1
  ds_read_b64_tr_b16 v[26:27], v44 offset:30720
  v_mfma_f32_16x16x32_bf16 v[132:135], v[28:31], v[68:71], v[132:135]
  ds_read_b64_tr_b16 v[28:29], v45 offset:24576
  v_mfma_f32_16x16x32_bf16 v[136:139], v[32:35], v[64:67], v[136:139]
  ds_read_b64_tr_b16 v[30:31], v45 offset:30720
  v_mfma_f32_16x16x32_bf16 v[140:143], v[32:35], v[68:71], v[140:143]
  s_waitcnt vmcnt(6)
  s_barrier
  s_waitcnt lgkmcnt(4)
  ds_read_b64_tr_b16 v[32:33], v7 offset:25600
  v_mfma_f32_16x16x32_bf16 v[112:115], v[36:39], v[72:75], v[112:115]
  ds_read_b64_tr_b16 v[34:35], v7 offset:31744
  v_mfma_f32_16x16x32_bf16 v[116:119], v[36:39], v[76:79], v[116:119]
  ds_read_b64_tr_b16 v[36:37], v8 offset:25600
  v_mfma_f32_16x16x32_bf16 v[120:123], v[40:43], v[72:75], v[120:123]
  s_add_u32 m0, s35, 73728
  s_add_u32 s49, s38, 256
  buffer_load_dwordx4 v2, s[12:15], s49 offen offset:0 lds
  ds_read_b64_tr_b16 v[38:39], v8 offset:31744
  v_mfma_f32_16x16x32_bf16 v[124:127], v[40:43], v[76:79], v[124:127]
  s_waitcnt lgkmcnt(4)
  ds_read_b64_tr_b16 v[40:41], v44 offset:25600
  v_mfma_f32_16x16x32_bf16 v[128:131], v[24:27], v[72:75], v[128:131]
  ds_read_b64_tr_b16 v[42:43], v44 offset:31744
  v_mfma_f32_16x16x32_bf16 v[132:135], v[24:27], v[76:79], v[132:135]
  ds_read_b64_tr_b16 v[24:25], v45 offset:25600
  v_mfma_f32_16x16x32_bf16 v[136:139], v[28:31], v[72:75], v[136:139]
  ds_read_b64_tr_b16 v[26:27], v45 offset:31744
  v_mfma_f32_16x16x32_bf16 v[140:143], v[28:31], v[76:79], v[140:143]
  s_waitcnt lgkmcnt(4)
  ds_read_b64_tr_b16 v[28:29], v7 offset:26624
  v_mfma_f32_16x16x32_bf16 v[112:115], v[32:35], v[80:83], v[112:115]
  ds_read_b64_tr_b16 v[30:31], v7 offset:32768
  v_mfma_f32_16x16x32_bf16 v[116:119], v[32:35], v[84:87], v[116:119]
  ds_read_b64_tr_b16 v[32:33], v8 offset:26624
  v_mfma_f32_16x16x32_bf16 v[120:123], v[36:39], v[80:83], v[120:123]
  s_add_u32 s49, s38, 72960
  buffer_load_dwordx4 v2, s[12:15], s49 offen offset:1024 lds
  ds_read_b64_tr_b16 v[34:35], v8 offset:32768
  v_mfma_f32_16x16x32_bf16 v[124:127], v[36:39], v[84:87], v[124:127]
  s_waitcnt lgkmcnt(4)
  ds_read_b64_tr_b16 v[36:37], v44 offset:26624
  v_mfma_f32_16x16x32_bf16 v[128:131], v[40:43], v[80:83], v[128:131]
  ds_read_b64_tr_b16 v[38:39], v44 offset:32768
  v_mfma_f32_16x16x32_bf16 v[132:135], v[40:43], v[84:87], v[132:135]
  ds_read_b64_tr_b16 v[40:41], v45 offset:26624
  v_mfma_f32_16x16x32_bf16 v[136:139], v[24:27], v[80:83], v[136:139]
  ds_read_b64_tr_b16 v[42:43], v45 offset:32768
  v_mfma_f32_16x16x32_bf16 v[140:143], v[24:27], v[84:87], v[140:143]
  s_waitcnt lgkmcnt(4)
  ds_read_b64_tr_b16 v[24:25], v20 offset:0
  v_mfma_f32_16x16x32_bf16 v[112:115], v[28:31], v[88:91], v[112:115]
  ds_read_b64_tr_b16 v[26:27], v20 offset:6144
  v_mfma_f32_16x16x32_bf16 v[116:119], v[28:31], v[92:95], v[116:119]
  ds_read_b64_tr_b16 v[28:29], v21 offset:0
  v_mfma_f32_16x16x32_bf16 v[120:123], v[32:35], v[88:91], v[120:123]
  s_add_u32 s49, s38, 145664
  buffer_load_dwordx4 v2, s[12:15], s49 offen offset:2048 lds
  ds_read_b64_tr_b16 v[30:31], v21 offset:6144
  v_mfma_f32_16x16x32_bf16 v[124:127], v[32:35], v[92:95], v[124:127]
  s_waitcnt lgkmcnt(4)
  ds_read_b64_tr_b16 v[32:33], v22 offset:0
  v_mfma_f32_16x16x32_bf16 v[128:131], v[36:39], v[88:91], v[128:131]
  ds_read_b64_tr_b16 v[34:35], v22 offset:6144
  v_mfma_f32_16x16x32_bf16 v[132:135], v[36:39], v[92:95], v[132:135]
  ds_read_b64_tr_b16 v[36:37], v23 offset:0
  v_mfma_f32_16x16x32_bf16 v[136:139], v[40:43], v[88:91], v[136:139]
  ds_read_b64_tr_b16 v[38:39], v23 offset:6144
  v_mfma_f32_16x16x32_bf16 v[140:143], v[40:43], v[92:95], v[140:143]
  s_waitcnt vmcnt(7)
  s_barrier
  s_waitcnt vmcnt(3)
  v_cmp_eq_u32 vcc, s30, v18
  v_cmp_eq_u32 s[46:47], s31, v19
  s_nop 0
  s_and_b32 vcc_lo, vcc_lo, s46
  s_andn2_b32 s43, 48, s53
  s_and_b32 s43, s43, vcc_lo
  s_or_b32 s53, s53, s43
  s_waitcnt lgkmcnt(4)
  ds_read_b64_tr_b16 v[40:41], v20 offset:1024
  v_mfma_f32_16x16x32_bf16 v[144:147], v[24:27], v[48:51], v[144:147]
  ds_read_b64_tr_b16 v[42:43], v20 offset:7168
  v_mfma_f32_16x16x32_bf16 v[148:151], v[24:27], v[52:55], v[148:151]
  ds_read_b64_tr_b16 v[24:25], v21 offset:1024
  v_mfma_f32_16x16x32_bf16 v[152:155], v[28:31], v[48:51], v[152:155]
  s_add_u32 m0, s35, 98304
  s_add_u32 s49, s37, 221440
  buffer_load_dwordx4 v2, s[12:15], s49 offen offset:0 lds
  ds_read_b64_tr_b16 v[26:27], v21 offset:7168
  v_mfma_f32_16x16x32_bf16 v[156:159], v[28:31], v[52:55], v[156:159]
  s_waitcnt lgkmcnt(4)
  ds_read_b64_tr_b16 v[28:29], v22 offset:1024
  v_mfma_f32_16x16x32_bf16 v[160:163], v[32:35], v[48:51], v[160:163]
  ds_read_b64_tr_b16 v[30:31], v22 offset:7168
  v_mfma_f32_16x16x32_bf16 v[164:167], v[32:35], v[52:55], v[164:167]
  ds_read_b64_tr_b16 v[32:33], v23 offset:1024
  v_mfma_f32_16x16x32_bf16 v[168:171], v[36:39], v[48:51], v[168:171]
  s_bitcmp1_b32 s43, 4
  s_cselect_b64 exec, -1, 0
  buffer_load_dwordx3 v[96:98], v12, s[16:19], s84 offen offset:0 sc1
  buffer_load_dwordx3 v[100:102], v12, s[16:19], s84 offen offset:1024 sc1
  s_mov_b64 exec, -1
  ds_read_b64_tr_b16 v[34:35], v23 offset:7168
  v_mfma_f32_16x16x32_bf16 v[172:175], v[36:39], v[52:55], v[172:175]
  ds_write_b128 v1, v[124:127] offset:49152
  s_waitcnt lgkmcnt(5)
  ds_read_b64_tr_b16 v[36:37], v20 offset:2048
  v_mfma_f32_16x16x32_bf16 v[144:147], v[40:43], v[56:59], v[144:147]
  ds_read_b64_tr_b16 v[38:39], v20 offset:8192
  v_mfma_f32_16x16x32_bf16 v[148:151], v[40:43], v[60:63], v[148:151]
  ds_read_b64_tr_b16 v[40:41], v21 offset:2048
  v_mfma_f32_16x16x32_bf16 v[152:155], v[24:27], v[56:59], v[152:155]
  s_add_u32 s49, s37, 294144
  buffer_load_dwordx4 v2, s[12:15], s49 offen offset:1024 lds
  ds_read_b64_tr_b16 v[42:43], v21 offset:8192
  v_mfma_f32_16x16x32_bf16 v[156:159], v[24:27], v[60:63], v[156:159]
  ds_write_b128 v1, v[136:139] offset:50176
  s_waitcnt lgkmcnt(6)
  ds_read_b64_tr_b16 v[24:25], v22 offset:2048
  v_mfma_f32_16x16x32_bf16 v[160:163], v[28:31], v[56:59], v[160:163]
  ds_read_b64_tr_b16 v[26:27], v22 offset:8192
  v_mfma_f32_16x16x32_bf16 v[164:167], v[28:31], v[60:63], v[164:167]
  ds_read_b64_tr_b16 v[28:29], v23 offset:2048
  v_mfma_f32_16x16x32_bf16 v[168:171], v[32:35], v[56:59], v[168:171]
  s_bitcmp1_b32 s43, 5
  s_cselect_b64 exec, -1, 0
  buffer_load_dwordx3 v[104:106], v12, s[16:19], s85 offen offset:0 sc1
  buffer_load_dwordx3 v[108:110], v12, s[16:19], s85 offen offset:1024 sc1
  s_mov_b64 exec, -1
  ds_read_b64_tr_b16 v[30:31], v23 offset:8192
  v_mfma_f32_16x16x32_bf16 v[172:175], v[32:35], v[60:63], v[172:175]
  ds_write_b128 v1, v[140:143] offset:51200
  s_waitcnt lgkmcnt(6)
  ds_read_b64_tr_b16 v[32:33], v20 offset:24576
  v_mfma_f32_16x16x32_bf16 v[144:147], v[36:39], v[64:67], v[144:147]
  ds_read_b64_tr_b16 v[34:35], v20 offset:30720
  v_mfma_f32_16x16x32_bf16 v[148:151], v[36:39], v[68:71], v[148:151]
  ds_read_b64_tr_b16 v[36:37], v21 offset:24576
  v_mfma_f32_16x16x32_bf16 v[152:155], v[40:43], v[64:67], v[152:155]
  s_add_u32 s49, s38, 219392
  buffer_load_dwordx4 v2, s[12:15], s49 offen offset:2048 lds
  ds_read_b64_tr_b16 v[38:39], v21 offset:30720
  v_mfma_f32_16x16x32_bf16 v[156:159], v[40:43], v[68:71], v[156:159]
  s_waitcnt lgkmcnt(5)
  ds_read_b64_tr_b16 v[40:41], v22 offset:24576
  v_mfma_f32_16x16x32_bf16 v[160:163], v[24:27], v[64:67], v[160:163]
  ds_read_b64_tr_b16 v[42:43], v22 offset:30720
  v_mfma_f32_16x16x32_bf16 v[164:167], v[24:27], v[68:71], v[164:167]
  ds_read_b64_tr_b16 v[24:25], v23 offset:24576
  v_mfma_f32_16x16x32_bf16 v[168:171], v[28:31], v[64:67], v[168:171]
  ds_read_b64_tr_b16 v[26:27], v23 offset:30720
  v_mfma_f32_16x16x32_bf16 v[172:175], v[28:31], v[68:71], v[172:175]
  s_waitcnt lgkmcnt(8)
  s_barrier
  s_waitcnt lgkmcnt(4)
  ds_read_b64_tr_b16 v[28:29], v20 offset:25600
  v_mfma_f32_16x16x32_bf16 v[144:147], v[32:35], v[72:75], v[144:147]
  ds_read_b128 v[124:127], v9 offset:49152
  ds_read_b128 v[136:139], v9 offset:50176
  ds_read_b64_tr_b16 v[30:31], v20 offset:31744
  v_mfma_f32_16x16x32_bf16 v[148:151], v[32:35], v[76:79], v[148:151]
  ds_read_b128 v[140:143], v9 offset:51200
  ds_read_b64_tr_b16 v[32:33], v21 offset:25600
  v_mfma_f32_16x16x32_bf16 v[152:155], v[36:39], v[72:75], v[152:155]
  s_add_u32 m0, s35, 0
  s_add_u32 s49, s38, 295168
  buffer_load_dwordx4 v2, s[12:15], s49 offen offset:0 lds
  ds_read_b64_tr_b16 v[34:35], v21 offset:31744
  v_mfma_f32_16x16x32_bf16 v[156:159], v[36:39], v[76:79], v[156:159]
  s_waitcnt lgkmcnt(2)
  ds_read_b64_tr_b16 v[36:37], v22 offset:25600
  v_mfma_f32_16x16x32_bf16 v[160:163], v[40:43], v[72:75], v[160:163]
  v_add_f32 v116, v116, v124
  v_add_f32 v117, v117, v125
  ds_read_b64_tr_b16 v[38:39], v22 offset:31744
  v_mfma_f32_16x16x32_bf16 v[164:167], v[40:43], v[76:79], v[164:167]
  v_add_f32 v118, v118, v126
  v_add_f32 v119, v119, v127
  ds_read_b64_tr_b16 v[40:41], v23 offset:25600
  v_mfma_f32_16x16x32_bf16 v[168:171], v[24:27], v[72:75], v[168:171]
  v_cvt_pk_bf16_f32 v124, v116, v117
  v_cvt_pk_bf16_f32 v125, v118, v119
  ds_read_b64_tr_b16 v[42:43], v23 offset:31744
  v_mfma_f32_16x16x32_bf16 v[172:175], v[24:27], v[76:79], v[172:175]
  v_mov_b32 v127, s30
  v_add_f32 v128, v128, v136
  s_waitcnt lgkmcnt(4)
  ds_read_b64_tr_b16 v[24:25], v20 offset:26624
  v_mfma_f32_16x16x32_bf16 v[144:147], v[28:31], v[80:83], v[144:147]
  v_add_f32 v129, v129, v137
  v_add_f32 v130, v130, v138
  ds_read_b64_tr_b16 v[26:27], v20 offset:32768
  v_mfma_f32_16x16x32_bf16 v[148:151], v[28:31], v[84:87], v[148:151]
  v_add_f32 v131, v131, v139
  v_cvt_pk_bf16_f32 v136, v128, v129
  ds_read_b64_tr_b16 v[28:29], v21 offset:26624
  v_mfma_f32_16x16x32_bf16 v[152:155], v[32:35], v[80:83], v[152:155]
  s_add_u32 s49, s37, 367872
  buffer_load_dwordx4 v2, s[12:15], s49 offen offset:1024 lds
  ds_read_b64_tr_b16 v[30:31], v21 offset:32768
  v_mfma_f32_16x16x32_bf16 v[156:159], v[32:35], v[84:87], v[156:159]
  v_cvt_pk_bf16_f32 v137, v130, v131
  v_mov_b32 v139, s30
  s_waitcnt lgkmcnt(4)
  ds_read_b64_tr_b16 v[32:33], v22 offset:26624
  v_mfma_f32_16x16x32_bf16 v[160:163], v[36:39], v[80:83], v[160:163]
  v_add_f32 v132, v132, v140
  v_add_f32 v133, v133, v141
  ds_read_b64_tr_b16 v[34:35], v22 offset:32768
  v_mfma_f32_16x16x32_bf16 v[164:167], v[36:39], v[84:87], v[164:167]
  v_add_f32 v134, v134, v142
  v_add_f32 v135, v135, v143
  ds_read_b64_tr_b16 v[36:37], v23 offset:26624
  v_mfma_f32_16x16x32_bf16 v[168:171], v[40:43], v[80:83], v[168:171]
  v_cvt_pk_bf16_f32 v140, v132, v133
  v_cvt_pk_bf16_f32 v141, v134, v135
  ds_read_b64_tr_b16 v[38:39], v23 offset:32768
  v_mfma_f32_16x16x32_bf16 v[172:175], v[40:43], v[84:87], v[172:175]
  v_mov_b32 v143, s30
  s_waitcnt lgkmcnt(4)
  ds_read_b64_tr_b16 v[40:41], v3 offset:0
  v_mfma_f32_16x16x32_bf16 v[144:147], v[24:27], v[88:91], v[144:147]
  ds_read_b64_tr_b16 v[42:43], v3 offset:6144
  v_mfma_f32_16x16x32_bf16 v[148:151], v[24:27], v[92:95], v[148:151]
  ds_read_b64_tr_b16 v[24:25], v4 offset:0
  v_mfma_f32_16x16x32_bf16 v[152:155], v[28:31], v[88:91], v[152:155]
  s_add_u32 s49, s38, 366848
  buffer_load_dwordx4 v2, s[12:15], s49 offen offset:2048 lds
  ds_read_b64_tr_b16 v[26:27], v4 offset:6144
  v_mfma_f32_16x16x32_bf16 v[156:159], v[28:31], v[92:95], v[156:159]
  s_waitcnt lgkmcnt(4)
  ds_read_b64_tr_b16 v[28:29], v5 offset:0
  v_mfma_f32_16x16x32_bf16 v[160:163], v[32:35], v[88:91], v[160:163]
  ds_read_b64_tr_b16 v[30:31], v5 offset:6144
  v_mfma_f32_16x16x32_bf16 v[164:167], v[32:35], v[92:95], v[164:167]
  ds_read_b64_tr_b16 v[32:33], v6 offset:0
  v_mfma_f32_16x16x32_bf16 v[168:171], v[36:39], v[88:91], v[168:171]
  ds_read_b64_tr_b16 v[34:35], v6 offset:6144
  v_mfma_f32_16x16x32_bf16 v[172:175], v[36:39], v[92:95], v[172:175]
  s_waitcnt vmcnt(6)
  s_barrier
  s_waitcnt lgkmcnt(4)
  ds_read_b64_tr_b16 v[36:37], v3 offset:1024
  v_mfma_f32_16x16x32_bf16 v[176:179], v[40:43], v[208:211], v[176:179]
  ds_read_b64_tr_b16 v[38:39], v3 offset:7168
  v_mfma_f32_16x16x32_bf16 v[180:183], v[40:43], v[212:215], v[180:183]
  ds_read_b64_tr_b16 v[40:41], v4 offset:1024
  v_mfma_f32_16x16x32_bf16 v[184:187], v[24:27], v[208:211], v[184:187]
  ds_read_b64_tr_b16 v[42:43], v4 offset:7168
  v_mfma_f32_16x16x32_bf16 v[188:191], v[24:27], v[212:215], v[188:191]
  s_waitcnt lgkmcnt(4)
  ds_read_b64_tr_b16 v[24:25], v5 offset:1024
  v_mfma_f32_16x16x32_bf16 v[192:195], v[28:31], v[208:211], v[192:195]
  ds_read_b64_tr_b16 v[26:27], v5 offset:7168
  v_mfma_f32_16x16x32_bf16 v[196:199], v[28:31], v[212:215], v[196:199]
  ds_write_b128 v1, v[156:159] offset:49152
  ds_read_b64_tr_b16 v[28:29], v6 offset:1024
  v_mfma_f32_16x16x32_bf16 v[200:203], v[32:35], v[208:211], v[200:203]
  ds_read_b64_tr_b16 v[30:31], v6 offset:7168
  v_mfma_f32_16x16x32_bf16 v[204:207], v[32:35], v[212:215], v[204:207]
  s_waitcnt lgkmcnt(5)
  ds_read_b64_tr_b16 v[32:33], v3 offset:2048
  v_mfma_f32_16x16x32_bf16 v[176:179], v[36:39], v[216:219], v[176:179]
  ds_write_b128 v1, v[168:171] offset:50176
  ds_read_b64_tr_b16 v[34:35], v3 offset:8192
  v_mfma_f32_16x16x32_bf16 v[180:183], v[36:39], v[220:223], v[180:183]
  ds_read_b64_tr_b16 v[36:37], v4 offset:2048
  v_mfma_f32_16x16x32_bf16 v[184:187], v[40:43], v[216:219], v[184:187]
  ds_read_b64_tr_b16 v[38:39], v4 offset:8192
  v_mfma_f32_16x16x32_bf16 v[188:191], v[40:43], v[220:223], v[188:191]
  ds_write_b128 v1, v[172:175] offset:51200
  s_waitcnt lgkmcnt(6)
  ds_read_b64_tr_b16 v[40:41], v5 offset:2048
  v_mfma_f32_16x16x32_bf16 v[192:195], v[24:27], v[216:219], v[192:195]
  ds_read_b64_tr_b16 v[42:43], v5 offset:8192
  v_mfma_f32_16x16x32_bf16 v[196:199], v[24:27], v[220:223], v[196:199]
  ds_read_b64_tr_b16 v[24:25], v6 offset:2048
  v_mfma_f32_16x16x32_bf16 v[200:203], v[28:31], v[216:219], v[200:203]
  ds_read_b64_tr_b16 v[26:27], v6 offset:8192
  v_mfma_f32_16x16x32_bf16 v[204:207], v[28:31], v[220:223], v[204:207]
  s_waitcnt lgkmcnt(5)
  ds_read_b64_tr_b16 v[28:29], v3 offset:24576
  v_mfma_f32_16x16x32_bf16 v[176:179], v[32:35], v[224:227], v[176:179]
  ds_read_b64_tr_b16 v[30:31], v3 offset:30720
  v_mfma_f32_16x16x32_bf16 v[180:183], v[32:35], v[228:231], v[180:183]
  ds_read_b64_tr_b16 v[32:33], v4 offset:24576
  v_mfma_f32_16x16x32_bf16 v[184:187], v[36:39], v[224:227], v[184:187]
  ds_read_b64_tr_b16 v[34:35], v4 offset:30720
  v_mfma_f32_16x16x32_bf16 v[188:191], v[36:39], v[228:231], v[188:191]
  s_waitcnt lgkmcnt(4)
  ds_read_b64_tr_b16 v[36:37], v5 offset:24576
  v_mfma_f32_16x16x32_bf16 v[192:195], v[40:43], v[224:227], v[192:195]
  ds_read_b64_tr_b16 v[38:39], v5 offset:30720
  v_mfma_f32_16x16x32_bf16 v[196:199], v[40:43], v[228:231], v[196:199]
  ds_read_b64_tr_b16 v[40:41], v6 offset:24576
  v_mfma_f32_16x16x32_bf16 v[200:203], v[24:27], v[224:227], v[200:203]
  s_mov_b32 exec_lo, 0xf0
  s_mov_b32 exec_hi, 0x0
  buffer_load_dwordx2 v[18:19], v47, s[16:19], s52 offen sc1
  s_mov_b64 exec, -1
  ds_read_b64_tr_b16 v[42:43], v6 offset:30720
  v_mfma_f32_16x16x32_bf16 v[204:207], v[24:27], v[228:231], v[204:207]
  s_waitcnt vmcnt(1)
  s_barrier
  s_waitcnt lgkmcnt(4)
  ds_read_b64_tr_b16 v[24:25], v3 offset:25600
  v_mfma_f32_16x16x32_bf16 v[176:179], v[28:31], v[232:235], v[176:179]
  ds_read_b128 v[156:159], v9 offset:49152
  ds_read_b128 v[168:171], v9 offset:50176
  ds_read_b64_tr_b16 v[26:27], v3 offset:31744
  v_mfma_f32_16x16x32_bf16 v[180:183], v[28:31], v[236:239], v[180:183]
  ds_read_b128 v[172:175], v9 offset:51200
  ds_read_b64_tr_b16 v[28:29], v4 offset:25600
  v_mfma_f32_16x16x32_bf16 v[184:187], v[32:35], v[232:235], v[184:187]
  s_waitcnt lgkmcnt(1)
  ds_read_b64_tr_b16 v[30:31], v4 offset:31744
  v_mfma_f32_16x16x32_bf16 v[188:191], v[32:35], v[236:239], v[188:191]
  v_add_f32 v148, v148, v156
  v_add_f32 v149, v149, v157
  ds_read_b64_tr_b16 v[32:33], v5 offset:25600
  v_mfma_f32_16x16x32_bf16 v[192:195], v[36:39], v[232:235], v[192:195]
  v_add_f32 v150, v150, v158
  v_add_f32 v151, v151, v159
  ds_read_b64_tr_b16 v[34:35], v5 offset:31744
  v_mfma_f32_16x16x32_bf16 v[196:199], v[36:39], v[236:239], v[196:199]
  v_cvt_pk_bf16_f32 v126, v148, v149
  v_cvt_pk_bf16_f32 v156, v150, v151
  ds_read_b64_tr_b16 v[36:37], v6 offset:25600
  v_mfma_f32_16x16x32_bf16 v[200:203], v[40:43], v[232:235], v[200:203]
  v_mov_b32 v159, s31
  buffer_store_dwordx4 v[124:127], v0, s[16:19], s78 offen offset:0 sc1
  ds_read_b64_tr_b16 v[38:39], v6 offset:31744
  v_mfma_f32_16x16x32_bf16 v[204:207], v[40:43], v[236:239], v[204:207]
  v_add_f32 v160, v160, v168
  v_add_f32 v161, v161, v169
  s_waitcnt lgkmcnt(4)
  ds_read_b64_tr_b16 v[40:41], v3 offset:26624
  v_mfma_f32_16x16x32_bf16 v[176:179], v[24:27], v[240:243], v[176:179]
  v_add_f32 v162, v162, v170
  v_add_f32 v163, v163, v171
  ds_read_b64_tr_b16 v[42:43], v3 offset:32768
  v_mfma_f32_16x16x32_bf16 v[180:183], v[24:27], v[244:247], v[180:183]
  v_cvt_pk_bf16_f32 v138, v160, v161
  v_cvt_pk_bf16_f32 v168, v162, v163
  ds_read_b64_tr_b16 v[24:25], v4 offset:26624
  v_mfma_f32_16x16x32_bf16 v[184:187], v[28:31], v[240:243], v[184:187]
  v_mov_b32 v171, s31
  buffer_store_dwordx4 v[136:139], v0, s[16:19], s79 offen offset:0 sc1
  ds_read_b64_tr_b16 v[26:27], v4 offset:32768
  v_mfma_f32_16x16x32_bf16 v[188:191], v[28:31], v[244:247], v[188:191]
  v_add_f32 v164, v164, v172
  v_add_f32 v165, v165, v173
  s_waitcnt lgkmcnt(4)
  ds_read_b64_tr_b16 v[28:29], v5 offset:26624
  v_mfma_f32_16x16x32_bf16 v[192:195], v[32:35], v[240:243], v[192:195]
  v_add_f32 v166, v166, v174
  v_add_f32 v167, v167, v175
  ds_read_b64_tr_b16 v[30:31], v5 offset:32768
  v_mfma_f32_16x16x32_bf16 v[196:199], v[32:35], v[244:247], v[196:199]
  v_cvt_pk_bf16_f32 v142, v164, v165
  v_cvt_pk_bf16_f32 v172, v166, v167
  ds_read_b64_tr_b16 v[32:33], v6 offset:26624
  v_mfma_f32_16x16x32_bf16 v[200:203], v[36:39], v[240:243], v[200:203]
  v_mov_b32 v175, s31
  buffer_store_dwordx4 v[140:143], v0, s[16:19], s74 offen offset:0 sc1
  ds_read_b64_tr_b16 v[34:35], v6 offset:32768
  v_mfma_f32_16x16x32_bf16 v[204:207], v[36:39], v[244:247], v[204:207]
  s_waitcnt lgkmcnt(4)
  ds_read_b64_tr_b16 v[36:37], v45 offset:0
  v_mfma_f32_16x16x32_bf16 v[176:179], v[40:43], v[248:251], v[176:179]
  ds_read_b64_tr_b16 v[38:39], v45 offset:6144
  v_mfma_f32_16x16x32_bf16 v[180:183], v[40:43], v[252:255], v[180:183]
  ds_read_b64_tr_b16 v[40:41], v45 offset:1024
  v_mfma_f32_16x16x32_bf16 v[184:187], v[24:27], v[248:251], v[184:187]
  ds_read_b64_tr_b16 v[42:43], v45 offset:7168
  v_mfma_f32_16x16x32_bf16 v[188:191], v[24:27], v[252:255], v[188:191]
  s_waitcnt lgkmcnt(4)
  ds_read_b64_tr_b16 v[24:25], v45 offset:2048
  v_mfma_f32_16x16x32_bf16 v[192:195], v[28:31], v[248:251], v[192:195]
  ds_read_b64_tr_b16 v[26:27], v45 offset:8192
  v_mfma_f32_16x16x32_bf16 v[196:199], v[28:31], v[252:255], v[196:199]
  ds_read_b64_tr_b16 v[28:29], v23 offset:0
  v_mfma_f32_16x16x32_bf16 v[200:203], v[32:35], v[248:251], v[200:203]
  ds_read_b64_tr_b16 v[30:31], v23 offset:6144
  v_mfma_f32_16x16x32_bf16 v[204:207], v[32:35], v[252:255], v[204:207]
  s_barrier
  s_waitcnt vmcnt(3)
  v_cmp_eq_u32 vcc, s30, v18
  v_cmp_eq_u32 s[46:47], s31, v19
  s_nop 0
  s_and_b32 vcc_lo, vcc_lo, s46
  s_andn2_b32 s43, 224, s53
  s_and_b32 s43, s43, vcc_lo
  s_or_b32 s53, s53, s43
  s_waitcnt lgkmcnt(4)
  ds_read_b64_tr_b16 v[32:33], v23 offset:1024
  v_mfma_f32_16x16x32_bf16 v[200:203], v[36:39], v[48:51], v[200:203]
  buffer_load_dwordx2 v[230:231], v13, s[20:23], s86 offen offset:0
  ds_read_b64_tr_b16 v[34:35], v23 offset:7168
  v_mfma_f32_16x16x32_bf16 v[204:207], v[36:39], v[52:55], v[204:207]
  ds_read_b64_tr_b16 v[36:37], v23 offset:2048
  v_mfma_f32_16x16x32_bf16 v[200:203], v[40:43], v[56:59], v[200:203]
  buffer_load_dwordx2 v[232:233], v13, s[20:23], s86 offen offset:128
  ds_read_b64_tr_b16 v[38:39], v23 offset:8192
  v_mfma_f32_16x16x32_bf16 v[204:207], v[40:43], v[60:63], v[204:207]
  s_waitcnt lgkmcnt(4)
  ds_read_b64_tr_b16 v[40:41], v8 offset:0
  v_mfma_f32_16x16x32_bf16 v[200:203], v[24:27], v[64:67], v[200:203]
  buffer_load_dwordx2 v[234:235], v13, s[20:23], s86 offen offset:256
  ds_read_b64_tr_b16 v[42:43], v8 offset:6144
  v_mfma_f32_16x16x32_bf16 v[204:207], v[24:27], v[68:71], v[204:207]
  ds_read_b64_tr_b16 v[24:25], v8 offset:1024
  v_mfma_f32_16x16x32_bf16 v[200:203], v[28:31], v[72:75], v[200:203]
  s_bitcmp1_b32 s43, 5
  s_cselect_b64 exec, -1, 0
  buffer_load_dwordx3 v[104:106], v12, s[16:19], s85 offen offset:0 sc1
  buffer_load_dwordx3 v[108:110], v12, s[16:19], s85 offen offset:1024 sc1
  s_mov_b64 exec, -1
  ds_read_b64_tr_b16 v[26:27], v8 offset:7168
  v_mfma_f32_16x16x32_bf16 v[204:207], v[28:31], v[76:79], v[204:207]
  s_waitcnt lgkmcnt(4)
  ds_read_b64_tr_b16 v[28:29], v8 offset:2048
  v_mfma_f32_16x16x32_bf16 v[200:203], v[32:35], v[80:83], v[200:203]
  ds_read_b64_tr_b16 v[30:31], v8 offset:8192
  v_mfma_f32_16x16x32_bf16 v[204:207], v[32:35], v[84:87], v[204:207]
  ds_write_b128 v1, v[120:123] offset:0
  ds_read_b64_tr_b16 v[32:33], v21 offset:0
  v_mfma_f32_16x16x32_bf16 v[200:203], v[36:39], v[88:91], v[200:203]
  ds_read_b64_tr_b16 v[34:35], v21 offset:6144
  v_mfma_f32_16x16x32_bf16 v[204:207], v[36:39], v[92:95], v[204:207]
  ds_write_b128 v1, v[152:155] offset:1024
  s_waitcnt lgkmcnt(6)
  ds_read_b64_tr_b16 v[36:37], v21 offset:1024
  v_mfma_f32_16x16x32_bf16 v[184:187], v[40:43], v[48:51], v[184:187]
  ds_read_b64_tr_b16 v[38:39], v21 offset:7168
  v_mfma_f32_16x16x32_bf16 v[188:191], v[40:43], v[52:55], v[188:191]
  ds_read_b64_tr_b16 v[40:41], v21 offset:2048
  v_mfma_f32_16x16x32_bf16 v[184:187], v[24:27], v[56:59], v[184:187]
  s_bitcmp1_b32 s43, 6
  s_cselect_b64 exec, -1, 0
  buffer_load_dwordx3 v[208:210], v12, s[16:19], s88 offen offset:0 sc1
  buffer_load_dwordx3 v[212:214], v12, s[16:19], s88 offen offset:1024 sc1
  s_mov_b64 exec, -1
  ds_read_b64_tr_b16 v[42:43], v21 offset:8192
  v_mfma_f32_16x16x32_bf16 v[188:191], v[24:27], v[60:63], v[188:191]
  s_waitcnt lgkmcnt(5)
  ds_read_b64_tr_b16 v[24:25], v44 offset:0
  v_mfma_f32_16x16x32_bf16 v[184:187], v[28:31], v[64:67], v[184:187]
  ds_read_b64_tr_b16 v[26:27], v44 offset:6144
  v_mfma_f32_16x16x32_bf16 v[188:191], v[28:31], v[68:71], v[188:191]
  ds_write_b128 v1, v[200:203] offset:50176
  ds_read_b64_tr_b16 v[28:29], v44 offset:1024
  v_mfma_f32_16x16x32_bf16 v[184:187], v[32:35], v[72:75], v[184:187]
  ds_read_b64_tr_b16 v[30:31], v44 offset:7168
  v_mfma_f32_16x16x32_bf16 v[188:191], v[32:35], v[76:79], v[188:191]
  ds_write_b128 v1, v[204:207] offset:51200
  s_waitcnt lgkmcnt(6)
  ds_read_b64_tr_b16 v[32:33], v44 offset:2048
  v_mfma_f32_16x16x32_bf16 v[184:187], v[36:39], v[80:83], v[184:187]
  s_bitcmp1_b32 s43, 7
  s_cselect_b64 exec, -1, 0
  buffer_load_dwordx3 v[216:218], v12, s[16:19], s89 offen offset:0 sc1
  buffer_load_dwordx3 v[220:222], v12, s[16:19], s89 offen offset:1024 sc1
  s_mov_b64 exec, -1
  ds_read_b64_tr_b16 v[34:35], v44 offset:8192
  v_mfma_f32_16x16x32_bf16 v[188:191], v[36:39], v[84:87], v[188:191]
  ds_read_b64_tr_b16 v[36:37], v22 offset:0
  v_mfma_f32_16x16x32_bf16 v[184:187], v[40:43], v[88:91], v[184:187]
  ds_read_b64_tr_b16 v[38:39], v22 offset:6144
  v_mfma_f32_16x16x32_bf16 v[188:191], v[40:43], v[92:95], v[188:191]
  s_waitcnt lgkmcnt(4)
  s_barrier
  ds_read_b64_tr_b16 v[40:41], v22 offset:1024
  v_mfma_f32_16x16x32_bf16 v[192:195], v[24:27], v[48:51], v[192:195]
  ds_read_b64_tr_b16 v[42:43], v22 offset:7168
  v_mfma_f32_16x16x32_bf16 v[196:199], v[24:27], v[52:55], v[196:199]
  ds_read_b128 v[200:203], v9 offset:50176
  ds_read_b128 v[204:207], v9 offset:51200
  ds_read_b64_tr_b16 v[24:25], v22 offset:2048
  v_mfma_f32_16x16x32_bf16 v[192:195], v[28:31], v[56:59], v[192:195]
  buffer_load_dwordx4 v[116:119], v0, s[16:19], s75 offen offset:0 sc1
  ds_read_b64_tr_b16 v[26:27], v22 offset:8192
  v_mfma_f32_16x16x32_bf16 v[196:199], v[28:31], v[60:63], v[196:199]
  ds_write_b128 v1, v[188:191] offset:49152
  s_waitcnt lgkmcnt(7)
  ds_read_b64_tr_b16 v[28:29], v7 offset:0
  v_mfma_f32_16x16x32_bf16 v[192:195], v[32:35], v[64:67], v[192:195]
  ds_read_b64_tr_b16 v[30:31], v7 offset:6144
  v_mfma_f32_16x16x32_bf16 v[196:199], v[32:35], v[68:71], v[196:199]
  ds_write_b128 v1, v[184:187] offset:2048
  ds_read_b64_tr_b16 v[32:33], v7 offset:1024
  v_mfma_f32_16x16x32_bf16 v[192:195], v[36:39], v[72:75], v[192:195]
  buffer_load_dwordx4 v[128:131], v0, s[16:19], s62 offen offset:0 sc1
  ds_read_b64_tr_b16 v[34:35], v7 offset:7168
  v_mfma_f32_16x16x32_bf16 v[196:199], v[36:39], v[76:79], v[196:199]
  ds_read_b128 v[120:123], v9 offset:0
  ds_read_b128 v[152:155], v9 offset:1024
  s_waitcnt lgkmcnt(8)
  ds_read_b64_tr_b16 v[36:37], v7 offset:2048
  v_mfma_f32_16x16x32_bf16 v[192:195], v[40:43], v[80:83], v[192:195]
  ds_read_b64_tr_b16 v[38:39], v7 offset:8192
  v_mfma_f32_16x16x32_bf16 v[196:199], v[40:43], v[84:87], v[196:199]
  ds_read_b64_tr_b16 v[40:41], v20 offset:0
  v_mfma_f32_16x16x32_bf16 v[192:195], v[24:27], v[88:91], v[192:195]
  buffer_load_dwordx4 v[132:135], v0, s[16:19], s63 offen offset:0 sc1
  ds_read_b64_tr_b16 v[42:43], v20 offset:6144
  v_mfma_f32_16x16x32_bf16 v[196:199], v[24:27], v[92:95], v[196:199]
  s_waitcnt lgkmcnt(8)
  s_barrier
  ds_read_b128 v[188:191], v9 offset:49152
  ds_read_b128 v[184:187], v9 offset:2048
  s_waitcnt lgkmcnt(8)
  ds_read_b64_tr_b16 v[24:25], v20 offset:1024
  v_mfma_f32_16x16x32_bf16 v[176:179], v[28:31], v[48:51], v[176:179]
  ds_read_b64_tr_b16 v[26:27], v20 offset:7168
  v_mfma_f32_16x16x32_bf16 v[180:183], v[28:31], v[52:55], v[180:183]
  ds_read_b64_tr_b16 v[28:29], v20 offset:2048
  v_mfma_f32_16x16x32_bf16 v[176:179], v[32:35], v[56:59], v[176:179]
  v_add_f32 v192, v192, v200
  v_add_f32 v193, v193, v201
  ds_read_b64_tr_b16 v[30:31], v20 offset:8192
  v_mfma_f32_16x16x32_bf16 v[180:183], v[32:35], v[60:63], v[180:183]
  v_add_f32 v194, v194, v202
  v_add_f32 v195, v195, v203
  s_waitcnt lgkmcnt(6)
  v_mfma_f32_16x16x32_bf16 v[176:179], v[36:39], v[64:67], v[176:179]
  v_cvt_pk_bf16_f32 v169, v192, v193
  v_cvt_pk_bf16_f32 v170, v194, v195
  v_mfma_f32_16x16x32_bf16 v[180:183], v[36:39], v[68:71], v[180:183]
  buffer_store_dwordx4 v[168:171], v0, s[16:19], s79 offen offset:1024 sc1
  v_add_f32 v196, v196, v204
  v_mfma_f32_16x16x32_bf16 v[176:179], v[40:43], v[72:75], v[176:179]
  v_add_f32 v197, v197, v205
  v_add_f32 v198, v198, v206
  v_mfma_f32_16x16x32_bf16 v[180:183], v[40:43], v[76:79], v[180:183]
  v_add_f32 v199, v199, v207
  v_cvt_pk_bf16_f32 v173, v196, v197
  s_waitcnt lgkmcnt(0)
  v_mfma_f32_16x16x32_bf16 v[176:179], v[24:27], v[80:83], v[176:179]
  v_cvt_pk_bf16_f32 v174, v198, v199
  buffer_store_dwordx4 v[172:175], v0, s[16:19], s74 offen offset:1024 sc1
  v_mfma_f32_16x16x32_bf16 v[180:183], v[24:27], v[84:87], v[180:183]
  v_mfma_f32_16x16x32_bf16 v[176:179], v[28:31], v[88:91], v[176:179]
  v_mfma_f32_16x16x32_bf16 v[180:183], v[28:31], v[92:95], v[180:183]
  s_nop 7
  v_add_f32 v180, v180, v188
  v_add_f32 v181, v181, v189
  v_add_f32 v182, v182, v190
  v_add_f32 v183, v183, v191
  v_cvt_pk_bf16_f32 v157, v180, v181
  v_cvt_pk_bf16_f32 v158, v182, v183
  buffer_store_dwordx4 v[156:159], v0, s[16:19], s78 offen offset:1024 sc1
  s_mov_b32 exec_lo, 0xf0
  s_mov_b32 exec_hi, 0x0
  buffer_load_dwordx2 v[18:19], v47, s[16:19], s52 offen sc1
  s_mov_b64 exec, -1
  s_waitcnt vmcnt(7)
  v_and_b32 v14, 0xf0, v0
  v_mul_u32_u24 v15, 12, v14
  v_add3_u32 v15, v15, v13, s3
  ds_read_b64 v[54:55], v15 offset:0
  ds_read_b64 v[56:57], v15 offset:64
  ds_read_b64 v[58:59], v15 offset:128
  v_and_b32 v16, 0xc0, v0
  v_add_u32 v14, v14, v16
  v_mul_u32_u24 v14, 144, v14
  v_lshl_add_u32 v78, v13, 1, v14
  v_rcp_f32 v79, v11
  v_add_f32 v112, v112, v120
  v_add_f32 v113, v113, v121
  v_add_f32 v114, v114, v122
  v_add_f32 v115, v115, v123
  v_add_f32 v144, v144, v152
  v_add_f32 v145, v145, v153
  v_add_f32 v146, v146, v154
  v_add_f32 v147, v147, v155
  v_add_f32 v176, v176, v184
  v_add_f32 v177, v177, v185
  v_add_f32 v178, v178, v186
  v_add_f32 v179, v179, v187
  v_lshlrev_b32 v224, 16, v230
  v_and_b32 v225, 0xffff0000, v230
  v_lshlrev_b32 v226, 16, v231
  v_and_b32 v227, 0xffff0000, v231
  v_lshlrev_b32 v228, 16, v232
  v_and_b32 v229, 0xffff0000, v232
  v_lshlrev_b32 v230, 16, v233
  v_and_b32 v231, 0xffff0000, v233
  v_lshlrev_b32 v232, 16, v234
  v_and_b32 v233, 0xffff0000, v234
  v_lshlrev_b32 v234, 16, v235
  v_and_b32 v235, 0xffff0000, v235
  s_waitcnt lgkmcnt(0)
  v_lshlrev_b32 v48, 16, v54
  v_and_b32 v49, 0xffff0000, v54
  v_lshlrev_b32 v50, 16, v55
  v_and_b32 v51, 0xffff0000, v55
  v_lshlrev_b32 v52, 16, v56
  v_and_b32 v53, 0xffff0000, v56
  v_lshlrev_b32 v54, 16, v57
  v_and_b32 v55, 0xffff0000, v57
  v_lshlrev_b32 v56, 16, v58
  v_and_b32 v57, 0xffff0000, v58
  v_lshlrev_b32 v58, 16, v59
  v_and_b32 v59, 0xffff0000, v59
  v_sub_f32 v60, v48, v46
  v_sub_f32 v61, v49, v46
  v_sub_f32 v62, v50, v46
  v_sub_f32 v63, v51, v46
  v_sub_f32 v64, v52, v46
  v_sub_f32 v65, v53, v46
  v_sub_f32 v66, v54, v46
  v_sub_f32 v67, v55, v46
  v_sub_f32 v68, v56, v46
  v_sub_f32 v69, v57, v46
  v_sub_f32 v70, v58, v46
  v_sub_f32 v71, v59, v46
  v_cvt_pk_bf16_f32 v72, v60, v61
  v_cvt_pk_bf16_f32 v73, v62, v63
  v_cvt_pk_bf16_f32 v74, v64, v65
  v_cvt_pk_bf16_f32 v75, v66, v67
  v_cvt_pk_bf16_f32 v76, v68, v69
  v_cvt_pk_bf16_f32 v77, v70, v71
  v_lshlrev_b32 v60, 16, v72
  v_and_b32 v61, 0xffff0000, v72
  v_lshlrev_b32 v62, 16, v73
  v_and_b32 v63, 0xffff0000, v73
  v_lshlrev_b32 v64, 16, v74
  v_and_b32 v65, 0xffff0000, v74
  v_lshlrev_b32 v66, 16, v75
  v_and_b32 v67, 0xffff0000, v75
  v_lshlrev_b32 v68, 16, v76
  v_and_b32 v69, 0xffff0000, v76
  v_lshlrev_b32 v70, 16, v77
  v_and_b32 v71, 0xffff0000, v77
  v_mul_f32 v60, v60, v79
  v_mul_f32 v61, v61, v79
  v_mul_f32 v62, v62, v79
  v_mul_f32 v63, v63, v79
  v_mul_f32 v64, v64, v79
  v_mul_f32 v65, v65, v79
  v_mul_f32 v66, v66, v79
  v_mul_f32 v67, v67, v79
  v_mul_f32 v68, v68, v79
  v_mul_f32 v69, v69, v79
  v_mul_f32 v70, v70, v79
  v_mul_f32 v71, v71, v79
  v_cvt_pk_bf16_f32 v72, v60, v61
  v_cvt_pk_bf16_f32 v73, v62, v63
  v_cvt_pk_bf16_f32 v74, v64, v65
  v_cvt_pk_bf16_f32 v75, v66, v67
  v_cvt_pk_bf16_f32 v76, v68, v69
  v_cvt_pk_bf16_f32 v77, v70, v71
  v_lshlrev_b32 v60, 16, v72
  v_and_b32 v61, 0xffff0000, v72
  v_lshlrev_b32 v62, 16, v73
  v_and_b32 v63, 0xffff0000, v73
  v_lshlrev_b32 v64, 16, v74
  v_and_b32 v65, 0xffff0000, v74
  v_lshlrev_b32 v66, 16, v75
  v_and_b32 v67, 0xffff0000, v75
  v_lshlrev_b32 v68, 16, v76
  v_and_b32 v69, 0xffff0000, v76
  v_lshlrev_b32 v70, 16, v77
  v_and_b32 v71, 0xffff0000, v77
  v_mul_f32 v224, v224, v60
  v_mul_f32 v225, v225, v61
  v_mul_f32 v226, v226, v62
  v_mul_f32 v227, v227, v63
  v_mul_f32 v228, v228, v64
  v_mul_f32 v229, v229, v65
  v_mul_f32 v230, v230, v66
  v_mul_f32 v231, v231, v67
  v_mul_f32 v232, v232, v68
  v_mul_f32 v233, v233, v69
  v_mul_f32 v234, v234, v70
  v_mul_f32 v235, v235, v71
  v_cvt_pk_bf16_f32 v72, v224, v225
  v_cvt_pk_bf16_f32 v73, v226, v227
  v_cvt_pk_bf16_f32 v74, v228, v229
  v_cvt_pk_bf16_f32 v75, v230, v231
  v_cvt_pk_bf16_f32 v76, v232, v233
  v_cvt_pk_bf16_f32 v77, v234, v235
  v_lshlrev_b32 v224, 16, v72
  v_and_b32 v225, 0xffff0000, v72
  v_lshlrev_b32 v226, 16, v73
  v_and_b32 v227, 0xffff0000, v73
  v_lshlrev_b32 v228, 16, v74
  v_and_b32 v229, 0xffff0000, v74
  v_lshlrev_b32 v230, 16, v75
  v_and_b32 v231, 0xffff0000, v75
  v_lshlrev_b32 v232, 16, v76
  v_and_b32 v233, 0xffff0000, v76
  v_lshlrev_b32 v234, 16, v77
  v_and_b32 v235, 0xffff0000, v77
  s_mov_b32 s56, 0x80000
  s_waitcnt vmcnt(0)
  v_cmp_eq_u32 vcc, s30, v18
  v_cmp_eq_u32 s[46:47], s31, v19
  s_nop 0
  s_and_b32 vcc_lo, vcc_lo, s46
  s_andn2_b32 s43, 0xf0, s53
  s_and_b32 s43, s43, vcc_lo
  s_or_b32 s53, s53, s43
  s_bitcmp1_b32 s43, 4
  s_cselect_b64 exec, -1, 0
  buffer_load_dwordx3 v[96:98], v12, s[16:19], s84 offen offset:0 sc1
  buffer_load_dwordx3 v[100:102], v12, s[16:19], s84 offen offset:1024 sc1
  s_bitcmp1_b32 s43, 5
  s_cselect_b64 exec, -1, 0
  buffer_load_dwordx3 v[104:106], v12, s[16:19], s85 offen offset:0 sc1
  buffer_load_dwordx3 v[108:110], v12, s[16:19], s85 offen offset:1024 sc1
  s_bitcmp1_b32 s43, 6
  s_cselect_b64 exec, -1, 0
  buffer_load_dwordx3 v[208:210], v12, s[16:19], s88 offen offset:0 sc1
  buffer_load_dwordx3 v[212:214], v12, s[16:19], s88 offen offset:1024 sc1
  s_bitcmp1_b32 s43, 7
  s_cselect_b64 exec, -1, 0
  buffer_load_dwordx3 v[216:218], v12, s[16:19], s89 offen offset:0 sc1
  buffer_load_dwordx3 v[220:222], v12, s[16:19], s89 offen offset:1024 sc1
  s_mov_b64 exec, -1
  s_waitcnt vmcnt(3)
L_g0_top:
  v_cmp_ne_u32 vcc, s30, v119
  v_cmp_ne_u32 s[46:47], s30, v131
  v_cmp_ne_u32 s[48:49], s30, v135
  s_or_b64 vcc, vcc, s[46:47]
  s_or_b64 vcc, vcc, s[48:49]
  s_cbranch_scc1 L_g0_again
L_g0_done:
  v_dot2_f32_bf16 v112, v116, s50, v112
  v_dot2_f32_bf16 v113, v116, s51, v113
  v_dot2_f32_bf16 v114, v117, s50, v114
  v_dot2_f32_bf16 v115, v117, s51, v115
  v_dot2_f32_bf16 v144, v118, s50, v144
  v_dot2_f32_bf16 v145, v118, s51, v145
  v_dot2_f32_bf16 v112, v128, s50, v112
  v_dot2_f32_bf16 v113, v128, s51, v113
  v_dot2_f32_bf16 v114, v129, s50, v114
  v_dot2_f32_bf16 v115, v129, s51, v115
  v_dot2_f32_bf16 v144, v130, s50, v144
  v_dot2_f32_bf16 v145, v130, s51, v145
  v_dot2_f32_bf16 v112, v132, s50, v112
  v_dot2_f32_bf16 v113, v132, s51, v113
  v_dot2_f32_bf16 v114, v133, s50, v114
  v_dot2_f32_bf16 v115, v133, s51, v115
  v_dot2_f32_bf16 v144, v134, s50, v144
  v_dot2_f32_bf16 v145, v134, s51, v145
  v_mul_f32 v60, 0xbfb8aa3b, v112
  v_mul_f32 v61, 0xbfb8aa3b, v113
  v_mul_f32 v62, 0xbfb8aa3b, v114
  v_mul_f32 v63, 0xbfb8aa3b, v115
  v_mul_f32 v64, 0xbfb8aa3b, v144
  v_mul_f32 v65, 0xbfb8aa3b, v145
  v_exp_f32 v60, v60
  v_exp_f32 v61, v61
  v_exp_f32 v62, v62
  v_exp_f32 v63, v63
  v_exp_f32 v64, v64
  v_exp_f32 v65, v65
  v_add_f32 v60, 1.0, v60
  v_add_f32 v61, 1.0, v61
  v_add_f32 v62, 1.0, v62
  v_add_f32 v63, 1.0, v63
  v_add_f32 v64, 1.0, v64
  v_add_f32 v65, 1.0, v65
  v_rcp_f32 v60, v60
  v_rcp_f32 v61, v61
  v_rcp_f32 v62, v62
  v_rcp_f32 v63, v63
  v_rcp_f32 v64, v64
  v_rcp_f32 v65, v65
  buffer_load_dwordx4 v[148:151], v0, s[16:19], s75 offen offset:1024 sc1
  buffer_load_dwordx4 v[160:163], v0, s[16:19], s62 offen offset:1024 sc1
  buffer_load_dwordx4 v[164:167], v0, s[16:19], s63 offen offset:1024 sc1
  s_cmp_eq_u32 s53, 0xf0
  s_cbranch_scc0 L_late_y
  s_waitcnt vmcnt(3)
  v_dot2_f32_bf16 v224, v96, s50, v224
  v_dot2_f32_bf16 v225, v96, s51, v225
  v_dot2_f32_bf16 v226, v97, s50, v226
  v_dot2_f32_bf16 v227, v97, s51, v227
  v_dot2_f32_bf16 v228, v98, s50, v228
  v_dot2_f32_bf16 v229, v98, s51, v229
  v_dot2_f32_bf16 v230, v100, s50, v230
  v_dot2_f32_bf16 v231, v100, s51, v231
  v_dot2_f32_bf16 v232, v101, s50, v232
  v_dot2_f32_bf16 v233, v101, s51, v233
  v_dot2_f32_bf16 v234, v102, s50, v234
  v_dot2_f32_bf16 v235, v102, s51, v235
  v_dot2_f32_bf16 v224, v104, s50, v224
  v_dot2_f32_bf16 v225, v104, s51, v225
  v_dot2_f32_bf16 v226, v105, s50, v226
  v_dot2_f32_bf16 v227, v105, s51, v227
  v_dot2_f32_bf16 v228, v106, s50, v228
  v_dot2_f32_bf16 v229, v106, s51, v229
  v_dot2_f32_bf16 v230, v108, s50, v230
  v_dot2_f32_bf16 v231, v108, s51, v231
  v_dot2_f32_bf16 v232, v109, s50, v232
  v_dot2_f32_bf16 v233, v109, s51, v233
  v_dot2_f32_bf16 v234, v110, s50, v234
  v_dot2_f32_bf16 v235, v110, s51, v235
  v_dot2_f32_bf16 v224, v208, s50, v224
  v_dot2_f32_bf16 v225, v208, s51, v225
  v_dot2_f32_bf16 v226, v209, s50, v226
  v_dot2_f32_bf16 v227, v209, s51, v227
  v_dot2_f32_bf16 v228, v210, s50, v228
  v_dot2_f32_bf16 v229, v210, s51, v229
  v_dot2_f32_bf16 v230, v212, s50, v230
  v_dot2_f32_bf16 v231, v212, s51, v231
  v_dot2_f32_bf16 v232, v213, s50, v232
  v_dot2_f32_bf16 v233, v213, s51, v233
  v_dot2_f32_bf16 v234, v214, s50, v234
  v_dot2_f32_bf16 v235, v214, s51, v235
  v_dot2_f32_bf16 v224, v216, s50, v224
  v_dot2_f32_bf16 v225, v216, s51, v225
  v_dot2_f32_bf16 v226, v217, s50, v226
  v_dot2_f32_bf16 v227, v217, s51, v227
  v_dot2_f32_bf16 v228, v218, s50, v228
  v_dot2_f32_bf16 v229, v218, s51, v229
  v_dot2_f32_bf16 v230, v220, s50, v230
  v_dot2_f32_bf16 v231, v220, s51, v231
  v_dot2_f32_bf16 v232, v221, s50, v232
  v_dot2_f32_bf16 v233, v221, s51, v233
  v_dot2_f32_bf16 v234, v222, s50, v234
  v_dot2_f32_bf16 v235, v222, s51, v235
  v_mul_f32 v112, v112, v224
  v_mul_f32 v113, v113, v225
  v_mul_f32 v114, v114, v226
  v_mul_f32 v115, v115, v227
  v_mul_f32 v144, v144, v228
  v_mul_f32 v145, v145, v229
  v_fma_f32 v48, v112, v60, v48
  v_fma_f32 v49, v113, v61, v49
  v_fma_f32 v50, v114, v62, v50
  v_fma_f32 v51, v115, v63, v51
  buffer_store_dwordx4 v[48:51], v78, s[4:7], s87 offen offset:0 sc1
  v_fma_f32 v52, v144, v64, v52
  v_fma_f32 v53, v145, v65, v53
  s_waitcnt vmcnt(1)
L_g1_top:
  v_cmp_ne_u32 vcc, s31, v151
  v_cmp_ne_u32 s[46:47], s31, v163
  v_cmp_ne_u32 s[48:49], s31, v167
  s_or_b64 vcc, vcc, s[46:47]
  s_or_b64 vcc, vcc, s[48:49]
  s_cbranch_scc1 L_g1_again
L_g1_done:
  v_dot2_f32_bf16 v146, v148, s50, v146
  v_dot2_f32_bf16 v147, v148, s51, v147
  v_dot2_f32_bf16 v176, v149, s50, v176
  v_dot2_f32_bf16 v177, v149, s51, v177
  v_dot2_f32_bf16 v178, v150, s50, v178
  v_dot2_f32_bf16 v179, v150, s51, v179
  v_dot2_f32_bf16 v146, v160, s50, v146
  v_dot2_f32_bf16 v147, v160, s51, v147
  v_dot2_f32_bf16 v176, v161, s50, v176
  v_dot2_f32_bf16 v177, v161, s51, v177
  v_dot2_f32_bf16 v178, v162, s50, v178
  v_dot2_f32_bf16 v179, v162, s51, v179
  v_dot2_f32_bf16 v146, v164, s50, v146
  v_dot2_f32_bf16 v147, v164, s51, v147
  v_dot2_f32_bf16 v176, v165, s50, v176
  v_dot2_f32_bf16 v177, v165, s51, v177
  v_dot2_f32_bf16 v178, v166, s50, v178
  v_dot2_f32_bf16 v179, v166, s51, v179
  v_mul_f32 v66, 0xbfb8aa3b, v146
  v_mul_f32 v67, 0xbfb8aa3b, v147
  v_mul_f32 v68, 0xbfb8aa3b, v176
  v_mul_f32 v69, 0xbfb8aa3b, v177
  v_mul_f32 v70, 0xbfb8aa3b, v178
  v_mul_f32 v71, 0xbfb8aa3b, v179
  v_exp_f32 v66, v66
  v_exp_f32 v67, v67
  v_exp_f32 v68, v68
  v_exp_f32 v69, v69
  v_exp_f32 v70, v70
  v_exp_f32 v71, v71
  v_add_f32 v66, 1.0, v66
  v_add_f32 v67, 1.0, v67
  v_add_f32 v68, 1.0, v68
  v_add_f32 v69, 1.0, v69
  v_add_f32 v70, 1.0, v70
  v_add_f32 v71, 1.0, v71
  v_rcp_f32 v66, v66
  v_rcp_f32 v67, v67
  v_rcp_f32 v68, v68
  v_rcp_f32 v69, v69
  v_rcp_f32 v70, v70
  v_rcp_f32 v71, v71
  v_mul_f32 v146, v146, v230
  v_mul_f32 v147, v147, v231
  v_mul_f32 v176, v176, v232
  v_mul_f32 v177, v177, v233
  v_mul_f32 v178, v178, v234
  v_mul_f32 v179, v179, v235
  v_fma_f32 v54, v146, v66, v54
  v_fma_f32 v55, v147, v67, v55
  buffer_store_dwordx4 v[52:55], v78, s[4:7], s87 offen offset:256 sc1
  v_fma_f32 v56, v176, v68, v56
  v_fma_f32 v57, v177, v69, v57
  v_fma_f32 v58, v178, v70, v58
  v_fma_f32 v59, v179, v71, v59
  buffer_store_dwordx4 v[56:59], v78, s[4:7], s87 offen offset:512 sc1
  s_branch L_final
L_late_y:
  s_mov_b32 exec_lo, 0xf0
  s_mov_b32 exec_hi, 0x0
  buffer_load_dwordx2 v[18:19], v47, s[16:19], s52 offen sc1
  s_mov_b64 exec, -1
  s_waitcnt vmcnt(0)
L_g1b_top:
  v_cmp_ne_u32 vcc, s31, v151
  v_cmp_ne_u32 s[46:47], s31, v163
  v_cmp_ne_u32 s[48:49], s31, v167
  s_or_b64 vcc, vcc, s[46:47]
  s_or_b64 vcc, vcc, s[48:49]
  s_cbranch_scc1 L_g1b_again
L_g1b_done:
  v_dot2_f32_bf16 v146, v148, s50, v146
  v_dot2_f32_bf16 v147, v148, s51, v147
  v_dot2_f32_bf16 v176, v149, s50, v176
  v_dot2_f32_bf16 v177, v149, s51, v177
  v_dot2_f32_bf16 v178, v150, s50, v178
  v_dot2_f32_bf16 v179, v150, s51, v179
  v_dot2_f32_bf16 v146, v160, s50, v146
  v_dot2_f32_bf16 v147, v160, s51, v147
  v_dot2_f32_bf16 v176, v161, s50, v176
  v_dot2_f32_bf16 v177, v161, s51, v177
  v_dot2_f32_bf16 v178, v162, s50, v178
  v_dot2_f32_bf16 v179, v162, s51, v179
  v_dot2_f32_bf16 v146, v164, s50, v146
  v_dot2_f32_bf16 v147, v164, s51, v147
  v_dot2_f32_bf16 v176, v165, s50, v176
  v_dot2_f32_bf16 v177, v165, s51, v177
  v_dot2_f32_bf16 v178, v166, s50, v178
  v_dot2_f32_bf16 v179, v166, s51, v179
  v_cmp_eq_u32 vcc, s30, v18
  v_cmp_eq_u32 s[46:47], s31, v19
  s_nop 0
  s_and_b32 vcc_lo, vcc_lo, s46
  s_andn2_b32 s43, 0xf0, s53
  s_and_b32 s43, s43, vcc_lo
  s_or_b32 s53, s53, s43
  s_bitcmp1_b32 s43, 4
  s_cselect_b64 exec, -1, 0
  buffer_load_dwordx3 v[96:98], v12, s[16:19], s84 offen offset:0 sc1
  buffer_load_dwordx3 v[100:102], v12, s[16:19], s84 offen offset:1024 sc1
  s_bitcmp1_b32 s43, 5
  s_cselect_b64 exec, -1, 0
  buffer_load_dwordx3 v[104:106], v12, s[16:19], s85 offen offset:0 sc1
  buffer_load_dwordx3 v[108:110], v12, s[16:19], s85 offen offset:1024 sc1
  s_bitcmp1_b32 s43, 6
  s_cselect_b64 exec, -1, 0
  buffer_load_dwordx3 v[208:210], v12, s[16:19], s88 offen offset:0 sc1
  buffer_load_dwordx3 v[212:214], v12, s[16:19], s88 offen offset:1024 sc1
  s_bitcmp1_b32 s43, 7
  s_cselect_b64 exec, -1, 0
  buffer_load_dwordx3 v[216:218], v12, s[16:19], s89 offen offset:0 sc1
  buffer_load_dwordx3 v[220:222], v12, s[16:19], s89 offen offset:1024 sc1
  s_mov_b64 exec, -1
  v_mul_f32 v66, 0xbfb8aa3b, v146
  v_mul_f32 v67, 0xbfb8aa3b, v147
  v_mul_f32 v68, 0xbfb8aa3b, v176
  v_mul_f32 v69, 0xbfb8aa3b, v177
  v_mul_f32 v70, 0xbfb8aa3b, v178
  v_mul_f32 v71, 0xbfb8aa3b, v179
  v_exp_f32 v66, v66
  v_exp_f32 v67, v67
  v_exp_f32 v68, v68
  v_exp_f32 v69, v69
  v_exp_f32 v70, v70
  v_exp_f32 v71, v71
  v_add_f32 v66, 1.0, v66
  v_add_f32 v67, 1.0, v67
  v_add_f32 v68, 1.0, v68
  v_add_f32 v69, 1.0, v69
  v_add_f32 v70, 1.0, v70
  v_add_f32 v71, 1.0, v71
  v_rcp_f32 v66, v66
  v_rcp_f32 v67, v67
  v_rcp_f32 v68, v68
  v_rcp_f32 v69, v69
  v_rcp_f32 v70, v70
  v_rcp_f32 v71, v71
L_y_a:
  s_and_b32 s48, s53, 112
  s_cmp_eq_u32 s48, 112
  s_cbranch_scc1 L_y_a_done
  s_mov_b32 exec_lo, 0xf0
  s_mov_b32 exec_hi, 0x0
  buffer_load_dwordx2 v[18:19], v47, s[16:19], s52 offen sc1
  s_mov_b64 exec, -1
  s_sub_u32 s56, s56, 1
  s_waitcnt vmcnt(0)
  v_cmp_eq_u32 vcc, s30, v18
  v_cmp_eq_u32 s[46:47], s31, v19
  s_nop 0
  s_and_b32 vcc_lo, vcc_lo, s46
  s_andn2_b32 s43, 0xf0, s53
  s_and_b32 s43, s43, vcc_lo
  s_or_b32 s53, s53, s43
  s_bitcmp1_b32 s43, 4
  s_cselect_b64 exec, -1, 0
  buffer_load_dwordx3 v[96:98], v12, s[16:19], s84 offen offset:0 sc1
  buffer_load_dwordx3 v[100:102], v12, s[16:19], s84 offen offset:1024 sc1
  s_bitcmp1_b32 s43, 5
  s_cselect_b64 exec, -1, 0
  buffer_load_dwordx3 v[104:106], v12, s[16:19], s85 offen offset:0 sc1
  buffer_load_dwordx3 v[108:110], v12, s[16:19], s85 offen offset:1024 sc1
  s_bitcmp1_b32 s43, 6
  s_cselect_b64 exec, -1, 0
  buffer_load_dwordx3 v[208:210], v12, s[16:19], s88 offen offset:0 sc1
  buffer_load_dwordx3 v[212:214], v12, s[16:19], s88 offen offset:1024 sc1
  s_bitcmp1_b32 s43, 7
  s_cselect_b64 exec, -1, 0
  buffer_load_dwordx3 v[216:218], v12, s[16:19], s89 offen offset:0 sc1
  buffer_load_dwordx3 v[220:222], v12, s[16:19], s89 offen offset:1024 sc1
  s_mov_b64 exec, -1
  s_cmp_gt_i32 s56, 0
  s_cbranch_scc1 L_y_a
L_y_a_done:
  s_and_b32 s48, s43, 0x70
  s_cbranch_scc0 L_y_acc
  s_waitcnt vmcnt(0)
L_y_acc:
  v_dot2_f32_bf16 v224, v96, s50, v224
  v_dot2_f32_bf16 v225, v96, s51, v225
  v_dot2_f32_bf16 v226, v97, s50, v226
  v_dot2_f32_bf16 v227, v97, s51, v227
  v_dot2_f32_bf16 v228, v98, s50, v228
  v_dot2_f32_bf16 v229, v98, s51, v229
  v_dot2_f32_bf16 v230, v100, s50, v230
  v_dot2_f32_bf16 v231, v100, s51, v231
  v_dot2_f32_bf16 v232, v101, s50, v232
  v_dot2_f32_bf16 v233, v101, s51, v233
  v_dot2_f32_bf16 v234, v102, s50, v234
  v_dot2_f32_bf16 v235, v102, s51, v235
  v_dot2_f32_bf16 v224, v104, s50, v224
  v_dot2_f32_bf16 v225, v104, s51, v225
  v_dot2_f32_bf16 v226, v105, s50, v226
  v_dot2_f32_bf16 v227, v105, s51, v227
  v_dot2_f32_bf16 v228, v106, s50, v228
  v_dot2_f32_bf16 v229, v106, s51, v229
  v_dot2_f32_bf16 v230, v108, s50, v230
  v_dot2_f32_bf16 v231, v108, s51, v231
  v_dot2_f32_bf16 v232, v109, s50, v232
  v_dot2_f32_bf16 v233, v109, s51, v233
  v_dot2_f32_bf16 v234, v110, s50, v234
  v_dot2_f32_bf16 v235, v110, s51, v235
  v_dot2_f32_bf16 v224, v208, s50, v224
  v_dot2_f32_bf16 v225, v208, s51, v225
  v_dot2_f32_bf16 v226, v209, s50, v226
  v_dot2_f32_bf16 v227, v209, s51, v227
  v_dot2_f32_bf16 v228, v210, s50, v228
  v_dot2_f32_bf16 v229, v210, s51, v229
  v_dot2_f32_bf16 v230, v212, s50, v230
  v_dot2_f32_bf16 v231, v212, s51, v231
  v_dot2_f32_bf16 v232, v213, s50, v232
  v_dot2_f32_bf16 v233, v213, s51, v233
  v_dot2_f32_bf16 v234, v214, s50, v234
  v_dot2_f32_bf16 v235, v214, s51, v235
L_y_b:
  s_and_b32 s48, s53, 240
  s_cmp_eq_u32 s48, 240
  s_cbranch_scc1 L_y_b_done
  s_mov_b32 exec_lo, 0xf0
  s_mov_b32 exec_hi, 0x0
  buffer_load_dwordx2 v[18:19], v47, s[16:19], s52 offen sc1
  s_mov_b64 exec, -1
  s_sub_u32 s56, s56, 1
  s_waitcnt vmcnt(0)
  v_cmp_eq_u32 vcc, s30, v18
  v_cmp_eq_u32 s[46:47], s31, v19
  s_nop 0
  s_and_b32 vcc_lo, vcc_lo, s46
  s_andn2_b32 s43, 0xf0, s53
  s_and_b32 s43, s43, vcc_lo
  s_or_b32 s53, s53, s43
  s_bitcmp1_b32 s43, 4
  s_cselect_b64 exec, -1, 0
  buffer_load_dwordx3 v[96:98], v12, s[16:19], s84 offen offset:0 sc1
  buffer_load_dwordx3 v[100:102], v12, s[16:19], s84 offen offset:1024 sc1
  s_bitcmp1_b32 s43, 5
  s_cselect_b64 exec, -1, 0
  buffer_load_dwordx3 v[104:106], v12, s[16:19], s85 offen offset:0 sc1
  buffer_load_dwordx3 v[108:110], v12, s[16:19], s85 offen offset:1024 sc1
  s_bitcmp1_b32 s43, 6
  s_cselect_b64 exec, -1, 0
  buffer_load_dwordx3 v[208:210], v12, s[16:19], s88 offen offset:0 sc1
  buffer_load_dwordx3 v[212:214], v12, s[16:19], s88 offen offset:1024 sc1
  s_bitcmp1_b32 s43, 7
  s_cselect_b64 exec, -1, 0
  buffer_load_dwordx3 v[216:218], v12, s[16:19], s89 offen offset:0 sc1
  buffer_load_dwordx3 v[220:222], v12, s[16:19], s89 offen offset:1024 sc1
  s_mov_b64 exec, -1
  s_cmp_gt_i32 s56, 0
  s_cbranch_scc1 L_y_b
L_y_b_done:
  s_waitcnt vmcnt(0)
  v_dot2_f32_bf16 v224, v216, s50, v224
  v_dot2_f32_bf16 v225, v216, s51, v225
  v_dot2_f32_bf16 v226, v217, s50, v226
  v_dot2_f32_bf16 v227, v217, s51, v227
  v_dot2_f32_bf16 v228, v218, s50, v228
  v_dot2_f32_bf16 v229, v218, s51, v229
  v_dot2_f32_bf16 v230, v220, s50, v230
  v_dot2_f32_bf16 v231, v220, s51, v231
  v_dot2_f32_bf16 v232, v221, s50, v232
  v_dot2_f32_bf16 v233, v221, s51, v233
  v_dot2_f32_bf16 v234, v222, s50, v234
  v_dot2_f32_bf16 v235, v222, s51, v235
  v_mul_f32 v112, v112, v224
  v_mul_f32 v113, v113, v225
  v_mul_f32 v114, v114, v226
  v_mul_f32 v115, v115, v227
  v_mul_f32 v144, v144, v228
  v_mul_f32 v145, v145, v229
  v_mul_f32 v146, v146, v230
  v_mul_f32 v147, v147, v231
  v_mul_f32 v176, v176, v232
  v_mul_f32 v177, v177, v233
  v_mul_f32 v178, v178, v234
  v_mul_f32 v179, v179, v235
  v_fma_f32 v48, v112, v60, v48
  v_fma_f32 v49, v113, v61, v49
  v_fma_f32 v50, v114, v62, v50
  v_fma_f32 v51, v115, v63, v51
  buffer_store_dwordx4 v[48:51], v78, s[4:7], s87 offen offset:0 sc1
  v_fma_f32 v52, v144, v64, v52
  v_fma_f32 v53, v145, v65, v53
  v_fma_f32 v54, v146, v66, v54
  v_fma_f32 v55, v147, v67, v55
  buffer_store_dwordx4 v[52:55], v78, s[4:7], s87 offen offset:256 sc1
  v_fma_f32 v56, v176, v68, v56
  v_fma_f32 v57, v177, v69, v57
  v_fma_f32 v58, v178, v70, v58
  v_fma_f32 v59, v179, v71, v59
  buffer_store_dwordx4 v[56:59], v78, s[4:7], s87 offen offset:512 sc1
L_final:
  s_lshl_b32 s46, s27, 7
  s_or_b32 s47, s28, s29
  s_or_b32 s47, s47, s24
  s_cmp_eq_u32 s47, 0
  s_cbranch_scc0 L_skip_8
  v_mov_b32 v1, s30
  s_mov_b64 exec, 1
  buffer_store_dword v1, v0, s[16:19], s46 offen sc1
  s_mov_b64 exec, -1
L_skip_8:
  s_endpgm
L_slow_r_5:
  s_mov_b32 s56, 0x80000
L_spin_r_5:
  s_nop 1
  s_mov_b64 exec, 3
  buffer_load_dwordx2 v[18:19], v17, s[16:19], 0 offen sc1
  s_mov_b64 exec, -1
  s_waitcnt vmcnt(0)
  v_subrev_u32 v19, s31, v19
  v_cmp_eq_u32 vcc, s30, v18
  v_subrev_u32 v19, 3, v19
  v_cmp_gt_u32 s[46:47], 13, v19
  s_nop 0
  s_and_b32 s46, s46, vcc_lo
  s_and_b32 s46, s46, 3
  s_cmp_eq_u32 s46, 3
  s_cbranch_scc1 L_back_r_5
  s_sub_u32 s56, s56, 1
  s_cmp_lg_u32 s56, 0
  s_cbranch_scc1 L_spin_r_5
  s_branch L_back_r_5
L_slow_r_6:
  s_mov_b32 s56, 0x80000
L_spin_r_6:
  s_nop 1
  s_mov_b64 exec, 3
  buffer_load_dwordx2 v[18:19], v17, s[16:19], 0 offen sc1
  s_mov_b64 exec, -1
  s_waitcnt vmcnt(0)
  v_subrev_u32 v19, s31, v19
  v_cmp_eq_u32 vcc, s30, v18
  v_subrev_u32 v19, 5, v19
  v_cmp_gt_u32 s[46:47], 11, v19
  s_nop 0
  s_and_b32 s46, s46, vcc_lo
  s_and_b32 s46, s46, 3
  s_cmp_eq_u32 s46, 3
  s_cbranch_scc1 L_back_r_6
  s_sub_u32 s56, s56, 1
  s_cmp_lg_u32 s56, 0
  s_cbranch_scc1 L_spin_r_6
  s_branch L_back_r_6
L_slow_r_7:
  s_mov_b32 s56, 0x80000
L_spin_r_7:
  s_nop 1
  s_mov_b64 exec, 3
  buffer_load_dwordx2 v[18:19], v17, s[16:19], 0 offen sc1
  s_mov_b64 exec, -1
  s_waitcnt vmcnt(0)
  v_subrev_u32 v19, s31, v19
  v_cmp_eq_u32 vcc, s30, v18
  v_subrev_u32 v19, 6, v19
  v_cmp_gt_u32 s[46:47], 10, v19
  s_nop 0
  s_and_b32 s46, s46, vcc_lo
  s_and_b32 s46, s46, 3
  s_cmp_eq_u32 s46, 3
  s_cbranch_scc1 L_back_r_7
  s_sub_u32 s56, s56, 1
  s_cmp_lg_u32 s56, 0
  s_cbranch_scc1 L_spin_r_7
  s_branch L_back_r_7
L_g0_again:
  v_cmp_ne_u32 vcc, s30, v119
  s_nop 0
  s_cmp_lg_u64 vcc, 0
  s_cselect_b64 exec, -1, 0
  buffer_load_dwordx4 v[116:119], v0, s[16:19], s75 offen offset:0 sc1
  s_mov_b64 exec, -1
  v_cmp_ne_u32 vcc, s30, v131
  s_nop 0
  s_cmp_lg_u64 vcc, 0
  s_cselect_b64 exec, -1, 0
  buffer_load_dwordx4 v[128:131], v0, s[16:19], s62 offen offset:0 sc1
  s_mov_b64 exec, -1
  v_cmp_ne_u32 vcc, s30, v135
  s_nop 0
  s_cmp_lg_u64 vcc, 0
  s_cselect_b64 exec, -1, 0
  buffer_load_dwordx4 v[132:135], v0, s[16:19], s63 offen offset:0 sc1
  s_mov_b64 exec, -1
  s_sub_u32 s56, s56, 1
  s_waitcnt vmcnt(0)
  s_cmp_gt_i32 s56, 0
  s_cbranch_scc1 L_g0_top
  s_branch L_g0_done
L_g1_again:
  v_cmp_ne_u32 vcc, s31, v151
  s_nop 0
  s_cmp_lg_u64 vcc, 0
  s_cselect_b64 exec, -1, 0
  buffer_load_dwordx4 v[148:151], v0, s[16:19], s75 offen offset:1024 sc1
  s_mov_b64 exec, -1
  v_cmp_ne_u32 vcc, s31, v163
  s_nop 0
  s_cmp_lg_u64 vcc, 0
  s_cselect_b64 exec, -1, 0
  buffer_load_dwordx4 v[160:163], v0, s[16:19], s62 offen offset:1024 sc1
  s_mov_b64 exec, -1
  v_cmp_ne_u32 vcc, s31, v167
  s_nop 0
  s_cmp_lg_u64 vcc, 0
  s_cselect_b64 exec, -1, 0
  buffer_load_dwordx4 v[164:167], v0, s[16:19], s63 offen offset:1024 sc1
  s_mov_b64 exec, -1
  s_sub_u32 s56, s56, 1
  s_waitcnt vmcnt(0)
  s_cmp_gt_i32 s56, 0
  s_cbranch_scc1 L_g1_top
  s_branch L_g1_done
L_g1b_again:
  v_cmp_ne_u32 vcc, s31, v151
  s_nop 0
  s_cmp_lg_u64 vcc, 0
  s_cselect_b64 exec, -1, 0
  buffer_load_dwordx4 v[148:151], v0, s[16:19], s75 offen offset:1024 sc1
  s_mov_b64 exec, -1
  v_cmp_ne_u32 vcc, s31, v163
  s_nop 0
  s_cmp_lg_u64 vcc, 0
  s_cselect_b64 exec, -1, 0
  buffer_load_dwordx4 v[160:163], v0, s[16:19], s62 offen offset:1024 sc1
  s_mov_b64 exec, -1
  v_cmp_ne_u32 vcc, s31, v167
  s_nop 0
  s_cmp_lg_u64 vcc, 0
  s_cselect_b64 exec, -1, 0
  buffer_load_dwordx4 v[164:167], v0, s[16:19], s63 offen offset:1024 sc1
  s_mov_b64 exec, -1
  s_sub_u32 s56, s56, 1
  s_waitcnt vmcnt(0)
  s_cmp_gt_i32 s56, 0
  s_cbranch_scc1 L_g1b_top
  s_branch L_g1b_done
L_ssm:
  s_mov_b32 s52, 0x3f803f80
  s_lshl_b32 s46, s27, 7
  s_load_dword s30, s[88:89], s46
  s_mov_b32 s16, s88
  s_mov_b32 s17, s89
  s_mov_b32 s18, 46137344
  s_mov_b32 s19, 0x20000
  s_mul_i32 s35, s24, 3072
  s_mov_b32 s50, 0x00003f80
  s_mov_b32 s51, 0x3f800000
  v_and_b32 v73, 15, v64
  v_lshrrev_b32 v74, 4, v64
  s_lshl_b32 s46, s28, 7
  s_add_u32 s46, s46, 2048
  s_load_dword s34, s[88:89], s46
  s_bitcmp1_b32 s24, 1
  s_cselect_b32 s8, s68, s66
  s_cselect_b32 s9, s69, s67
  s_mov_b32 s10, 663552
  s_mov_b32 s11, 0x20000
  s_cselect_b32 s12, s72, s70
  s_cselect_b32 s13, s73, s71
  s_mov_b32 s14, 663552
  s_mov_b32 s15, 0x20000
  s_and_b32 s47, s24, 1
  s_lshl_b32 s48, s47, 2
  v_lshrrev_b32 v92, 1, v65
  v_add_u32 v92, s48, v92
  v_xor_b32 v92, v92, v66
  v_mul_u32_u24 v1, 1152, v65
  v_lshl_add_u32 v1, v92, 4, v1
  s_lshl_b32 s48, s26, 1
  s_add_u32 s47, s48, s47
  s_mul_i32 s48, s47, 9216
  s_mul_i32 s49, s28, 165888
  s_add_u32 s32, s48, s49
  s_lshl_b32 s46, s28, 8
  s_add_u32 s33, s48, s46
  s_and_b32 s48, s27, 7
  s_lshl_b32 s48, s48, 2
  s_add_u32 s48, s48, s47
  s_mul_i32 s57, s48, 1152
  s_add_u32 s57, s57, s49
  s_mul_i32 s58, s48, 20736
  s_add_u32 s58, s58, s46
  v_mul_u32_u24 v92, 114, v64
  v_lshrrev_b32 v92, 10, v92
  v_mul_u32_u24 v104, 35712, v92
  v_lshl_add_u32 v104, v64, 7, v104
  v_mul_u32_u24 v92, 342, v64
  v_lshrrev_b32 v92, 10, v92
  v_mul_u32_u24 v15, 768, v92
  v_lshl_add_u32 v15, v64, 7, v15
  s_mul_i32 s20, s28, 3
  s_lshr_b32 s20, s20, 1
  s_mov_b32 s86, 0xe900f94
  s_mov_b32 s87, 0xe900f94
  s_lshl_b32 s46, s28, 4
  s_lshr_b64 s[86:87], s[86:87], s46
  s_mul_i32 s21, s26, 4294949248
  s_add_u32 s21, s21, s32
  s_add_u32 s21, s21, 147456
  v_lshrrev_b32 v92, 1, v73
  v_xor_b32 v93, v92, v74
  v_and_b32 v94, 7, v73
  v_lshlrev_b32 v94, 7, v94
  v_lshrrev_b32 v95, 3, v73
  v_mul_u32_u24 v95, 3072, v95
  s_mul_i32 s46, s26, 6144
  v_add3_u32 v94, v94, v95, s46
  v_lshl_add_u32 v2, v93, 4, v94
  v_xor_b32 v3, 64, v2
  s_lshl_b32 s47, s26, 7
  s_add_u32 s47, s47, 122880
  v_lshl_add_u32 v4, v73, 3, s47
  v_mul_u32_u24 v5, 1152, v74
  v_add_u32 v5, v5, v4
  s_mul_i32 s47, s26, 896
  s_lshl_b32 s48, s25, 7
  s_add_u32 s47, s47, s48
  s_add_u32 s47, s47, 150528
  v_lshl_add_u32 v6, v73, 3, s47
  s_add_u32 s48, s48, 159488
  v_lshl_add_u32 v7, v74, 5, s48
  s_mov_b32 s40, 0
  s_mov_b32 s41, -1
  s_mov_b32 s36, 0xffff0000
  s_mov_b32 s37, 0xffff0000
  s_mul_i32 s39, s28, 9
  s_add_u32 s39, s39, s26
  s_lshl_b32 s39, s39, 12
  s_add_u32 s39, s39, 262144
  s_mul_i32 s54, s27, 196608
  s_lshl_b32 s46, s24, 11
  s_add_u32 s54, s54, s46
  s_add_u32 s54, s54, 33554432
  s_mul_i32 s59, s27, 6144
  s_lshl_b32 s46, s24, 6
  s_add_u32 s59, s59, s46
  s_add_u32 s59, s59, 163872
  s_lshl_b32 s55, s27, 8
  s_add_u32 s55, s55, s39
  s_cmp_eq_u32 s25, 3
  s_cselect_b32 s55, s55, 0x70000000
  v_bfe_u32 v88, v64, 2, 2
  v_and_b32 v89, 3, v64
  v_lshl_add_u32 v90, v74, 3, v88
  v_lshlrev_b32 v89, 1, v89
  v_and_b32 v91, 1, v74
  v_xor_b32 v89, v89, v91
  v_and_b32 v88, 2, v88
  v_xor_b32 v89, v89, v88
  v_lshlrev_b32 v89, 3, v89
  v_lshl_add_u32 v84, v90, 6, v89
  v_lshrrev_b32 v88, 3, v73
  v_and_b32 v89, 6, v73
  v_xor_b32 v89, v88, v89
  v_lshlrev_b32 v90, 1, v74
  v_xor_b32 v89, v89, v90
  v_lshlrev_b32 v89, 3, v89
  v_lshl_add_u32 v85, v73, 6, v89
  v_lshrrev_b32 v89, 1, v73
  v_xor_b32 v89, v89, v91
  v_and_b32 v90, 2, v74
  v_add_u32 v90, v90, v88
  v_mul_u32_u24 v90, 3072, v90
  v_and_b32 v88, 7, v73
  v_lshl_add_u32 v90, v88, 7, v90
  s_add_u32 s47, s28, 0
  s_and_b32 s48, s47, 3
  s_lshl_b32 s48, s48, 1
  s_lshr_b32 s47, s47, 2
  s_lshl_b32 s47, s47, 10
  v_xor_b32 v80, s48, v89
  v_lshl_add_u32 v80, v80, 4, v90
  v_add_u32 v80, s47, v80
  s_add_u32 s47, s28, 1
  s_and_b32 s48, s47, 3
  s_lshl_b32 s48, s48, 1
  s_lshr_b32 s47, s47, 2
  s_lshl_b32 s47, s47, 10
  v_xor_b32 v81, s48, v89
  v_lshl_add_u32 v81, v81, 4, v90
  v_add_u32 v81, s47, v81
  s_add_u32 s47, s28, 2
  s_and_b32 s48, s47, 3
  s_lshl_b32 s48, s48, 1
  s_lshr_b32 s47, s47, 2
  s_lshl_b32 s47, s47, 10
  v_xor_b32 v82, s48, v89
  v_lshl_add_u32 v82, v82, 4, v90
  v_add_u32 v82, s47, v82
  s_add_u32 s47, s28, 3
  s_and_b32 s48, s47, 3
  s_lshl_b32 s48, s48, 1
  s_lshr_b32 s47, s47, 2
  s_lshl_b32 s47, s47, 10
  v_xor_b32 v83, s48, v89
  v_lshl_add_u32 v83, v83, 4, v90
  v_add_u32 v83, s47, v83
  v_add_u32 v88, 161152, v0
  v_lshlrev_b32 v89, 3, v64
  v_add_u32 v89, 162176, v89
  ds_write_b128 v88, v[80:83]
  ds_write_b64 v89, v[84:85]
  s_mul_i32 s22, s25, 18432
  s_add_u32 s22, s22, 73728
  s_lshl_b32 s23, s26, 11
  s_add_u32 s23, s23, s22
  s_mul_i32 s53, s26, 12288
  s_mul_i32 s3, s25, 4608
  v_bfe_u32 v80, v1, 4, 3
  s_lshl_b32 s46, s28, 1
  v_cmp_le_u32 s[74:75], s46, v80
  s_add_u32 s46, s46, 2
  v_cmp_gt_u32 s[76:77], s46, v80
  s_mul_i32 s46, s25, 18432
  s_add_u32 s46, s46, 73728
  v_xor_b32 v70, v65, v66
  s_bfe_u32 s47, s42, 0x20005
  s_mul_i32 s47, s47, 18432
  s_and_b32 s48, s42, 16
  s_lshl_b32 s48, s48, 3
  s_add_u32 s47, s47, s48
  s_add_u32 s47, s47, 73728
  v_lshlrev_b32 v70, 4, v70
  v_lshl_add_u32 v70, v66, 8, v70
  v_add_u32 v70, s47, v70
  v_xor_b32 v71, v73, v74
  v_lshlrev_b32 v71, 4, v71
  v_lshl_add_u32 v71, v74, 8, v71
  v_add_u32 v71, s46, v71
  v_xor_b32 v72, 64, v71
  s_and_b32 s48, s42, 127
  v_add_u32 v75, s48, v67
  v_lshlrev_b32 v75, 3, v75
  v_add_u32 v82, 162816, v75
  v_mov_b32 v32, 0
  v_mov_b32 v33, 0
  v_mov_b32 v34, 0
  v_mov_b32 v35, 0
  v_lshlrev_b32 v36, 4, v69
  v_add_u32 v36, 150528, v36
  ds_write_b128 v36, v[32:35]
  v_min_u32 v36, 151280, v36
  ds_write_b128 v36, v[32:35] offset:8192
  v_cmp_eq_u32 vcc, 3, v106
  s_nop 1
  v_cndmask_b32 v106, v106, v32, vcc
  v_mul_u32_u24 v47, 9216, v106
  v_lshl_add_u32 v47, v107, 3, v47
  v_add_u32 v47, 122880, v47
  v_cvt_f32_u32 v37, v106
  v_cmp_eq_u32 vcc, 0, v106
  v_mov_b32 v38, 0xc2600000
  v_mov_b32 v39, 0x44000000
  v_fmac_f32 v38, 0x42800000, v37
  v_max_f32 v38, 0, v38
  v_mov_b32 v40, 0x41000000
  v_cndmask_b32 v39, v40, v39, vcc
  s_waitcnt vmcnt(9)
  v_lshlrev_b32 v109, 16, v109
  v_lshlrev_b32 v110, 16, v110
  v_lshlrev_b32 v111, 16, v111
  v_mul_f32 v111, 0x3fb8aa3b, v111
  v_exp_f32 v111, v111
  v_mul_f32 v37, v109, v109
  v_fma_f32 v37, v110, v110, v37
  v_cvt_pk_bf16_f32 v111, v111, v111
  v_rcp_f32 v37, v37
  v_and_b32 v111, 0xffff0000, v111
  v_mul_f32 v40, v111, v109
  v_mul_f32 v41, v111, v110
  v_mul_f32 v40, 0x3fb8aa3b, v40
  v_mul_f32 v41, 0x3e22f983, v41
  v_add_f32 v37, v37, v37
  v_mul_f32 v109, v109, v37
  v_mul_f32 v110, v110, v37
  v_mul_f32 v46, v38, v40
  v_mul_f32 v49, v38, v41
  v_exp_f32 v46, v46
  v_fract_f32 v49, v49
  v_cos_f32 v48, v49
  v_sin_f32 v49, v49
  v_mul_f32 v48, v48, v46
  v_mul_f32 v49, v49, v46
  v_mul_f32 v46, v39, v40
  v_mul_f32 v43, v39, v41
  v_exp_f32 v46, v46
  v_fract_f32 v43, v43
  v_cos_f32 v42, v43
  v_sin_f32 v43, v43
  v_mul_f32 v42, v42, v46
  v_mul_f32 v43, v43, v46
  v_exp_f32 v46, v40
  v_fract_f32 v45, v41
  v_cos_f32 v44, v45
  v_sin_f32 v45, v45
  v_mul_f32 v44, v44, v46
  v_mul_f32 v45, v45, v46
  v_mul_f32 v50, v48, v42
  v_mul_f32 v51, v49, v42
  v_fma_f32 v50, -v49, v43, v50
  v_fma_f32 v51, v48, v43, v51
  v_mul_f32 v52, v50, v42
  v_mul_f32 v53, v51, v42
  v_fma_f32 v52, -v51, v43, v52
  v_fma_f32 v53, v50, v43, v53
  v_mul_f32 v54, v52, v42
  v_mul_f32 v55, v53, v42
  v_fma_f32 v54, -v53, v43, v54
  v_fma_f32 v55, v52, v43, v55
  v_mul_f32 v56, v54, v42
  v_mul_f32 v57, v55, v42
  v_fma_f32 v56, -v55, v43, v56
  v_fma_f32 v57, v54, v43, v57
  v_mul_f32 v58, v56, v42
  v_mul_f32 v59, v57, v42
  v_fma_f32 v58, -v57, v43, v58
  v_fma_f32 v59, v56, v43, v59
  v_mul_f32 v60, v58, v42
  v_mul_f32 v61, v59, v42
  v_fma_f32 v60, -v59, v43, v60
  v_fma_f32 v61, v58, v43, v61
  v_mul_f32 v62, v60, v42
  v_mul_f32 v63, v61, v42
  v_fma_f32 v62, -v61, v43, v62
  v_fma_f32 v63, v60, v43, v63
  v_add_f32 v37, -1.0, v44
  v_mul_f32 v38, v37, v109
  v_fma_f32 v38, v45, v110, v38
  v_mul_f32 v39, v45, v109
  v_fma_f32 v39, -v37, v110, v39
  v_cndmask_b32 v56, v56, v44, vcc
  v_cndmask_b32 v57, v57, v45, vcc
  v_cndmask_b32 v58, v58, v38, vcc
  v_cndmask_b32 v59, v59, v39, vcc
  v_cndmask_b32 v62, v62, v48, vcc
  v_cndmask_b32 v63, v63, v49, vcc
  s_waitcnt vmcnt(8)
  buffer_load_dwordx4 v[220:223], v68, s[4:7], s45 offen offset:0
  v_dot2_f32_bf16 v76, v184, s52, 0
  v_dot2_f32_bf16 v78, v184, v184, 0
  v_dot2_f32_bf16 v77, v185, s52, 0
  v_dot2_f32_bf16 v79, v185, v185, 0
  v_dot2_f32_bf16 v76, v186, s52, v76
  v_dot2_f32_bf16 v78, v186, v186, v78
  v_dot2_f32_bf16 v77, v187, s52, v77
  v_dot2_f32_bf16 v79, v187, v187, v79
  s_waitcnt vmcnt(8)
  buffer_load_dwordx4 v[224:227], v68, s[4:7], s45 offen offset:128
  v_dot2_f32_bf16 v76, v188, s52, v76
  v_dot2_f32_bf16 v78, v188, v188, v78
  v_dot2_f32_bf16 v77, v189, s52, v77
  v_dot2_f32_bf16 v79, v189, v189, v79
  v_dot2_f32_bf16 v76, v190, s52, v76
  v_dot2_f32_bf16 v78, v190, v190, v78
  v_dot2_f32_bf16 v77, v191, s52, v77
  v_dot2_f32_bf16 v79, v191, v191, v79
  s_waitcnt vmcnt(8)
  buffer_load_dwordx4 v[228:231], v68, s[4:7], s45 offen offset:256
  v_dot2_f32_bf16 v76, v192, s52, v76
  v_dot2_f32_bf16 v78, v192, v192, v78
  v_dot2_f32_bf16 v77, v193, s52, v77
  v_dot2_f32_bf16 v79, v193, v193, v79
  v_dot2_f32_bf16 v76, v194, s52, v76
  v_dot2_f32_bf16 v78, v194, v194, v78
  v_dot2_f32_bf16 v77, v195, s52, v77
  v_dot2_f32_bf16 v79, v195, v195, v79
  s_waitcnt vmcnt(8)
  buffer_load_dwordx4 v[232:235], v68, s[4:7], s45 offen offset:384
  v_dot2_f32_bf16 v76, v196, s52, v76
  v_dot2_f32_bf16 v78, v196, v196, v78
  v_dot2_f32_bf16 v77, v197, s52, v77
  v_dot2_f32_bf16 v79, v197, v197, v79
  v_dot2_f32_bf16 v76, v198, s52, v76
  v_dot2_f32_bf16 v78, v198, v198, v78
  v_dot2_f32_bf16 v77, v199, s52, v77
  v_dot2_f32_bf16 v79, v199, v199, v79
  s_waitcnt vmcnt(8)
  buffer_load_dwordx4 v[236:239], v68, s[4:7], s45 offen offset:512
  v_dot2_f32_bf16 v76, v200, s52, v76
  v_dot2_f32_bf16 v78, v200, v200, v78
  v_dot2_f32_bf16 v77, v201, s52, v77
  v_dot2_f32_bf16 v79, v201, v201, v79
  v_dot2_f32_bf16 v76, v202, s52, v76
  v_dot2_f32_bf16 v78, v202, v202, v78
  v_dot2_f32_bf16 v77, v203, s52, v77
  v_dot2_f32_bf16 v79, v203, v203, v79
  s_waitcnt vmcnt(8)
  buffer_load_dwordx4 v[240:243], v68, s[4:7], s45 offen offset:640
  v_dot2_f32_bf16 v76, v204, s52, v76
  v_dot2_f32_bf16 v78, v204, v204, v78
  v_dot2_f32_bf16 v77, v205, s52, v77
  v_dot2_f32_bf16 v79, v205, v205, v79
  v_dot2_f32_bf16 v76, v206, s52, v76
  v_dot2_f32_bf16 v78, v206, v206, v78
  v_dot2_f32_bf16 v77, v207, s52, v77
  v_dot2_f32_bf16 v79, v207, v207, v79
  s_waitcnt vmcnt(8)
  buffer_load_dwordx4 v[244:247], v68, s[4:7], s45 offen offset:768
  v_dot2_f32_bf16 v76, v208, s52, v76
  v_dot2_f32_bf16 v78, v208, v208, v78
  v_dot2_f32_bf16 v77, v209, s52, v77
  v_dot2_f32_bf16 v79, v209, v209, v79
  v_dot2_f32_bf16 v76, v210, s52, v76
  v_dot2_f32_bf16 v78, v210, v210, v78
  v_dot2_f32_bf16 v77, v211, s52, v77
  v_dot2_f32_bf16 v79, v211, v211, v79
  s_waitcnt vmcnt(8)
  buffer_load_dwordx4 v[248:251], v68, s[4:7], s45 offen offset:896
  v_dot2_f32_bf16 v76, v212, s52, v76
  v_dot2_f32_bf16 v78, v212, v212, v78
  v_dot2_f32_bf16 v77, v213, s52, v77
  v_dot2_f32_bf16 v79, v213, v213, v79
  v_dot2_f32_bf16 v76, v214, s52, v76
  v_dot2_f32_bf16 v78, v214, v214, v78
  v_dot2_f32_bf16 v77, v215, s52, v77
  v_dot2_f32_bf16 v79, v215, v215, v79
  s_waitcnt vmcnt(8)
  buffer_load_dwordx4 v[252:255], v68, s[4:7], s45 offen offset:1024
  v_dot2_f32_bf16 v76, v216, s52, v76
  v_dot2_f32_bf16 v78, v216, v216, v78
  v_dot2_f32_bf16 v77, v217, s52, v77
  v_dot2_f32_bf16 v79, v217, v217, v79
  v_dot2_f32_bf16 v76, v218, s52, v76
  v_dot2_f32_bf16 v78, v218, v218, v78
  v_dot2_f32_bf16 v77, v219, s52, v77
  v_dot2_f32_bf16 v79, v219, v219, v79
  s_mov_b32 exec_lo, 0x1ff
  s_mov_b32 exec_hi, 0x1ff0
  buffer_load_dword v14, v104, s[8:11], s57 offen
  s_mov_b64 exec, -1
  v_add_f32 v76, v76, v77
  v_add_f32 v78, v78, v79
  s_nop 0
  v_add_f32_dpp v76, v76, v76 quad_perm:[1,0,3,2] row_mask:0xf bank_mask:0xf
  v_add_f32_dpp v78, v78, v78 quad_perm:[1,0,3,2] row_mask:0xf bank_mask:0xf
  s_nop 0
  v_add_f32_dpp v76, v76, v76 quad_perm:[2,3,0,1] row_mask:0xf bank_mask:0xf
  v_add_f32_dpp v78, v78, v78 quad_perm:[2,3,0,1] row_mask:0xf bank_mask:0xf
  s_nop 0
  v_add_f32_dpp v76, v76, v76 row_half_mirror row_mask:0xf bank_mask:0xf
  v_add_f32_dpp v78, v78, v78 row_half_mirror row_mask:0xf bank_mask:0xf
  v_mul_f32 v76, 0x3ae38e39, v76
  v_mul_f32 v78, 0x3ae38e39, v78
  v_fma_f32 v78, -v76, v76, v78
  v_max_f32 v78, 0, v78
  v_cvt_pk_bf16_f32 v77, v76, v78
  v_lshlrev_b32 v81, 16, v77
  v_and_b32 v78, 0xffff0000, v77
  v_add_f32 v78, 0x3727c5ac, v78
  v_cvt_pk_bf16_f32 v78, v78, v78
  v_and_b32 v78, 0xffff0000, v78
  v_sqrt_f32 v78, v78
  s_nop 0
  v_cvt_pk_bf16_f32 v78, v78, v78
  v_and_b32 v80, 0xffff0000, v78
  ds_write_b64 v82, v[80:81] offset:0
  v_rcp_f32 v92, v80
  v_lshrrev_b32 v93, 1, v75
  v_add_u32 v93, 159488, v93
  ds_write_b32 v93, v92 offset:0
  v_dot2_f32_bf16 v84, v184, s50, v81 neg_lo:[0,0,1]
  v_dot2_f32_bf16 v85, v184, s51, v81 neg_lo:[0,0,1]
  v_dot2_f32_bf16 v86, v185, s50, v81 neg_lo:[0,0,1]
  v_dot2_f32_bf16 v87, v185, s51, v81 neg_lo:[0,0,1]
  v_dot2_f32_bf16 v88, v186, s50, v81 neg_lo:[0,0,1]
  v_dot2_f32_bf16 v89, v186, s51, v81 neg_lo:[0,0,1]
  v_dot2_f32_bf16 v90, v187, s50, v81 neg_lo:[0,0,1]
  v_dot2_f32_bf16 v91, v187, s51, v81 neg_lo:[0,0,1]
  v_cvt_pk_bf16_f32 v184, v84, v85
  v_cvt_pk_bf16_f32 v185, v86, v87
  v_cvt_pk_bf16_f32 v186, v88, v89
  v_cvt_pk_bf16_f32 v187, v90, v91
  ds_write_b128 v70, v[184:187] offset:0
  v_dot2_f32_bf16 v84, v188, s50, v81 neg_lo:[0,0,1]
  v_dot2_f32_bf16 v85, v188, s51, v81 neg_lo:[0,0,1]
  v_dot2_f32_bf16 v86, v189, s50, v81 neg_lo:[0,0,1]
  v_dot2_f32_bf16 v87, v189, s51, v81 neg_lo:[0,0,1]
  v_dot2_f32_bf16 v88, v190, s50, v81 neg_lo:[0,0,1]
  v_dot2_f32_bf16 v89, v190, s51, v81 neg_lo:[0,0,1]
  v_dot2_f32_bf16 v90, v191, s50, v81 neg_lo:[0,0,1]
  v_dot2_f32_bf16 v91, v191, s51, v81 neg_lo:[0,0,1]
  v_cvt_pk_bf16_f32 v188, v84, v85
  v_cvt_pk_bf16_f32 v189, v86, v87
  v_cvt_pk_bf16_f32 v190, v88, v89
  v_cvt_pk_bf16_f32 v191, v90, v91
  ds_write_b128 v70, v[188:191] offset:2048
  v_dot2_f32_bf16 v84, v192, s50, v81 neg_lo:[0,0,1]
  v_dot2_f32_bf16 v85, v192, s51, v81 neg_lo:[0,0,1]
  v_dot2_f32_bf16 v86, v193, s50, v81 neg_lo:[0,0,1]
  v_dot2_f32_bf16 v87, v193, s51, v81 neg_lo:[0,0,1]
  v_dot2_f32_bf16 v88, v194, s50, v81 neg_lo:[0,0,1]
  v_dot2_f32_bf16 v89, v194, s51, v81 neg_lo:[0,0,1]
  v_dot2_f32_bf16 v90, v195, s50, v81 neg_lo:[0,0,1]
  v_dot2_f32_bf16 v91, v195, s51, v81 neg_lo:[0,0,1]
  v_cvt_pk_bf16_f32 v192, v84, v85
  v_cvt_pk_bf16_f32 v193, v86, v87
  v_cvt_pk_bf16_f32 v194, v88, v89
  v_cvt_pk_bf16_f32 v195, v90, v91
  ds_write_b128 v70, v[192:195] offset:4096
  v_dot2_f32_bf16 v84, v196, s50, v81 neg_lo:[0,0,1]
  v_dot2_f32_bf16 v85, v196, s51, v81 neg_lo:[0,0,1]
  v_dot2_f32_bf16 v86, v197, s50, v81 neg_lo:[0,0,1]
  v_dot2_f32_bf16 v87, v197, s51, v81 neg_lo:[0,0,1]
  v_dot2_f32_bf16 v88, v198, s50, v81 neg_lo:[0,0,1]
  v_dot2_f32_bf16 v89, v198, s51, v81 neg_lo:[0,0,1]
  v_dot2_f32_bf16 v90, v199, s50, v81 neg_lo:[0,0,1]
  v_dot2_f32_bf16 v91, v199, s51, v81 neg_lo:[0,0,1]
  v_cvt_pk_bf16_f32 v196, v84, v85
  v_cvt_pk_bf16_f32 v197, v86, v87
  v_cvt_pk_bf16_f32 v198, v88, v89
  v_cvt_pk_bf16_f32 v199, v90, v91
  ds_write_b128 v70, v[196:199] offset:6144
  v_dot2_f32_bf16 v84, v200, s50, v81 neg_lo:[0,0,1]
  v_dot2_f32_bf16 v85, v200, s51, v81 neg_lo:[0,0,1]
  v_dot2_f32_bf16 v86, v201, s50, v81 neg_lo:[0,0,1]
  v_dot2_f32_bf16 v87, v201, s51, v81 neg_lo:[0,0,1]
  v_dot2_f32_bf16 v88, v202, s50, v81 neg_lo:[0,0,1]
  v_dot2_f32_bf16 v89, v202, s51, v81 neg_lo:[0,0,1]
  v_dot2_f32_bf16 v90, v203, s50, v81 neg_lo:[0,0,1]
  v_dot2_f32_bf16 v91, v203, s51, v81 neg_lo:[0,0,1]
  v_cvt_pk_bf16_f32 v200, v84, v85
  v_cvt_pk_bf16_f32 v201, v86, v87
  v_cvt_pk_bf16_f32 v202, v88, v89
  v_cvt_pk_bf16_f32 v203, v90, v91
  ds_write_b128 v70, v[200:203] offset:8192
  v_dot2_f32_bf16 v84, v204, s50, v81 neg_lo:[0,0,1]
  v_dot2_f32_bf16 v85, v204, s51, v81 neg_lo:[0,0,1]
  v_dot2_f32_bf16 v86, v205, s50, v81 neg_lo:[0,0,1]
  v_dot2_f32_bf16 v87, v205, s51, v81 neg_lo:[0,0,1]
  v_dot2_f32_bf16 v88, v206, s50, v81 neg_lo:[0,0,1]
  v_dot2_f32_bf16 v89, v206, s51, v81 neg_lo:[0,0,1]
  v_dot2_f32_bf16 v90, v207, s50, v81 neg_lo:[0,0,1]
  v_dot2_f32_bf16 v91, v207, s51, v81 neg_lo:[0,0,1]
  v_cvt_pk_bf16_f32 v204, v84, v85
  v_cvt_pk_bf16_f32 v205, v86, v87
  v_cvt_pk_bf16_f32 v206, v88, v89
  v_cvt_pk_bf16_f32 v207, v90, v91
  ds_write_b128 v70, v[204:207] offset:10240
  v_dot2_f32_bf16 v84, v208, s50, v81 neg_lo:[0,0,1]
  v_dot2_f32_bf16 v85, v208, s51, v81 neg_lo:[0,0,1]
  v_dot2_f32_bf16 v86, v209, s50, v81 neg_lo:[0,0,1]
  v_dot2_f32_bf16 v87, v209, s51, v81 neg_lo:[0,0,1]
  v_dot2_f32_bf16 v88, v210, s50, v81 neg_lo:[0,0,1]
  v_dot2_f32_bf16 v89, v210, s51, v81 neg_lo:[0,0,1]
  v_dot2_f32_bf16 v90, v211, s50, v81 neg_lo:[0,0,1]
  v_dot2_f32_bf16 v91, v211, s51, v81 neg_lo:[0,0,1]
  v_cvt_pk_bf16_f32 v208, v84, v85
  v_cvt_pk_bf16_f32 v209, v86, v87
  v_cvt_pk_bf16_f32 v210, v88, v89
  v_cvt_pk_bf16_f32 v211, v90, v91
  ds_write_b128 v70, v[208:211] offset:12288
  v_dot2_f32_bf16 v84, v212, s50, v81 neg_lo:[0,0,1]
  v_dot2_f32_bf16 v85, v212, s51, v81 neg_lo:[0,0,1]
  v_dot2_f32_bf16 v86, v213, s50, v81 neg_lo:[0,0,1]
  v_dot2_f32_bf16 v87, v213, s51, v81 neg_lo:[0,0,1]
  v_dot2_f32_bf16 v88, v214, s50, v81 neg_lo:[0,0,1]
  v_dot2_f32_bf16 v89, v214, s51, v81 neg_lo:[0,0,1]
  v_dot2_f32_bf16 v90, v215, s50, v81 neg_lo:[0,0,1]
  v_dot2_f32_bf16 v91, v215, s51, v81 neg_lo:[0,0,1]
  v_cvt_pk_bf16_f32 v212, v84, v85
  v_cvt_pk_bf16_f32 v213, v86, v87
  v_cvt_pk_bf16_f32 v214, v88, v89
  v_cvt_pk_bf16_f32 v215, v90, v91
  ds_write_b128 v70, v[212:215] offset:14336
  v_dot2_f32_bf16 v84, v216, s50, v81 neg_lo:[0,0,1]
  v_dot2_f32_bf16 v85, v216, s51, v81 neg_lo:[0,0,1]
  v_dot2_f32_bf16 v86, v217, s50, v81 neg_lo:[0,0,1]
  v_dot2_f32_bf16 v87, v217, s51, v81 neg_lo:[0,0,1]
  v_dot2_f32_bf16 v88, v218, s50, v81 neg_lo:[0,0,1]
  v_dot2_f32_bf16 v89, v218, s51, v81 neg_lo:[0,0,1]
  v_dot2_f32_bf16 v90, v219, s50, v81 neg_lo:[0,0,1]
  v_dot2_f32_bf16 v91, v219, s51, v81 neg_lo:[0,0,1]
  v_cvt_pk_bf16_f32 v216, v84, v85
  v_cvt_pk_bf16_f32 v217, v86, v87
  v_cvt_pk_bf16_f32 v218, v88, v89
  v_cvt_pk_bf16_f32 v219, v90, v91
  ds_write_b128 v70, v[216:219] offset:16384
  s_waitcnt lgkmcnt(0)
  s_barrier
  ds_read_b128 v[112:115], v71 offset:0
  ds_read_b128 v[116:119], v72 offset:1024
  ds_read_b128 v[120:123], v71 offset:2048
  ds_read_b128 v[124:127], v72 offset:3072
  ds_read_b128 v[128:131], v71 offset:4096
  ds_read_b128 v[132:135], v72 offset:5120
  ds_read_b128 v[136:139], v71 offset:6144
  ds_read_b128 v[140:143], v72 offset:7168
  ds_read_b128 v[144:147], v71 offset:8192
  ds_read_b128 v[148:151], v72 offset:9216
  ds_read_b128 v[152:155], v71 offset:10240
  ds_read_b128 v[156:159], v72 offset:11264
  ds_read_b128 v[160:163], v71 offset:12288
  ds_read_b128 v[164:167], v72 offset:13312
  ds_read_b128 v[168:171], v71 offset:14336
  ds_read_b128 v[172:175], v72 offset:15360
  ds_read_b128 v[176:179], v71 offset:16384
  ds_read_b128 v[180:183], v72 offset:17408
  s_waitcnt vmcnt(9)
  v_dot2_f32_bf16 v76, v220, s52, 0
  v_dot2_f32_bf16 v78, v220, v220, 0
  v_dot2_f32_bf16 v77, v221, s52, 0
  v_dot2_f32_bf16 v79, v221, v221, 0
  v_dot2_f32_bf16 v76, v222, s52, v76
  v_dot2_f32_bf16 v78, v222, v222, v78
  v_dot2_f32_bf16 v77, v223, s52, v77
  v_dot2_f32_bf16 v79, v223, v223, v79
  s_waitcnt vmcnt(8)
  v_dot2_f32_bf16 v76, v224, s52, v76
  v_dot2_f32_bf16 v78, v224, v224, v78
  v_dot2_f32_bf16 v77, v225, s52, v77
  v_dot2_f32_bf16 v79, v225, v225, v79
  v_dot2_f32_bf16 v76, v226, s52, v76
  v_dot2_f32_bf16 v78, v226, v226, v78
  v_dot2_f32_bf16 v77, v227, s52, v77
  v_dot2_f32_bf16 v79, v227, v227, v79
  s_waitcnt vmcnt(7)
  v_dot2_f32_bf16 v76, v228, s52, v76
  v_dot2_f32_bf16 v78, v228, v228, v78
  v_dot2_f32_bf16 v77, v229, s52, v77
  v_dot2_f32_bf16 v79, v229, v229, v79
  v_dot2_f32_bf16 v76, v230, s52, v76
  v_dot2_f32_bf16 v78, v230, v230, v78
  v_dot2_f32_bf16 v77, v231, s52, v77
  v_dot2_f32_bf16 v79, v231, v231, v79
  s_waitcnt vmcnt(6)
  v_dot2_f32_bf16 v76, v232, s52, v76
  v_dot2_f32_bf16 v78, v232, v232, v78
  v_dot2_f32_bf16 v77, v233, s52, v77
  v_dot2_f32_bf16 v79, v233, v233, v79
  v_dot2_f32_bf16 v76, v234, s52, v76
  v_dot2_f32_bf16 v78, v234, v234, v78
  v_dot2_f32_bf16 v77, v235, s52, v77
  v_dot2_f32_bf16 v79, v235, v235, v79
  s_waitcnt vmcnt(5)
  v_dot2_f32_bf16 v76, v236, s52, v76
  v_dot2_f32_bf16 v78, v236, v236, v78
  v_dot2_f32_bf16 v77, v237, s52, v77
  v_dot2_f32_bf16 v79, v237, v237, v79
  v_dot2_f32_bf16 v76, v238, s52, v76
  v_dot2_f32_bf16 v78, v238, v238, v78
  v_dot2_f32_bf16 v77, v239, s52, v77
  v_dot2_f32_bf16 v79, v239, v239, v79
  s_waitcnt vmcnt(4)
  v_dot2_f32_bf16 v76, v240, s52, v76
  v_dot2_f32_bf16 v78, v240, v240, v78
  v_dot2_f32_bf16 v77, v241, s52, v77
  v_dot2_f32_bf16 v79, v241, v241, v79
  v_dot2_f32_bf16 v76, v242, s52, v76
  v_dot2_f32_bf16 v78, v242, v242, v78
  v_dot2_f32_bf16 v77, v243, s52, v77
  v_dot2_f32_bf16 v79, v243, v243, v79
  s_waitcnt vmcnt(3)
  s_add_u32 m0, s35, 0
  s_add_u32 s49, s21, 0
  buffer_load_dwordx4 v1, s[8:11], s49 offen lds
  v_dot2_f32_bf16 v76, v244, s52, v76
  v_dot2_f32_bf16 v78, v244, v244, v78
  v_dot2_f32_bf16 v77, v245, s52, v77
  v_dot2_f32_bf16 v79, v245, v245, v79
  v_dot2_f32_bf16 v76, v246, s52, v76
  v_dot2_f32_bf16 v78, v246, v246, v78
  v_dot2_f32_bf16 v77, v247, s52, v77
  v_dot2_f32_bf16 v79, v247, v247, v79
  s_waitcnt vmcnt(3)
  s_add_u32 m0, s35, 1024
  s_add_u32 s49, s21, 128
  buffer_load_dwordx4 v1, s[8:11], s49 offen lds
  v_dot2_f32_bf16 v76, v248, s52, v76
  v_dot2_f32_bf16 v78, v248, v248, v78
  v_dot2_f32_bf16 v77, v249, s52, v77
  v_dot2_f32_bf16 v79, v249, v249, v79
  v_dot2_f32_bf16 v76, v250, s52, v76
  v_dot2_f32_bf16 v78, v250, v250, v78
  v_dot2_f32_bf16 v77, v251, s52, v77
  v_dot2_f32_bf16 v79, v251, v251, v79
  s_waitcnt vmcnt(3)
  s_add_u32 m0, s35, 2048
  s_add_u32 s49, s21, 256
  buffer_load_dwordx4 v1, s[8:11], s49 offen lds
  s_mov_b32 exec_lo, 0x3fe00
  s_mov_b32 exec_hi, 0x0
  buffer_load_dword v14, v104, s[8:11], s57 offen
  s_mov_b64 exec, -1
  v_dot2_f32_bf16 v76, v252, s52, v76
  v_dot2_f32_bf16 v78, v252, v252, v78
  v_dot2_f32_bf16 v77, v253, s52, v77
  v_dot2_f32_bf16 v79, v253, v253, v79
  v_dot2_f32_bf16 v76, v254, s52, v76
  v_dot2_f32_bf16 v78, v254, v254, v78
  v_dot2_f32_bf16 v77, v255, s52, v77
  v_dot2_f32_bf16 v79, v255, v255, v79
  s_nop 1
  v_add_f32 v76, v76, v77
  v_add_f32 v78, v78, v79
  s_nop 0
  v_add_f32_dpp v76, v76, v76 quad_perm:[1,0,3,2] row_mask:0xf bank_mask:0xf
  v_add_f32_dpp v78, v78, v78 quad_perm:[1,0,3,2] row_mask:0xf bank_mask:0xf
  s_nop 0
  v_add_f32_dpp v76, v76, v76 quad_perm:[2,3,0,1] row_mask:0xf bank_mask:0xf
  v_add_f32_dpp v78, v78, v78 quad_perm:[2,3,0,1] row_mask:0xf bank_mask:0xf
  s_nop 0
  v_add_f32_dpp v76, v76, v76 row_half_mirror row_mask:0xf bank_mask:0xf
  v_add_f32_dpp v78, v78, v78 row_half_mirror row_mask:0xf bank_mask:0xf
  v_mul_f32 v76, 0x3ae38e39, v76
  v_mul_f32 v78, 0x3ae38e39, v78
  v_fma_f32 v78, -v76, v76, v78
  v_max_f32 v78, 0, v78
  v_cvt_pk_bf16_f32 v77, v76, v78
  v_lshlrev_b32 v81, 16, v77
  v_and_b32 v78, 0xffff0000, v77
  v_add_f32 v78, 0x3727c5ac, v78
  v_cvt_pk_bf16_f32 v78, v78, v78
  v_and_b32 v78, 0xffff0000, v78
  v_sqrt_f32 v78, v78
  s_nop 0
  v_cvt_pk_bf16_f32 v78, v78, v78
  v_and_b32 v80, 0xffff0000, v78
  ds_write_b64 v82, v[80:81] offset:32
  v_rcp_f32 v92, v80
  v_lshrrev_b32 v93, 1, v75
  v_add_u32 v93, 159488, v93
  ds_write_b32 v93, v92 offset:16
  s_waitcnt lgkmcnt(0)
  s_barrier
  v_dot2_f32_bf16 v84, v220, s50, v81 neg_lo:[0,0,1]
  v_dot2_f32_bf16 v85, v220, s51, v81 neg_lo:[0,0,1]
  v_dot2_f32_bf16 v86, v221, s50, v81 neg_lo:[0,0,1]
  v_dot2_f32_bf16 v87, v221, s51, v81 neg_lo:[0,0,1]
  v_dot2_f32_bf16 v88, v222, s50, v81 neg_lo:[0,0,1]
  v_dot2_f32_bf16 v89, v222, s51, v81 neg_lo:[0,0,1]
  v_dot2_f32_bf16 v90, v223, s50, v81 neg_lo:[0,0,1]
  v_dot2_f32_bf16 v91, v223, s51, v81 neg_lo:[0,0,1]
  v_cvt_pk_bf16_f32 v220, v84, v85
  v_cvt_pk_bf16_f32 v221, v86, v87
  v_cvt_pk_bf16_f32 v222, v88, v89
  v_cvt_pk_bf16_f32 v223, v90, v91
  ds_write_b128 v70, v[220:223] offset:0
  s_add_u32 m0, s35, 24576
  s_add_u32 s49, s21, 768
  buffer_load_dwordx4 v1, s[8:11], s49 offen lds
  v_dot2_f32_bf16 v84, v224, s50, v81 neg_lo:[0,0,1]
  v_dot2_f32_bf16 v85, v224, s51, v81 neg_lo:[0,0,1]
  v_dot2_f32_bf16 v86, v225, s50, v81 neg_lo:[0,0,1]
  v_dot2_f32_bf16 v87, v225, s51, v81 neg_lo:[0,0,1]
  v_dot2_f32_bf16 v88, v226, s50, v81 neg_lo:[0,0,1]
  v_dot2_f32_bf16 v89, v226, s51, v81 neg_lo:[0,0,1]
  v_dot2_f32_bf16 v90, v227, s50, v81 neg_lo:[0,0,1]
  v_dot2_f32_bf16 v91, v227, s51, v81 neg_lo:[0,0,1]
  v_cvt_pk_bf16_f32 v224, v84, v85
  v_cvt_pk_bf16_f32 v225, v86, v87
  v_cvt_pk_bf16_f32 v226, v88, v89
  v_cvt_pk_bf16_f32 v227, v90, v91
  ds_write_b128 v70, v[224:227] offset:2048
  s_add_u32 m0, s35, 25600
  s_add_u32 s49, s21, 896
  buffer_load_dwordx4 v1, s[8:11], s49 offen lds
  v_dot2_f32_bf16 v84, v228, s50, v81 neg_lo:[0,0,1]
  v_dot2_f32_bf16 v85, v228, s51, v81 neg_lo:[0,0,1]
  v_dot2_f32_bf16 v86, v229, s50, v81 neg_lo:[0,0,1]
  v_dot2_f32_bf16 v87, v229, s51, v81 neg_lo:[0,0,1]
  v_dot2_f32_bf16 v88, v230, s50, v81 neg_lo:[0,0,1]
  v_dot2_f32_bf16 v89, v230, s51, v81 neg_lo:[0,0,1]
  v_dot2_f32_bf16 v90, v231, s50, v81 neg_lo:[0,0,1]
  v_dot2_f32_bf16 v91, v231, s51, v81 neg_lo:[0,0,1]
  v_cvt_pk_bf16_f32 v228, v84, v85
  v_cvt_pk_bf16_f32 v229, v86, v87
  v_cvt_pk_bf16_f32 v230, v88, v89
  v_cvt_pk_bf16_f32 v231, v90, v91
  ds_write_b128 v70, v[228:231] offset:4096
  s_add_u32 m0, s35, 26624
  s_add_u32 s49, s21, 1024
  buffer_load_dwordx4 v1, s[8:11], s49 offen lds
  v_dot2_f32_bf16 v84, v232, s50, v81 neg_lo:[0,0,1]
  v_dot2_f32_bf16 v85, v232, s51, v81 neg_lo:[0,0,1]
  v_dot2_f32_bf16 v86, v233, s50, v81 neg_lo:[0,0,1]
  v_dot2_f32_bf16 v87, v233, s51, v81 neg_lo:[0,0,1]
  v_dot2_f32_bf16 v88, v234, s50, v81 neg_lo:[0,0,1]
  v_dot2_f32_bf16 v89, v234, s51, v81 neg_lo:[0,0,1]
  v_dot2_f32_bf16 v90, v235, s50, v81 neg_lo:[0,0,1]
  v_dot2_f32_bf16 v91, v235, s51, v81 neg_lo:[0,0,1]
  v_cvt_pk_bf16_f32 v232, v84, v85
  v_cvt_pk_bf16_f32 v233, v86, v87
  v_cvt_pk_bf16_f32 v234, v88, v89
  v_cvt_pk_bf16_f32 v235, v90, v91
  ds_write_b128 v70, v[232:235] offset:6144
  s_add_u32 m0, s35, 49152
  s_add_u32 s49, s32, 0
  buffer_load_dwordx4 v1, s[8:11], s49 offen lds
  v_dot2_f32_bf16 v84, v236, s50, v81 neg_lo:[0,0,1]
  v_dot2_f32_bf16 v85, v236, s51, v81 neg_lo:[0,0,1]
  v_dot2_f32_bf16 v86, v237, s50, v81 neg_lo:[0,0,1]
  v_dot2_f32_bf16 v87, v237, s51, v81 neg_lo:[0,0,1]
  v_dot2_f32_bf16 v88, v238, s50, v81 neg_lo:[0,0,1]
  v_dot2_f32_bf16 v89, v238, s51, v81 neg_lo:[0,0,1]
  v_dot2_f32_bf16 v90, v239, s50, v81 neg_lo:[0,0,1]
  v_dot2_f32_bf16 v91, v239, s51, v81 neg_lo:[0,0,1]
  v_cvt_pk_bf16_f32 v236, v84, v85
  v_cvt_pk_bf16_f32 v237, v86, v87
  v_cvt_pk_bf16_f32 v238, v88, v89
  v_cvt_pk_bf16_f32 v239, v90, v91
  ds_write_b128 v70, v[236:239] offset:8192
  s_add_u32 m0, s35, 50176
  s_add_u32 s49, s32, 128
  buffer_load_dwordx4 v1, s[8:11], s49 offen lds
  v_dot2_f32_bf16 v84, v240, s50, v81 neg_lo:[0,0,1]
  v_dot2_f32_bf16 v85, v240, s51, v81 neg_lo:[0,0,1]
  v_dot2_f32_bf16 v86, v241, s50, v81 neg_lo:[0,0,1]
  v_dot2_f32_bf16 v87, v241, s51, v81 neg_lo:[0,0,1]
  v_dot2_f32_bf16 v88, v242, s50, v81 neg_lo:[0,0,1]
  v_dot2_f32_bf16 v89, v242, s51, v81 neg_lo:[0,0,1]
  v_dot2_f32_bf16 v90, v243, s50, v81 neg_lo:[0,0,1]
  v_dot2_f32_bf16 v91, v243, s51, v81 neg_lo:[0,0,1]
  v_cvt_pk_bf16_f32 v240, v84, v85
  v_cvt_pk_bf16_f32 v241, v86, v87
  v_cvt_pk_bf16_f32 v242, v88, v89
  v_cvt_pk_bf16_f32 v243, v90, v91
  ds_write_b128 v70, v[240:243] offset:10240
  s_add_u32 m0, s35, 51200
  s_add_u32 s49, s32, 256
  buffer_load_dwordx4 v1, s[8:11], s49 offen lds
  v_dot2_f32_bf16 v84, v244, s50, v81 neg_lo:[0,0,1]
  v_dot2_f32_bf16 v85, v244, s51, v81 neg_lo:[0,0,1]
  v_dot2_f32_bf16 v86, v245, s50, v81 neg_lo:[0,0,1]
  v_dot2_f32_bf16 v87, v245, s51, v81 neg_lo:[0,0,1]
  v_dot2_f32_bf16 v88, v246, s50, v81 neg_lo:[0,0,1]
  v_dot2_f32_bf16 v89, v246, s51, v81 neg_lo:[0,0,1]
  v_dot2_f32_bf16 v90, v247, s50, v81 neg_lo:[0,0,1]
  v_dot2_f32_bf16 v91, v247, s51, v81 neg_lo:[0,0,1]
  v_cvt_pk_bf16_f32 v244, v84, v85
  v_cvt_pk_bf16_f32 v245, v86, v87
  v_cvt_pk_bf16_f32 v246, v88, v89
  v_cvt_pk_bf16_f32 v247, v90, v91
  ds_write_b128 v70, v[244:247] offset:12288
  v_dot2_f32_bf16 v84, v248, s50, v81 neg_lo:[0,0,1]
  v_dot2_f32_bf16 v85, v248, s51, v81 neg_lo:[0,0,1]
  v_dot2_f32_bf16 v86, v249, s50, v81 neg_lo:[0,0,1]
  v_dot2_f32_bf16 v87, v249, s51, v81 neg_lo:[0,0,1]
  v_dot2_f32_bf16 v88, v250, s50, v81 neg_lo:[0,0,1]
  v_dot2_f32_bf16 v89, v250, s51, v81 neg_lo:[0,0,1]
  v_dot2_f32_bf16 v90, v251, s50, v81 neg_lo:[0,0,1]
  v_dot2_f32_bf16 v91, v251, s51, v81 neg_lo:[0,0,1]
  v_cvt_pk_bf16_f32 v248, v84, v85
  v_cvt_pk_bf16_f32 v249, v86, v87
  v_cvt_pk_bf16_f32 v250, v88, v89
  v_cvt_pk_bf16_f32 v251, v90, v91
  ds_write_b128 v70, v[248:251] offset:14336
  v_dot2_f32_bf16 v84, v252, s50, v81 neg_lo:[0,0,1]
  v_dot2_f32_bf16 v85, v252, s51, v81 neg_lo:[0,0,1]
  v_dot2_f32_bf16 v86, v253, s50, v81 neg_lo:[0,0,1]
  v_dot2_f32_bf16 v87, v253, s51, v81 neg_lo:[0,0,1]
  v_dot2_f32_bf16 v88, v254, s50, v81 neg_lo:[0,0,1]
  v_dot2_f32_bf16 v89, v254, s51, v81 neg_lo:[0,0,1]
  v_dot2_f32_bf16 v90, v255, s50, v81 neg_lo:[0,0,1]
  v_dot2_f32_bf16 v91, v255, s51, v81 neg_lo:[0,0,1]
  v_cvt_pk_bf16_f32 v252, v84, v85
  v_cvt_pk_bf16_f32 v253, v86, v87
  v_cvt_pk_bf16_f32 v254, v88, v89
  v_cvt_pk_bf16_f32 v255, v90, v91
  ds_write_b128 v70, v[252:255] offset:16384
  s_waitcnt lgkmcnt(0)
  s_barrier
  ds_read_b128 v[184:187], v71 offset:0
  ds_read_b128 v[188:191], v72 offset:1024
  ds_read_b128 v[192:195], v71 offset:2048
  ds_read_b128 v[196:199], v72 offset:3072
  ds_read_b128 v[200:203], v71 offset:4096
  ds_read_b128 v[204:207], v72 offset:5120
  ds_read_b128 v[208:211], v71 offset:6144
  ds_read_b128 v[212:215], v72 offset:7168
  ds_read_b128 v[216:219], v71 offset:8192
  ds_read_b128 v[220:223], v72 offset:9216
  ds_read_b128 v[224:227], v71 offset:10240
  ds_read_b128 v[228:231], v72 offset:11264
  ds_read_b128 v[232:235], v71 offset:12288
  ds_read_b128 v[236:239], v72 offset:13312
  ds_read_b128 v[240:243], v71 offset:14336
  ds_read_b128 v[244:247], v72 offset:15360
  ds_read_b128 v[248:251], v71 offset:16384
  ds_read_b128 v[252:255], v72 offset:17408
  s_waitcnt lgkmcnt(0)
  s_waitcnt vmcnt(3)
  s_barrier
  ds_read_b128 v[16:19], v2 offset:0
  ds_read_b128 v[20:23], v3 offset:0
  ds_read_b128 v[24:27], v2 offset:1024
  s_waitcnt lgkmcnt(2)
  v_mfma_f32_16x16x32_bf16 v[32:35], v[112:115], v[16:19], 0
  ds_write_b64 v47, v[48:49] offset:0
  ds_write_b64 v47, v[50:51] offset:1152
  ds_read_b128 v[28:31], v3 offset:1024
  v_mfma_f32_16x16x32_bf16 v[36:39], v[184:187], v[16:19], 0
  ds_write_b64 v47, v[52:53] offset:2304
  ds_write_b64 v47, v[54:55] offset:3456
  s_waitcnt lgkmcnt(6)
  v_mfma_f32_16x16x32_bf16 v[32:35], v[116:119], v[20:23], v[32:35]
  s_add_u32 m0, s35, 73728
  s_add_u32 s49, s32, 384
  buffer_load_dwordx4 v1, s[8:11], s49 offen lds
  ds_read_b128 v[16:19], v2 offset:2048
  v_mfma_f32_16x16x32_bf16 v[36:39], v[188:191], v[20:23], v[36:39]
  ds_write_b64 v47, v[56:57] offset:4608
  ds_write_b64 v47, v[58:59] offset:5760
  s_waitcnt lgkmcnt(8)
  v_mfma_f32_16x16x32_bf16 v[32:35], v[120:123], v[24:27], v[32:35]
  ds_write_b64 v47, v[60:61] offset:6912
  ds_write_b64 v47, v[62:63] offset:8064
  ds_read_b128 v[20:23], v3 offset:2048
  v_mfma_f32_16x16x32_bf16 v[36:39], v[192:195], v[24:27], v[36:39]
  s_mul_i32 s30, s30, 0x9E3779B1
  s_add_u32 s30, s30, 0x7F4A7C15
  s_mul_i32 s31, s30, 0x85EBCA6B
  s_xor_b32 s31, s31, 0x5bd1e995
  s_andn2_b32 s31, s31, 15
  s_waitcnt lgkmcnt(8)
  v_mfma_f32_16x16x32_bf16 v[32:35], v[124:127], v[28:31], v[32:35]
  s_mul_i32 s34, s34, 0x9E3779B1
  s_add_u32 s34, s34, 0x7F4A7C15
  s_mul_i32 s38, s34, 0x85EBCA6B
  s_xor_b32 s38, s38, 0x5bd1e995
  s_andn2_b32 s38, s38, 15
  ds_read_b128 v[24:27], v2 offset:12288
  v_mfma_f32_16x16x32_bf16 v[36:39], v[196:199], v[28:31], v[36:39]
  s_lshl_b32 s46, s27, 3
  s_add_u32 s46, s46, s24
  s_mul_i32 s46, s46, 288
  s_mul_i32 s47, s28, 36864
  s_add_u32 s46, s46, s47
  s_waitcnt lgkmcnt(6)
  v_mfma_f32_16x16x32_bf16 v[32:35], v[128:131], v[16:19], v[32:35]
  s_add_u32 s46, s46, 262144
  ds_read_b128 v[28:31], v3 offset:12288
  v_mfma_f32_16x16x32_bf16 v[36:39], v[200:203], v[16:19], v[36:39]
  s_mov_b32 exec_lo, 0x7
  s_mov_b32 exec_hi, 0x0
  buffer_load_dword v14, v104, s[16:19], s46 offen sc1
  s_mov_b64 exec, -1
  s_waitcnt lgkmcnt(2)
  v_mfma_f32_16x16x32_bf16 v[32:35], v[132:135], v[20:23], v[32:35]
  s_add_u32 m0, s35, 74752
  s_add_u32 s49, s32, 512
  buffer_load_dwordx4 v1, s[8:11], s49 offen lds
  ds_read_b128 v[16:19], v2 offset:13312
  v_mfma_f32_16x16x32_bf16 v[36:39], v[204:207], v[20:23], v[36:39]
  s_waitcnt lgkmcnt(2)
  v_mfma_f32_16x16x32_bf16 v[32:35], v[136:139], v[24:27], v[32:35]
  ds_read_b128 v[20:23], v3 offset:13312
  v_mfma_f32_16x16x32_bf16 v[36:39], v[208:211], v[24:27], v[36:39]
  s_waitcnt lgkmcnt(2)
  v_mfma_f32_16x16x32_bf16 v[32:35], v[140:143], v[28:31], v[32:35]
  ds_read_b128 v[24:27], v2 offset:14336
  v_mfma_f32_16x16x32_bf16 v[36:39], v[212:215], v[28:31], v[36:39]
  s_waitcnt lgkmcnt(2)
  v_mfma_f32_16x16x32_bf16 v[32:35], v[144:147], v[16:19], v[32:35]
  ds_read_b128 v[28:31], v3 offset:14336
  v_mfma_f32_16x16x32_bf16 v[36:39], v[216:219], v[16:19], v[36:39]
  s_waitcnt lgkmcnt(2)
  v_mfma_f32_16x16x32_bf16 v[32:35], v[148:151], v[20:23], v[32:35]
  s_add_u32 m0, s35, 75776
  s_add_u32 s49, s32, 640
  buffer_load_dwordx4 v1, s[8:11], s49 offen lds
  ds_read_b128 v[16:19], v2 offset:24576
  v_mfma_f32_16x16x32_bf16 v[36:39], v[220:223], v[20:23], v[36:39]
  s_waitcnt lgkmcnt(2)
  v_mfma_f32_16x16x32_bf16 v[32:35], v[152:155], v[24:27], v[32:35]
  ds_read_b128 v[20:23], v3 offset:24576
  v_mfma_f32_16x16x32_bf16 v[36:39], v[224:227], v[24:27], v[36:39]
  s_waitcnt lgkmcnt(2)
  v_mfma_f32_16x16x32_bf16 v[32:35], v[156:159], v[28:31], v[32:35]
  ds_read_b128 v[24:27], v2 offset:25600
  v_mfma_f32_16x16x32_bf16 v[36:39], v[228:231], v[28:31], v[36:39]
  s_waitcnt vmcnt(4)
  s_barrier
  s_waitcnt lgkmcnt(2)
  v_mfma_f32_16x16x32_bf16 v[32:35], v[160:163], v[16:19], v[32:35]
  ds_read_b128 v[28:31], v3 offset:25600
  v_mfma_f32_16x16x32_bf16 v[36:39], v[232:235], v[16:19], v[36:39]
  s_waitcnt lgkmcnt(2)
  v_mfma_f32_16x16x32_bf16 v[32:35], v[164:167], v[20:23], v[32:35]
  s_add_u32 m0, s35, 0
  s_add_u32 s49, s32, 768
  buffer_load_dwordx4 v1, s[8:11], s49 offen lds
  ds_read_b128 v[16:19], v2 offset:26624
  v_mfma_f32_16x16x32_bf16 v[36:39], v[236:239], v[20:23], v[36:39]
  s_lshl_b32 s48, s25, 12
  s_add_u32 s48, s48, 98304
  v_add_u32 v8, s48, v0
  s_lshl_b32 s48, s26, 11
  v_add_u32 v9, s48, v8
  s_waitcnt lgkmcnt(2)
  v_mfma_f32_16x16x32_bf16 v[32:35], v[168:171], v[24:27], v[32:35]
  ds_read_b128 v[20:23], v3 offset:26624
  v_mfma_f32_16x16x32_bf16 v[36:39], v[240:243], v[24:27], v[36:39]
  s_waitcnt lgkmcnt(2)
  v_mfma_f32_16x16x32_bf16 v[32:35], v[172:175], v[28:31], v[32:35]
  s_add_u32 m0, s35, 1024
  s_add_u32 s49, s32, 896
  buffer_load_dwordx4 v1, s[8:11], s49 offen lds
  s_mul_i32 s49, s26, 6144
  s_add_u32 s49, s49, 49152
  v_add_u32 v2, s49, v2
  v_add_u32 v3, s49, v3
  ds_read_b128 v[24:27], v2 offset:0
  v_mfma_f32_16x16x32_bf16 v[36:39], v[244:247], v[28:31], v[36:39]
  s_waitcnt lgkmcnt(2)
  v_mfma_f32_16x16x32_bf16 v[32:35], v[176:179], v[16:19], v[32:35]
  s_mov_b32 exec_lo, 0xfffc0000
  s_mov_b32 exec_hi, 0xf
  buffer_load_dword v14, v104, s[8:11], s57 offen
  s_mov_b64 exec, -1
  ds_read_b128 v[28:31], v2 offset:6144
  v_mfma_f32_16x16x32_bf16 v[36:39], v[248:251], v[16:19], v[36:39]
  s_waitcnt lgkmcnt(2)
  v_mfma_f32_16x16x32_bf16 v[32:35], v[180:183], v[20:23], v[32:35]
  s_add_u32 m0, s35, 2048
  s_add_u32 s49, s32, 1024
  buffer_load_dwordx4 v1, s[8:11], s49 offen lds
  ds_read_b128 v[16:19], v3 offset:0
  v_mfma_f32_16x16x32_bf16 v[36:39], v[252:255], v[20:23], v[36:39]
  s_nop 2
  ds_write_b128 v9, v[32:35] offset:0
  s_nop 3
  ds_write_b128 v9, v[36:39] offset:1024
  s_waitcnt lgkmcnt(0)
  s_waitcnt vmcnt(4)
  s_barrier
  v_mfma_f32_16x16x32_bf16 v[48:51], v[112:115], v[24:27], 0
  ds_read_b128 v[32:35], v8 offset:0
  ds_read_b128 v[36:39], v8 offset:1024
  ds_read_b128 v[40:43], v8 offset:2048
  ds_read_b128 v[44:47], v8 offset:3072
  ds_read_b128 v[20:23], v3 offset:6144
  v_mfma_f32_16x16x32_bf16 v[52:55], v[184:187], v[24:27], 0
  ds_read_b128 v[96:99], v7
  ds_read_b128 v[100:103], v7 offset:16
  ds_read_b64 v[106:107], v4 offset:5632
  v_mfma_f32_16x16x32_bf16 v[56:59], v[112:115], v[28:31], 0
  s_add_u32 m0, s35, 24576
  s_add_u32 s49, s32, 36864
  buffer_load_dwordx4 v1, s[8:11], s49 offen lds
  ds_read_b128 v[24:27], v2 offset:1024
  v_mfma_f32_16x16x32_bf16 v[60:63], v[184:187], v[28:31], 0
  v_mfma_f32_16x16x32_bf16 v[48:51], v[116:119], v[16:19], v[48:51]
  ds_read_b128 v[28:31], v2 offset:7168
  v_mfma_f32_16x16x32_bf16 v[52:55], v[188:191], v[16:19], v[52:55]
  s_waitcnt lgkmcnt(5)
  v_mfma_f32_16x16x32_bf16 v[56:59], v[116:119], v[20:23], v[56:59]
  s_waitcnt lgkmcnt(2)
  v_mul_f32 v8, v32, v96
  v_mul_f32 v9, v40, v96
  ds_read_b128 v[16:19], v3 offset:1024
  v_mfma_f32_16x16x32_bf16 v[60:63], v[188:191], v[20:23], v[60:63]
  v_mul_f32 v10, v33, v97
  v_mul_f32 v11, v41, v97
  s_waitcnt lgkmcnt(2)
  v_mfma_f32_16x16x32_bf16 v[48:51], v[120:123], v[24:27], v[48:51]
  v_mul_f32 v32, v34, v98
  v_mul_f32 v33, v42, v98
  ds_read_b128 v[20:23], v3 offset:7168
  v_mfma_f32_16x16x32_bf16 v[52:55], v[192:195], v[24:27], v[52:55]
  v_mul_f32 v40, v35, v99
  v_mul_f32 v41, v43, v99
  s_waitcnt lgkmcnt(2)
  v_mfma_f32_16x16x32_bf16 v[56:59], v[120:123], v[28:31], v[56:59]
  s_add_u32 m0, s35, 25600
  s_add_u32 s49, s32, 36992
  buffer_load_dwordx4 v1, s[8:11], s49 offen lds
  ds_read_b128 v[24:27], v2 offset:2048
  v_mfma_f32_16x16x32_bf16 v[60:63], v[192:195], v[28:31], v[60:63]
  v_mul_f32 v34, v36, v100
  v_mul_f32 v35, v44, v100
  s_waitcnt lgkmcnt(2)
  v_mfma_f32_16x16x32_bf16 v[48:51], v[124:127], v[16:19], v[48:51]
  v_mul_f32 v42, v37, v101
  v_mul_f32 v43, v45, v101
  ds_read_b128 v[28:31], v2 offset:8192
  v_mfma_f32_16x16x32_bf16 v[52:55], v[196:199], v[16:19], v[52:55]
  v_mul_f32 v36, v38, v102
  v_mul_f32 v37, v46, v102
  s_waitcnt lgkmcnt(2)
  v_mfma_f32_16x16x32_bf16 v[56:59], v[124:127], v[20:23], v[56:59]
  v_mul_f32 v44, v39, v103
  v_mul_f32 v45, v47, v103
  ds_read_b128 v[16:19], v3 offset:2048
  v_mfma_f32_16x16x32_bf16 v[60:63], v[196:199], v[20:23], v[60:63]
  ds_read_b64 v[96:97], v4 offset:10240
  ds_read_b64 v[98:99], v4 offset:11392
  v_fma_f32 v110, v106, v8, v10
  s_waitcnt lgkmcnt(4)
  v_mfma_f32_16x16x32_bf16 v[48:51], v[128:131], v[24:27], v[48:51]
  v_fma_f32 v111, v106, v9, v11
  v_fma_f32 v110, -v107, v9, v110
  ds_read_b128 v[20:23], v3 offset:8192
  v_mfma_f32_16x16x32_bf16 v[52:55], v[200:203], v[24:27], v[52:55]
  v_fma_f32 v111, v107, v8, v111
  v_fma_f32 v108, v106, v110, v32
  s_waitcnt lgkmcnt(4)
  v_mfma_f32_16x16x32_bf16 v[56:59], v[128:131], v[28:31], v[56:59]
  s_add_u32 m0, s35, 26624
  s_add_u32 s49, s32, 37120
  buffer_load_dwordx4 v1, s[8:11], s49 offen lds
  ds_read_b128 v[24:27], v2 offset:24576
  v_mfma_f32_16x16x32_bf16 v[60:63], v[200:203], v[28:31], v[60:63]
  v_fma_f32 v109, v106, v111, v33
  v_fma_f32 v108, -v107, v111, v108
  s_waitcnt lgkmcnt(4)
  v_mfma_f32_16x16x32_bf16 v[48:51], v[132:135], v[16:19], v[48:51]
  v_fma_f32 v109, v107, v110, v109
  v_fma_f32 v110, v106, v108, v40
  ds_read_b128 v[28:31], v2 offset:30720
  v_mfma_f32_16x16x32_bf16 v[52:55], v[204:207], v[16:19], v[52:55]
  v_fma_f32 v111, v106, v109, v41
  v_fma_f32 v110, -v107, v109, v110
  s_waitcnt lgkmcnt(2)
  v_mfma_f32_16x16x32_bf16 v[56:59], v[132:135], v[20:23], v[56:59]
  v_fma_f32 v111, v107, v108, v111
  v_fma_f32 v108, v106, v110, v34
  ds_read_b128 v[16:19], v3 offset:24576
  v_mfma_f32_16x16x32_bf16 v[60:63], v[204:207], v[20:23], v[60:63]
  v_fma_f32 v109, v106, v111, v35
  v_fma_f32 v108, -v107, v111, v108
  s_waitcnt vmcnt(3)
  s_barrier
  s_waitcnt lgkmcnt(2)
  v_mfma_f32_16x16x32_bf16 v[48:51], v[136:139], v[24:27], v[48:51]
  v_fma_f32 v109, v107, v110, v109
  v_fma_f32 v110, v106, v108, v42
  ds_read_b128 v[20:23], v3 offset:30720
  v_mfma_f32_16x16x32_bf16 v[52:55], v[208:211], v[24:27], v[52:55]
  v_fma_f32 v111, v106, v109, v43
  v_fma_f32 v110, -v107, v109, v110
  s_waitcnt lgkmcnt(2)
  v_mfma_f32_16x16x32_bf16 v[56:59], v[136:139], v[28:31], v[56:59]
  s_add_u32 m0, s35, 49152
  s_add_u32 s49, s32, 37248
  buffer_load_dwordx4 v1, s[8:11], s49 offen lds
  ds_read_b128 v[24:27], v2 offset:25600
  v_mfma_f32_16x16x32_bf16 v[60:63], v[208:211], v[28:31], v[60:63]
  v_fma_f32 v111, v107, v108, v111
  v_fma_f32 v108, v106, v110, v36
  s_waitcnt lgkmcnt(2)
  v_mfma_f32_16x16x32_bf16 v[48:51], v[140:143], v[16:19], v[48:51]
  v_fma_f32 v109, v106, v111, v37
  v_fma_f32 v108, -v107, v111, v108
  ds_read_b128 v[28:31], v2 offset:31744
  v_mfma_f32_16x16x32_bf16 v[52:55], v[212:215], v[16:19], v[52:55]
  v_fma_f32 v109, v107, v110, v109
  v_fma_f32 v110, v106, v108, v44
  s_waitcnt lgkmcnt(2)
  v_mfma_f32_16x16x32_bf16 v[56:59], v[140:143], v[20:23], v[56:59]
  v_fma_f32 v111, v106, v109, v45
  v_fma_f32 v110, -v107, v109, v110
  ds_read_b128 v[16:19], v3 offset:25600
  v_mfma_f32_16x16x32_bf16 v[60:63], v[212:215], v[20:23], v[60:63]
  v_fma_f32 v111, v107, v108, v111
  v_mov_b32 v108, v110
  s_waitcnt lgkmcnt(2)
  v_mfma_f32_16x16x32_bf16 v[48:51], v[144:147], v[24:27], v[48:51]
  v_mov_b32 v109, v111
  ds_read_b128 v[20:23], v3 offset:31744
  v_mfma_f32_16x16x32_bf16 v[52:55], v[216:219], v[24:27], v[52:55]
  v_permlane16_swap_b32 v110, v108
  s_waitcnt lgkmcnt(2)
  v_mfma_f32_16x16x32_bf16 v[56:59], v[144:147], v[28:31], v[56:59]
  s_add_u32 m0, s35, 50176
  s_add_u32 s49, s32, 37376
  buffer_load_dwordx4 v1, s[8:11], s49 offen lds
  ds_read_b128 v[24:27], v2 offset:26624
  v_mfma_f32_16x16x32_bf16 v[60:63], v[216:219], v[28:31], v[60:63]
  v_permlane16_swap_b32 v111, v109
  s_waitcnt lgkmcnt(2)
  v_mfma_f32_16x16x32_bf16 v[48:51], v[148:151], v[16:19], v[48:51]
  v_fma_f32 v100, v96, v110, v108
  v_fma_f32 v101, v96, v111, v109
  ds_read_b128 v[28:31], v2 offset:32768
  v_mfma_f32_16x16x32_bf16 v[52:55], v[220:223], v[16:19], v[52:55]
  v_fma_f32 v100, -v97, v111, v100
  v_fma_f32 v101, v97, v110, v101
  s_waitcnt lgkmcnt(2)
  v_mfma_f32_16x16x32_bf16 v[56:59], v[148:151], v[20:23], v[56:59]
  v_mov_b32 v102, v100
  v_mov_b32 v103, v101
  ds_read_b128 v[16:19], v3 offset:26624
  v_mfma_f32_16x16x32_bf16 v[60:63], v[220:223], v[20:23], v[60:63]
  v_permlane32_swap_b32 v100, v102
  s_waitcnt lgkmcnt(2)
  v_mfma_f32_16x16x32_bf16 v[48:51], v[152:155], v[24:27], v[48:51]
  v_permlane32_swap_b32 v101, v103
  ds_read_b128 v[20:23], v3 offset:32768
  v_mfma_f32_16x16x32_bf16 v[52:55], v[224:227], v[24:27], v[52:55]
  v_fma_f32 v102, v98, v100, v102
  v_fma_f32 v103, v98, v101, v103
  s_waitcnt lgkmcnt(2)
  v_mfma_f32_16x16x32_bf16 v[56:59], v[152:155], v[28:31], v[56:59]
  s_add_u32 m0, s35, 51200
  s_add_u32 s49, s32, 37504
  buffer_load_dwordx4 v1, s[8:11], s49 offen lds
  v_add_u32 v2, 4294918144, v2
  v_add_u32 v3, 4294918144, v3
  ds_read_b128 v[24:27], v2 offset:0
  v_mfma_f32_16x16x32_bf16 v[60:63], v[224:227], v[28:31], v[60:63]
  v_fma_f32 v102, -v99, v101, v102
  v_fma_f32 v103, v99, v100, v103
  ds_write_b64 v6, v[102:103] offset:7552
  s_waitcnt lgkmcnt(3)
  v_mfma_f32_16x16x32_bf16 v[48:51], v[156:159], v[16:19], v[48:51]
  v_cndmask_b32 v104, 0, v100, s[40:41]
  v_cndmask_b32 v105, 0, v101, s[40:41]
  ds_read_b128 v[28:31], v2 offset:6144
  v_mfma_f32_16x16x32_bf16 v[52:55], v[228:231], v[16:19], v[52:55]
  v_fma_f32 v110, v96, v104, v110
  v_fma_f32 v111, v96, v105, v111
  s_waitcnt lgkmcnt(3)
  v_mfma_f32_16x16x32_bf16 v[56:59], v[156:159], v[20:23], v[56:59]
  v_fma_f32 v110, -v97, v105, v110
  v_fma_f32 v111, v97, v104, v111
  ds_read_b128 v[16:19], v3 offset:0
  v_mfma_f32_16x16x32_bf16 v[60:63], v[228:231], v[20:23], v[60:63]
  v_cndmask_b32 v38, v104, v110, s[36:37]
  v_cndmask_b32 v39, v105, v111, s[36:37]
  s_waitcnt lgkmcnt(2)
  s_waitcnt vmcnt(3)
  s_barrier
  v_mfma_f32_16x16x32_bf16 v[48:51], v[160:163], v[24:27], v[48:51]
  ds_read_b64 v[96:97], v6 offset:7168
  ds_read_b64 v[98:99], v6 offset:7296
  ds_read_b64 v[100:101], v6 offset:7424
  ds_read_b64 v[108:109], v6 offset:7552
  ds_read_b128 v[20:23], v3 offset:6144
  v_mfma_f32_16x16x32_bf16 v[52:55], v[232:235], v[24:27], v[52:55]
  ds_read_b64 v[104:105], v4 offset:13696
  ds_read_b64 v[106:107], v5 offset:9088
  v_mov_b32 v110, s34
  s_waitcnt lgkmcnt(8)
  v_mfma_f32_16x16x32_bf16 v[56:59], v[160:163], v[28:31], v[56:59]
  s_add_u32 m0, s35, 73728
  s_add_u32 s49, s32, 37632
  buffer_load_dwordx4 v1, s[8:11], s49 offen lds
  ds_read_b128 v[24:27], v2 offset:1024
  v_mfma_f32_16x16x32_bf16 v[60:63], v[232:235], v[28:31], v[60:63]
  v_mov_b32 v111, s38
  s_waitcnt lgkmcnt(8)
  v_mfma_f32_16x16x32_bf16 v[48:51], v[164:167], v[16:19], v[48:51]
  ds_read_b128 v[28:31], v2 offset:7168
  v_mfma_f32_16x16x32_bf16 v[52:55], v[236:239], v[16:19], v[52:55]
  s_waitcnt lgkmcnt(4)
  v_mfma_f32_16x16x32_bf16 v[56:59], v[164:167], v[20:23], v[56:59]
  s_add_u32 m0, s35, 74752
  s_add_u32 s49, s32, 37760
  buffer_load_dwordx4 v1, s[8:11], s49 offen lds
  ds_read_b128 v[16:19], v3 offset:1024
  v_mfma_f32_16x16x32_bf16 v[60:63], v[236:239], v[20:23], v[60:63]
  s_waitcnt lgkmcnt(3)
  v_fma_f32 v98, v104, v96, v98
  v_fma_f32 v99, v104, v97, v99
  s_waitcnt lgkmcnt(2)
  v_mfma_f32_16x16x32_bf16 v[48:51], v[168:171], v[24:27], v[48:51]
  v_fma_f32 v98, -v105, v97, v98
  v_fma_f32 v99, v105, v96, v99
  ds_read_b128 v[20:23], v3 offset:7168
  v_mfma_f32_16x16x32_bf16 v[52:55], v[240:243], v[24:27], v[52:55]
  v_fma_f32 v100, v104, v98, v100
  v_fma_f32 v101, v104, v99, v101
  s_waitcnt lgkmcnt(2)
  v_mfma_f32_16x16x32_bf16 v[56:59], v[168:171], v[28:31], v[56:59]
  s_add_u32 m0, s35, 75776
  s_add_u32 s49, s32, 37888
  buffer_load_dwordx4 v1, s[8:11], s49 offen lds
  ds_read_b128 v[24:27], v2 offset:2048
  v_mfma_f32_16x16x32_bf16 v[60:63], v[240:243], v[28:31], v[60:63]
  v_fma_f32 v100, -v105, v99, v100
  v_fma_f32 v101, v105, v98, v101
  s_waitcnt lgkmcnt(2)
  v_mfma_f32_16x16x32_bf16 v[48:51], v[172:175], v[16:19], v[48:51]
  v_fma_f32 v108, v104, v100, v108
  v_fma_f32 v109, v104, v101, v109
  ds_read_b128 v[28:31], v2 offset:8192
  v_mfma_f32_16x16x32_bf16 v[52:55], v[244:247], v[16:19], v[52:55]
  v_fma_f32 v108, -v105, v101, v108
  v_fma_f32 v109, v105, v100, v109
  s_waitcnt lgkmcnt(2)
  v_mfma_f32_16x16x32_bf16 v[56:59], v[172:175], v[20:23], v[56:59]
  s_add_u32 m0, s35, 98304
  s_add_u32 s49, s32, 73728
  buffer_load_dwordx4 v1, s[8:11], s49 offen lds
  ds_read_b128 v[16:19], v3 offset:2048
  v_mfma_f32_16x16x32_bf16 v[60:63], v[244:247], v[20:23], v[60:63]
  s_add_u32 s48, s55, 32768
  s_cmp_eq_u32 s26, 0
  s_cselect_b32 s48, s48, 0x70000000
  s_mov_b32 exec_lo, 0xffff
  s_mov_b32 exec_hi, 0x0
  buffer_store_dwordx4 v[108:111], v0, s[16:19], s48 offen sc1
  s_mov_b64 exec, -1
  s_waitcnt lgkmcnt(2)
  v_mfma_f32_16x16x32_bf16 v[48:51], v[176:179], v[24:27], v[48:51]
  v_fma_f32 v38, v106, v100, v38
  v_fma_f32 v39, v106, v101, v39
  ds_read_b128 v[20:23], v3 offset:8192
  v_mfma_f32_16x16x32_bf16 v[52:55], v[248:251], v[24:27], v[52:55]
  v_fma_f32 v38, -v107, v101, v38
  v_fma_f32 v39, v107, v100, v39
  s_waitcnt lgkmcnt(2)
  v_mfma_f32_16x16x32_bf16 v[56:59], v[176:179], v[28:31], v[56:59]
  s_add_u32 m0, s35, 99328
  s_add_u32 s49, s32, 73856
  buffer_load_dwordx4 v1, s[8:11], s49 offen lds
  ds_read_b128 v[24:27], v2 offset:24576
  v_mfma_f32_16x16x32_bf16 v[60:63], v[248:251], v[28:31], v[60:63]
  s_waitcnt lgkmcnt(2)
  v_mfma_f32_16x16x32_bf16 v[48:51], v[180:183], v[16:19], v[48:51]
  ds_read_b128 v[28:31], v2 offset:30720
  v_mfma_f32_16x16x32_bf16 v[52:55], v[252:255], v[16:19], v[52:55]
  s_waitcnt lgkmcnt(2)
  v_mfma_f32_16x16x32_bf16 v[56:59], v[180:183], v[20:23], v[56:59]
  s_add_u32 m0, s35, 100352
  s_add_u32 s49, s32, 73984
  buffer_load_dwordx4 v1, s[8:11], s49 offen lds
  ds_read_b128 v[16:19], v3 offset:24576
  v_mfma_f32_16x16x32_bf16 v[60:63], v[252:255], v[20:23], v[60:63]
  s_waitcnt vmcnt(6)
  s_barrier
  s_waitcnt lgkmcnt(2)
  v_mfma_f32_16x16x32_bf16 v[64:67], v[112:115], v[24:27], 0
  ds_read_b128 v[20:23], v3 offset:30720
  v_mfma_f32_16x16x32_bf16 v[68:71], v[184:187], v[24:27], 0
  s_waitcnt lgkmcnt(2)
  v_mfma_f32_16x16x32_bf16 v[72:75], v[112:115], v[28:31], 0
  s_add_u32 m0, s35, 0
  s_add_u32 s49, s32, 74112
  buffer_load_dwordx4 v1, s[8:11], s49 offen lds
  ds_read_b128 v[24:27], v2 offset:25600
  v_mfma_f32_16x16x32_bf16 v[76:79], v[184:187], v[28:31], 0
  ds_read_b128 v[96:99], v7
  ds_read_b128 v[100:103], v7 offset:16
  ds_read_b64 v[106:107], v4 offset:4608
  s_waitcnt lgkmcnt(5)
  v_mfma_f32_16x16x32_bf16 v[64:67], v[116:119], v[16:19], v[64:67]
  ds_read_b128 v[28:31], v2 offset:31744
  v_mfma_f32_16x16x32_bf16 v[68:71], v[188:191], v[16:19], v[68:71]
  s_waitcnt lgkmcnt(5)
  v_mfma_f32_16x16x32_bf16 v[72:75], v[116:119], v[20:23], v[72:75]
  ds_read_b128 v[16:19], v3 offset:25600
  v_mfma_f32_16x16x32_bf16 v[76:79], v[188:191], v[20:23], v[76:79]
  s_waitcnt lgkmcnt(2)
  v_mul_f32 v46, v48, v96
  v_mul_f32 v47, v56, v96
  v_mfma_f32_16x16x32_bf16 v[64:67], v[120:123], v[24:27], v[64:67]
  v_mul_f32 v12, v49, v97
  v_mul_f32 v13, v57, v97
  ds_read_b128 v[20:23], v3 offset:31744
  v_mfma_f32_16x16x32_bf16 v[68:71], v[192:195], v[24:27], v[68:71]
  v_mul_f32 v48, v50, v98
  v_mul_f32 v49, v58, v98
  s_waitcnt lgkmcnt(2)
  v_mfma_f32_16x16x32_bf16 v[72:75], v[120:123], v[28:31], v[72:75]
  s_add_u32 m0, s35, 1024
  s_add_u32 s49, s32, 74240
  buffer_load_dwordx4 v1, s[8:11], s49 offen lds
  ds_read_b128 v[24:27], v2 offset:26624
  v_mfma_f32_16x16x32_bf16 v[76:79], v[192:195], v[28:31], v[76:79]
  v_mul_f32 v56, v51, v99
  v_mul_f32 v57, v59, v99
  s_waitcnt lgkmcnt(2)
  v_mfma_f32_16x16x32_bf16 v[64:67], v[124:127], v[16:19], v[64:67]
  v_mul_f32 v50, v52, v100
  v_mul_f32 v51, v60, v100
  ds_read_b128 v[28:31], v2 offset:32768
  v_mfma_f32_16x16x32_bf16 v[68:71], v[196:199], v[16:19], v[68:71]
  v_mul_f32 v58, v53, v101
  v_mul_f32 v59, v61, v101
  s_waitcnt lgkmcnt(2)
  v_mfma_f32_16x16x32_bf16 v[72:75], v[124:127], v[20:23], v[72:75]
  v_mul_f32 v52, v54, v102
  v_mul_f32 v53, v62, v102
  ds_read_b128 v[16:19], v3 offset:26624
  v_mfma_f32_16x16x32_bf16 v[76:79], v[196:199], v[20:23], v[76:79]
  v_mul_f32 v60, v55, v103
  v_mul_f32 v61, v63, v103
  s_waitcnt lgkmcnt(2)
  v_mfma_f32_16x16x32_bf16 v[64:67], v[128:131], v[24:27], v[64:67]
  ds_read_b64 v[96:97], v4 offset:9216
  ds_read_b64 v[98:99], v4 offset:10368
  v_fma_f32 v110, v106, v46, v12
  ds_read_b128 v[20:23], v3 offset:32768
  v_mfma_f32_16x16x32_bf16 v[68:71], v[200:203], v[24:27], v[68:71]
  v_fma_f32 v111, v106, v47, v13
  v_fma_f32 v110, -v107, v47, v110
  s_waitcnt lgkmcnt(4)
  v_mfma_f32_16x16x32_bf16 v[72:75], v[128:131], v[28:31], v[72:75]
  s_add_u32 m0, s35, 2048
  s_add_u32 s49, s32, 74368
  buffer_load_dwordx4 v1, s[8:11], s49 offen lds
  v_add_u32 v2, 49152, v2
  v_add_u32 v3, 49152, v3
  ds_read_b128 v[24:27], v2 offset:0
  v_mfma_f32_16x16x32_bf16 v[76:79], v[200:203], v[28:31], v[76:79]
  v_fma_f32 v111, v107, v46, v111
  v_fma_f32 v108, v106, v110, v48
  s_waitcnt lgkmcnt(4)
  v_mfma_f32_16x16x32_bf16 v[64:67], v[132:135], v[16:19], v[64:67]
  v_fma_f32 v109, v106, v111, v49
  v_fma_f32 v108, -v107, v111, v108
  ds_read_b128 v[28:31], v2 offset:6144
  v_mfma_f32_16x16x32_bf16 v[68:71], v[204:207], v[16:19], v[68:71]
  v_fma_f32 v109, v107, v110, v109
  v_fma_f32 v110, v106, v108, v56
  s_waitcnt lgkmcnt(2)
  v_mfma_f32_16x16x32_bf16 v[72:75], v[132:135], v[20:23], v[72:75]
  v_fma_f32 v111, v106, v109, v57
  v_fma_f32 v110, -v107, v109, v110
  ds_read_b128 v[16:19], v3 offset:0
  v_mfma_f32_16x16x32_bf16 v[76:79], v[204:207], v[20:23], v[76:79]
  v_fma_f32 v111, v107, v108, v111
  v_fma_f32 v108, v106, v110, v50
  s_waitcnt vmcnt(6)
  s_barrier
  s_waitcnt lgkmcnt(2)
  v_mfma_f32_16x16x32_bf16 v[64:67], v[136:139], v[24:27], v[64:67]
  v_fma_f32 v109, v106, v111, v51
  v_fma_f32 v108, -v107, v111, v108
  ds_read_b128 v[20:23], v3 offset:6144
  v_mfma_f32_16x16x32_bf16 v[68:71], v[208:211], v[24:27], v[68:71]
  v_fma_f32 v109, v107, v110, v109
  v_fma_f32 v110, v106, v108, v58
  s_waitcnt lgkmcnt(2)
  v_mfma_f32_16x16x32_bf16 v[72:75], v[136:139], v[28:31], v[72:75]
  s_add_u32 m0, s35, 24576
  s_add_u32 s49, s32, 74496
  buffer_load_dwordx4 v1, s[8:11], s49 offen lds
  ds_read_b128 v[24:27], v2 offset:1024
  v_mfma_f32_16x16x32_bf16 v[76:79], v[208:211], v[28:31], v[76:79]
  v_fma_f32 v111, v106, v109, v59
  v_fma_f32 v110, -v107, v109, v110
  s_waitcnt lgkmcnt(2)
  v_mfma_f32_16x16x32_bf16 v[64:67], v[140:143], v[16:19], v[64:67]
  v_fma_f32 v111, v107, v108, v111
  v_fma_f32 v108, v106, v110, v52
  ds_read_b128 v[28:31], v2 offset:7168
  v_mfma_f32_16x16x32_bf16 v[68:71], v[212:215], v[16:19], v[68:71]
  v_fma_f32 v109, v106, v111, v53
  v_fma_f32 v108, -v107, v111, v108
  s_waitcnt lgkmcnt(2)
  v_mfma_f32_16x16x32_bf16 v[72:75], v[140:143], v[20:23], v[72:75]
  v_fma_f32 v109, v107, v110, v109
  v_fma_f32 v110, v106, v108, v60
  ds_read_b128 v[16:19], v3 offset:1024
  v_mfma_f32_16x16x32_bf16 v[76:79], v[212:215], v[20:23], v[76:79]
  v_fma_f32 v111, v106, v109, v61
  v_fma_f32 v110, -v107, v109, v110
  s_waitcnt lgkmcnt(2)
  v_mfma_f32_16x16x32_bf16 v[64:67], v[144:147], v[24:27], v[64:67]
  v_fma_f32 v111, v107, v108, v111
  v_mov_b32 v108, v110
  ds_read_b128 v[20:23], v3 offset:7168
  v_mfma_f32_16x16x32_bf16 v[68:71], v[216:219], v[24:27], v[68:71]
  v_mov_b32 v109, v111
  s_waitcnt lgkmcnt(2)
  v_mfma_f32_16x16x32_bf16 v[72:75], v[144:147], v[28:31], v[72:75]
  s_add_u32 m0, s35, 25600
  s_add_u32 s49, s32, 74624
  buffer_load_dwordx4 v1, s[8:11], s49 offen lds
  ds_read_b128 v[24:27], v2 offset:2048
  v_mfma_f32_16x16x32_bf16 v[76:79], v[216:219], v[28:31], v[76:79]
  v_permlane16_swap_b32 v110, v108
  s_waitcnt lgkmcnt(2)
  v_mfma_f32_16x16x32_bf16 v[64:67], v[148:151], v[16:19], v[64:67]
  v_permlane16_swap_b32 v111, v109
  ds_read_b128 v[28:31], v2 offset:8192
  v_mfma_f32_16x16x32_bf16 v[68:71], v[220:223], v[16:19], v[68:71]
  v_fma_f32 v100, v96, v110, v108
  v_fma_f32 v101, v96, v111, v109
  s_waitcnt lgkmcnt(2)
  v_mfma_f32_16x16x32_bf16 v[72:75], v[148:151], v[20:23], v[72:75]
  v_fma_f32 v100, -v97, v111, v100
  v_fma_f32 v101, v97, v110, v101
  ds_read_b128 v[16:19], v3 offset:2048
  v_mfma_f32_16x16x32_bf16 v[76:79], v[220:223], v[20:23], v[76:79]
  v_mov_b32 v102, v100
  v_mov_b32 v103, v101
  s_waitcnt lgkmcnt(2)
  v_mfma_f32_16x16x32_bf16 v[64:67], v[152:155], v[24:27], v[64:67]
  v_permlane32_swap_b32 v100, v102
  ds_read_b128 v[20:23], v3 offset:8192
  v_mfma_f32_16x16x32_bf16 v[68:71], v[224:227], v[24:27], v[68:71]
  v_permlane32_swap_b32 v101, v103
  s_waitcnt lgkmcnt(2)
  v_mfma_f32_16x16x32_bf16 v[72:75], v[152:155], v[28:31], v[72:75]
  s_add_u32 m0, s35, 26624
  s_add_u32 s49, s32, 74752
  buffer_load_dwordx4 v1, s[8:11], s49 offen lds
  ds_read_b128 v[24:27], v2 offset:24576
  v_mfma_f32_16x16x32_bf16 v[76:79], v[224:227], v[28:31], v[76:79]
  v_fma_f32 v102, v98, v100, v102
  v_fma_f32 v103, v98, v101, v103
  s_waitcnt lgkmcnt(2)
  v_mfma_f32_16x16x32_bf16 v[64:67], v[156:159], v[16:19], v[64:67]
  v_fma_f32 v102, -v99, v101, v102
  v_fma_f32 v103, v99, v100, v103
  ds_write_b64 v6, v[102:103] offset:384
  ds_read_b128 v[28:31], v2 offset:30720
  v_mfma_f32_16x16x32_bf16 v[68:71], v[228:231], v[16:19], v[68:71]
  v_cndmask_b32 v104, 0, v100, s[40:41]
  v_cndmask_b32 v105, 0, v101, s[40:41]
  s_waitcnt lgkmcnt(3)
  v_mfma_f32_16x16x32_bf16 v[72:75], v[156:159], v[20:23], v[72:75]
  v_fma_f32 v110, v96, v104, v110
  v_fma_f32 v111, v96, v105, v111
  ds_read_b128 v[16:19], v3 offset:24576
  v_mfma_f32_16x16x32_bf16 v[76:79], v[228:231], v[20:23], v[76:79]
  v_fma_f32 v110, -v97, v105, v110
  v_fma_f32 v111, v97, v104, v111
  v_cndmask_b32 v54, v104, v110, s[36:37]
  v_cndmask_b32 v55, v105, v111, s[36:37]
  s_waitcnt lgkmcnt(2)
  s_waitcnt vmcnt(6)
  s_barrier
  v_mfma_f32_16x16x32_bf16 v[64:67], v[160:163], v[24:27], v[64:67]
  ds_read_b64 v[96:97], v6 offset:0
  ds_read_b64 v[98:99], v6 offset:128
  ds_read_b64 v[100:101], v6 offset:256
  ds_read_b64 v[108:109], v6 offset:384
  ds_read_b128 v[20:23], v3 offset:30720
  v_mfma_f32_16x16x32_bf16 v[68:71], v[232:235], v[24:27], v[68:71]
  ds_read_b64 v[104:105], v4 offset:12672
  ds_read_b64 v[106:107], v5 offset:8064
  v_mov_b32 v110, s34
  s_waitcnt lgkmcnt(8)
  v_mfma_f32_16x16x32_bf16 v[72:75], v[160:163], v[28:31], v[72:75]
  s_add_u32 m0, s35, 49152
  s_add_u32 s49, s32, 110592
  buffer_load_dwordx4 v1, s[8:11], s49 offen lds
  ds_read_b128 v[24:27], v2 offset:25600
  v_mfma_f32_16x16x32_bf16 v[76:79], v[232:235], v[28:31], v[76:79]
  v_mov_b32 v111, s38
  s_waitcnt lgkmcnt(8)
  v_mfma_f32_16x16x32_bf16 v[64:67], v[164:167], v[16:19], v[64:67]
  ds_read_b128 v[28:31], v2 offset:31744
  v_mfma_f32_16x16x32_bf16 v[68:71], v[236:239], v[16:19], v[68:71]
  s_waitcnt lgkmcnt(4)
  v_mfma_f32_16x16x32_bf16 v[72:75], v[164:167], v[20:23], v[72:75]
  s_waitcnt lgkmcnt(2)
  v_fma_f32 v98, v104, v96, v98
  v_fma_f32 v99, v104, v97, v99
  ds_read_b128 v[16:19], v3 offset:25600
  v_mfma_f32_16x16x32_bf16 v[76:79], v[236:239], v[20:23], v[76:79]
  v_fma_f32 v98, -v105, v97, v98
  v_fma_f32 v99, v105, v96, v99
  s_waitcnt lgkmcnt(2)
  v_mfma_f32_16x16x32_bf16 v[64:67], v[168:171], v[24:27], v[64:67]
  v_fma_f32 v100, v104, v98, v100
  v_fma_f32 v101, v104, v99, v101
  ds_read_b128 v[20:23], v3 offset:31744
  v_mfma_f32_16x16x32_bf16 v[68:71], v[240:243], v[24:27], v[68:71]
  v_fma_f32 v100, -v105, v99, v100
  v_fma_f32 v101, v105, v98, v101
  s_waitcnt lgkmcnt(2)
  v_mfma_f32_16x16x32_bf16 v[72:75], v[168:171], v[28:31], v[72:75]
  s_add_u32 m0, s35, 50176
  s_add_u32 s49, s32, 110720
  buffer_load_dwordx4 v1, s[8:11], s49 offen lds
  ds_read_b128 v[24:27], v2 offset:26624
  v_mfma_f32_16x16x32_bf16 v[76:79], v[240:243], v[28:31], v[76:79]
  v_fma_f32 v108, v104, v100, v108
  v_fma_f32 v109, v104, v101, v109
  s_waitcnt lgkmcnt(2)
  v_mfma_f32_16x16x32_bf16 v[64:67], v[172:175], v[16:19], v[64:67]
  v_fma_f32 v108, -v105, v101, v108
  v_fma_f32 v109, v105, v100, v109
  ds_read_b128 v[28:31], v2 offset:32768
  v_mfma_f32_16x16x32_bf16 v[68:71], v[244:247], v[16:19], v[68:71]
  s_add_u32 s48, s55, 0
  s_mov_b32 exec_lo, 0xffff
  s_mov_b32 exec_hi, 0x0
  buffer_store_dwordx4 v[108:111], v0, s[16:19], s48 offen sc1
  s_mov_b64 exec, -1
  s_waitcnt lgkmcnt(2)
  v_mfma_f32_16x16x32_bf16 v[72:75], v[172:175], v[20:23], v[72:75]
  v_fma_f32 v54, v106, v100, v54
  v_fma_f32 v55, v106, v101, v55
  ds_read_b128 v[16:19], v3 offset:26624
  v_mfma_f32_16x16x32_bf16 v[76:79], v[244:247], v[20:23], v[76:79]
  v_fma_f32 v54, -v107, v101, v54
  v_fma_f32 v55, v107, v100, v55
  s_waitcnt lgkmcnt(2)
  v_mfma_f32_16x16x32_bf16 v[64:67], v[176:179], v[24:27], v[64:67]
  ds_read_b128 v[20:23], v3 offset:32768
  v_mfma_f32_16x16x32_bf16 v[68:71], v[248:251], v[24:27], v[68:71]
  s_waitcnt lgkmcnt(2)
  v_mfma_f32_16x16x32_bf16 v[72:75], v[176:179], v[28:31], v[72:75]
  s_add_u32 m0, s35, 51200
  s_add_u32 s49, s32, 110848
  buffer_load_dwordx4 v1, s[8:11], s49 offen lds
  v_add_u32 v2, 49152, v2
  v_add_u32 v3, 49152, v3
  ds_read_b128 v[24:27], v2 offset:0
  v_mfma_f32_16x16x32_bf16 v[76:79], v[248:251], v[28:31], v[76:79]
  s_waitcnt lgkmcnt(2)
  v_mfma_f32_16x16x32_bf16 v[64:67], v[180:183], v[16:19], v[64:67]
  ds_read_b128 v[28:31], v2 offset:6144
  v_mfma_f32_16x16x32_bf16 v[68:71], v[252:255], v[16:19], v[68:71]
  s_waitcnt lgkmcnt(2)
  v_mfma_f32_16x16x32_bf16 v[72:75], v[180:183], v[20:23], v[72:75]
  ds_read_b128 v[16:19], v3 offset:0
  v_mfma_f32_16x16x32_bf16 v[76:79], v[252:255], v[20:23], v[76:79]
  s_waitcnt vmcnt(6)
  s_barrier
  s_waitcnt lgkmcnt(2)
  v_mfma_f32_16x16x32_bf16 v[80:83], v[112:115], v[24:27], 0
  ds_read_b128 v[20:23], v3 offset:6144
  v_mfma_f32_16x16x32_bf16 v[84:87], v[184:187], v[24:27], 0
  s_waitcnt lgkmcnt(2)
  v_mfma_f32_16x16x32_bf16 v[88:91], v[112:115], v[28:31], 0
  s_add_u32 m0, s35, 73728
  s_add_u32 s49, s32, 110976
  buffer_load_dwordx4 v1, s[8:11], s49 offen lds
  ds_read_b128 v[24:27], v2 offset:1024
  v_mfma_f32_16x16x32_bf16 v[92:95], v[184:187], v[28:31], 0
  ds_read_b128 v[96:99], v7
  ds_read_b128 v[100:103], v7 offset:16
  ds_read_b64 v[106:107], v4 offset:4864
  s_waitcnt lgkmcnt(5)
  v_mfma_f32_16x16x32_bf16 v[80:83], v[116:119], v[16:19], v[80:83]
  ds_read_b128 v[28:31], v2 offset:7168
  v_mfma_f32_16x16x32_bf16 v[84:87], v[188:191], v[16:19], v[84:87]
  s_waitcnt lgkmcnt(5)
  v_mfma_f32_16x16x32_bf16 v[88:91], v[116:119], v[20:23], v[88:91]
  ds_read_b128 v[16:19], v3 offset:1024
  v_mfma_f32_16x16x32_bf16 v[92:95], v[188:191], v[20:23], v[92:95]
  s_waitcnt lgkmcnt(2)
  v_mul_f32 v62, v64, v96
  v_mul_f32 v63, v72, v96
  v_mfma_f32_16x16x32_bf16 v[80:83], v[120:123], v[24:27], v[80:83]
  v_mul_f32 v14, v65, v97
  v_mul_f32 v15, v73, v97
  ds_read_b128 v[20:23], v3 offset:7168
  v_mfma_f32_16x16x32_bf16 v[84:87], v[192:195], v[24:27], v[84:87]
  v_mul_f32 v64, v66, v98
  v_mul_f32 v65, v74, v98
  s_waitcnt lgkmcnt(2)
  v_mfma_f32_16x16x32_bf16 v[88:91], v[120:123], v[28:31], v[88:91]
  s_add_u32 m0, s35, 74752
  s_add_u32 s49, s32, 111104
  buffer_load_dwordx4 v1, s[8:11], s49 offen lds
  ds_read_b128 v[24:27], v2 offset:2048
  v_mfma_f32_16x16x32_bf16 v[92:95], v[192:195], v[28:31], v[92:95]
  v_mul_f32 v72, v67, v99
  v_mul_f32 v73, v75, v99
  s_waitcnt lgkmcnt(2)
  v_mfma_f32_16x16x32_bf16 v[80:83], v[124:127], v[16:19], v[80:83]
  v_mul_f32 v66, v68, v100
  v_mul_f32 v67, v76, v100
  ds_read_b128 v[28:31], v2 offset:8192
  v_mfma_f32_16x16x32_bf16 v[84:87], v[196:199], v[16:19], v[84:87]
  v_mul_f32 v74, v69, v101
  v_mul_f32 v75, v77, v101
  s_waitcnt lgkmcnt(2)
  v_mfma_f32_16x16x32_bf16 v[88:91], v[124:127], v[20:23], v[88:91]
  v_mul_f32 v68, v70, v102
  v_mul_f32 v69, v78, v102
  ds_read_b128 v[16:19], v3 offset:2048
  v_mfma_f32_16x16x32_bf16 v[92:95], v[196:199], v[20:23], v[92:95]
  v_mul_f32 v76, v71, v103
  v_mul_f32 v77, v79, v103
  s_waitcnt lgkmcnt(2)
  v_mfma_f32_16x16x32_bf16 v[80:83], v[128:131], v[24:27], v[80:83]
  ds_read_b64 v[96:97], v4 offset:9472
  ds_read_b64 v[98:99], v4 offset:10624
  v_fma_f32 v110, v106, v62, v14
  ds_read_b128 v[20:23], v3 offset:8192
  v_mfma_f32_16x16x32_bf16 v[84:87], v[200:203], v[24:27], v[84:87]
  v_fma_f32 v111, v106, v63, v15
  v_fma_f32 v110, -v107, v63, v110
  s_waitcnt lgkmcnt(4)
  v_mfma_f32_16x16x32_bf16 v[88:91], v[128:131], v[28:31], v[88:91]
  s_add_u32 m0, s35, 75776
  s_add_u32 s49, s32, 111232
  buffer_load_dwordx4 v1, s[8:11], s49 offen lds
  v_add_u32 v2, 4294868992, v2
  v_add_u32 v3, 4294868992, v3
  ds_read_b128 v[24:27], v2 offset:0
  v_mfma_f32_16x16x32_bf16 v[92:95], v[200:203], v[28:31], v[92:95]
  v_fma_f32 v111, v107, v62, v111
  v_fma_f32 v108, v106, v110, v64
  s_waitcnt lgkmcnt(4)
  v_mfma_f32_16x16x32_bf16 v[80:83], v[132:135], v[16:19], v[80:83]
  v_fma_f32 v109, v106, v111, v65
  v_fma_f32 v108, -v107, v111, v108
  ds_read_b128 v[28:31], v2 offset:6144
  v_mfma_f32_16x16x32_bf16 v[84:87], v[204:207], v[16:19], v[84:87]
  v_fma_f32 v109, v107, v110, v109
  v_fma_f32 v110, v106, v108, v72
  s_waitcnt lgkmcnt(2)
  v_mfma_f32_16x16x32_bf16 v[88:91], v[132:135], v[20:23], v[88:91]
  v_fma_f32 v111, v106, v109, v73
  v_fma_f32 v110, -v107, v109, v110
  ds_read_b128 v[16:19], v3 offset:0
  v_mfma_f32_16x16x32_bf16 v[92:95], v[204:207], v[20:23], v[92:95]
  v_fma_f32 v111, v107, v108, v111
  v_fma_f32 v108, v106, v110, v66
  s_waitcnt vmcnt(6)
  s_barrier
  s_waitcnt lgkmcnt(2)
  v_mfma_f32_16x16x32_bf16 v[80:83], v[136:139], v[24:27], v[80:83]
  v_fma_f32 v109, v106, v111, v67
  v_fma_f32 v108, -v107, v111, v108
  ds_read_b128 v[20:23], v3 offset:6144
  v_mfma_f32_16x16x32_bf16 v[84:87], v[208:211], v[24:27], v[84:87]
  v_fma_f32 v109, v107, v110, v109
  v_fma_f32 v110, v106, v108, v74
  s_waitcnt lgkmcnt(2)
  v_mfma_f32_16x16x32_bf16 v[88:91], v[136:139], v[28:31], v[88:91]
  s_add_u32 m0, s35, 98304
  s_add_u32 s49, s32, 111360
  buffer_load_dwordx4 v1, s[8:11], s49 offen lds
  ds_read_b128 v[24:27], v2 offset:1024
  v_mfma_f32_16x16x32_bf16 v[92:95], v[208:211], v[28:31], v[92:95]
  v_fma_f32 v111, v106, v109, v75
  v_fma_f32 v110, -v107, v109, v110
  s_waitcnt lgkmcnt(2)
  v_mfma_f32_16x16x32_bf16 v[80:83], v[140:143], v[16:19], v[80:83]
  v_fma_f32 v111, v107, v108, v111
  v_fma_f32 v108, v106, v110, v68
  ds_read_b128 v[28:31], v2 offset:7168
  v_mfma_f32_16x16x32_bf16 v[84:87], v[212:215], v[16:19], v[84:87]
  v_fma_f32 v109, v106, v111, v69
  v_fma_f32 v108, -v107, v111, v108
  s_waitcnt lgkmcnt(2)
  v_mfma_f32_16x16x32_bf16 v[88:91], v[140:143], v[20:23], v[88:91]
  v_fma_f32 v109, v107, v110, v109
  v_fma_f32 v110, v106, v108, v76
  ds_read_b128 v[16:19], v3 offset:1024
  v_mfma_f32_16x16x32_bf16 v[92:95], v[212:215], v[20:23], v[92:95]
  v_fma_f32 v111, v106, v109, v77
  v_fma_f32 v110, -v107, v109, v110
  s_waitcnt lgkmcnt(2)
  v_mfma_f32_16x16x32_bf16 v[80:83], v[144:147], v[24:27], v[80:83]
  v_fma_f32 v111, v107, v108, v111
  v_mov_b32 v108, v110
  ds_read_b128 v[20:23], v3 offset:7168
  v_mfma_f32_16x16x32_bf16 v[84:87], v[216:219], v[24:27], v[84:87]
  v_mov_b32 v109, v111
  s_waitcnt lgkmcnt(2)
  v_mfma_f32_16x16x32_bf16 v[88:91], v[144:147], v[28:31], v[88:91]
  s_add_u32 m0, s35, 99328
  s_add_u32 s49, s32, 111488
  buffer_load_dwordx4 v1, s[8:11], s49 offen lds
  ds_read_b128 v[24:27], v2 offset:2048
  v_mfma_f32_16x16x32_bf16 v[92:95], v[216:219], v[28:31], v[92:95]
  v_permlane16_swap_b32 v110, v108
  s_waitcnt lgkmcnt(2)
  v_mfma_f32_16x16x32_bf16 v[80:83], v[148:151], v[16:19], v[80:83]
  v_permlane16_swap_b32 v111, v109
  ds_read_b128 v[28:31], v2 offset:8192
  v_mfma_f32_16x16x32_bf16 v[84:87], v[220:223], v[16:19], v[84:87]
  v_fma_f32 v100, v96, v110, v108
  v_fma_f32 v101, v96, v111, v109
  s_waitcnt lgkmcnt(2)
  v_mfma_f32_16x16x32_bf16 v[88:91], v[148:151], v[20:23], v[88:91]
  v_fma_f32 v100, -v97, v111, v100
  v_fma_f32 v101, v97, v110, v101
  ds_read_b128 v[16:19], v3 offset:2048
  v_mfma_f32_16x16x32_bf16 v[92:95], v[220:223], v[20:23], v[92:95]
  v_mov_b32 v102, v100
  v_mov_b32 v103, v101
  s_waitcnt lgkmcnt(2)
  v_mfma_f32_16x16x32_bf16 v[80:83], v[152:155], v[24:27], v[80:83]
  v_permlane32_swap_b32 v100, v102
  ds_read_b128 v[20:23], v3 offset:8192
  v_mfma_f32_16x16x32_bf16 v[84:87], v[224:227], v[24:27], v[84:87]
  v_permlane32_swap_b32 v101, v103
  s_waitcnt lgkmcnt(2)
  v_mfma_f32_16x16x32_bf16 v[88:91], v[152:155], v[28:31], v[88:91]
  s_add_u32 m0, s35, 100352
  s_add_u32 s49, s32, 111616
  buffer_load_dwordx4 v1, s[8:11], s49 offen lds
  ds_read_b128 v[24:27], v2 offset:24576
  v_mfma_f32_16x16x32_bf16 v[92:95], v[224:227], v[28:31], v[92:95]
  v_fma_f32 v102, v98, v100, v102
  v_fma_f32 v103, v98, v101, v103
  s_waitcnt lgkmcnt(2)
  v_mfma_f32_16x16x32_bf16 v[80:83], v[156:159], v[16:19], v[80:83]
  v_fma_f32 v102, -v99, v101, v102
  v_fma_f32 v103, v99, v100, v103
  ds_write_b64 v6, v[102:103] offset:2176
  ds_read_b128 v[28:31], v2 offset:30720
  v_mfma_f32_16x16x32_bf16 v[84:87], v[228:231], v[16:19], v[84:87]
  v_cndmask_b32 v104, 0, v100, s[40:41]
  v_cndmask_b32 v105, 0, v101, s[40:41]
  s_waitcnt lgkmcnt(3)
  v_mfma_f32_16x16x32_bf16 v[88:91], v[156:159], v[20:23], v[88:91]
  v_fma_f32 v110, v96, v104, v110
  v_fma_f32 v111, v96, v105, v111
  ds_read_b128 v[16:19], v3 offset:24576
  v_mfma_f32_16x16x32_bf16 v[92:95], v[228:231], v[20:23], v[92:95]
  v_fma_f32 v110, -v97, v105, v110
  v_fma_f32 v111, v97, v104, v111
  v_cndmask_b32 v70, v104, v110, s[36:37]
  v_cndmask_b32 v71, v105, v111, s[36:37]
  s_waitcnt lgkmcnt(2)
  s_waitcnt vmcnt(6)
  s_barrier
  v_mfma_f32_16x16x32_bf16 v[80:83], v[160:163], v[24:27], v[80:83]
  ds_read_b64 v[96:97], v6 offset:1792
  ds_read_b64 v[98:99], v6 offset:1920
  ds_read_b64 v[100:101], v6 offset:2048
  ds_read_b64 v[108:109], v6 offset:2176
  ds_read_b128 v[20:23], v3 offset:30720
  v_mfma_f32_16x16x32_bf16 v[84:87], v[232:235], v[24:27], v[84:87]
  ds_read_b64 v[104:105], v4 offset:12928
  ds_read_b64 v[106:107], v5 offset:8320
  v_mov_b32 v110, s34
  s_waitcnt lgkmcnt(8)
  v_mfma_f32_16x16x32_bf16 v[88:91], v[160:163], v[28:31], v[88:91]
  s_add_u32 m0, s35, 0
  s_add_u32 s49, s20, 0
  s_cmp_ge_u32 s49, 6
  s_cselect_b32 s4, 6, 0
  s_sub_u32 s49, s49, s4
  s_lshr_b32 s4, s49, 1
  s_lshl_b32 s4, s4, 2
  s_add_u32 s4, s4, s49
  s_mul_i32 s4, s4, 36864
  s_add_u32 s4, s4, s33
  s_add_u32 s49, s4, 0
  s_mov_b64 exec, s[74:75]
  buffer_load_dwordx4 v1, s[12:15], s49 offen lds
  s_mov_b64 exec, -1
  ds_read_b128 v[24:27], v2 offset:25600
  v_mfma_f32_16x16x32_bf16 v[92:95], v[232:235], v[28:31], v[92:95]
  v_mov_b32 v111, s38
  s_waitcnt lgkmcnt(8)
  v_mfma_f32_16x16x32_bf16 v[80:83], v[164:167], v[16:19], v[80:83]
  ds_read_b128 v[28:31], v2 offset:31744
  v_mfma_f32_16x16x32_bf16 v[84:87], v[236:239], v[16:19], v[84:87]
  s_waitcnt lgkmcnt(4)
  v_mfma_f32_16x16x32_bf16 v[88:91], v[164:167], v[20:23], v[88:91]
  s_waitcnt lgkmcnt(2)
  v_fma_f32 v98, v104, v96, v98
  v_fma_f32 v99, v104, v97, v99
  ds_read_b128 v[16:19], v3 offset:25600
  v_mfma_f32_16x16x32_bf16 v[92:95], v[236:239], v[20:23], v[92:95]
  v_fma_f32 v98, -v105, v97, v98
  v_fma_f32 v99, v105, v96, v99
  s_waitcnt lgkmcnt(2)
  v_mfma_f32_16x16x32_bf16 v[80:83], v[168:171], v[24:27], v[80:83]
  v_fma_f32 v100, v104, v98, v100
  v_fma_f32 v101, v104, v99, v101
  ds_read_b128 v[20:23], v3 offset:31744
  v_mfma_f32_16x16x32_bf16 v[84:87], v[240:243], v[24:27], v[84:87]
  v_fma_f32 v100, -v105, v99, v100
  v_fma_f32 v101, v105, v98, v101
  s_waitcnt lgkmcnt(2)
  v_mfma_f32_16x16x32_bf16 v[88:91], v[168:171], v[28:31], v[88:91]
  s_add_u32 m0, s35, 1024
  s_add_u32 s49, s4, 128
  buffer_load_dwordx4 v1, s[12:15], s49 offen lds
  ds_read_b128 v[24:27], v2 offset:26624
  v_mfma_f32_16x16x32_bf16 v[92:95], v[240:243], v[28:31], v[92:95]
  v_fma_f32 v108, v104, v100, v108
  v_fma_f32 v109, v104, v101, v109
  s_waitcnt lgkmcnt(2)
  v_mfma_f32_16x16x32_bf16 v[80:83], v[172:175], v[16:19], v[80:83]
  v_fma_f32 v108, -v105, v101, v108
  v_fma_f32 v109, v105, v100, v109
  ds_read_b128 v[28:31], v2 offset:32768
  v_mfma_f32_16x16x32_bf16 v[84:87], v[244:247], v[16:19], v[84:87]
  s_add_u32 s48, s55, 8192
  s_mov_b32 exec_lo, 0xffff
  s_mov_b32 exec_hi, 0x0
  buffer_store_dwordx4 v[108:111], v0, s[16:19], s48 offen sc1
  s_mov_b64 exec, -1
  s_waitcnt lgkmcnt(2)
  v_mfma_f32_16x16x32_bf16 v[88:91], v[172:175], v[20:23], v[88:91]
  v_fma_f32 v70, v106, v100, v70
  v_fma_f32 v71, v106, v101, v71
  ds_read_b128 v[16:19], v3 offset:26624
  v_mfma_f32_16x16x32_bf16 v[92:95], v[244:247], v[20:23], v[92:95]
  v_fma_f32 v70, -v107, v101, v70
  v_fma_f32 v71, v107, v100, v71
  s_waitcnt lgkmcnt(2)
  v_mfma_f32_16x16x32_bf16 v[80:83], v[176:179], v[24:27], v[80:83]
  ds_read_b128 v[20:23], v3 offset:32768
  v_mfma_f32_16x16x32_bf16 v[84:87], v[248:251], v[24:27], v[84:87]
  s_waitcnt lgkmcnt(2)
  v_mfma_f32_16x16x32_bf16 v[88:91], v[176:179], v[28:31], v[88:91]
  s_add_u32 m0, s35, 2048
  s_add_u32 s49, s4, 256
  s_mov_b64 exec, s[76:77]
  buffer_load_dwordx4 v1, s[12:15], s49 offen lds
  s_mov_b64 exec, -1
  v_add_u32 v2, 49152, v2
  v_add_u32 v3, 49152, v3
  ds_read_b128 v[24:27], v2 offset:0
  v_mfma_f32_16x16x32_bf16 v[92:95], v[248:251], v[28:31], v[92:95]
  s_waitcnt lgkmcnt(2)
  v_mfma_f32_16x16x32_bf16 v[80:83], v[180:183], v[16:19], v[80:83]
  ds_read_b128 v[28:31], v2 offset:6144
  v_mfma_f32_16x16x32_bf16 v[84:87], v[252:255], v[16:19], v[84:87]
  s_waitcnt lgkmcnt(2)
  v_mfma_f32_16x16x32_bf16 v[88:91], v[180:183], v[20:23], v[88:91]
  ds_read_b128 v[16:19], v3 offset:0
  v_mfma_f32_16x16x32_bf16 v[92:95], v[252:255], v[20:23], v[92:95]
  s_waitcnt vmcnt(6)
  s_barrier
  s_waitcnt lgkmcnt(2)
  v_mfma_f32_16x16x32_bf16 v[96:99], v[112:115], v[24:27], 0
  ds_read_b128 v[20:23], v3 offset:6144
  v_mfma_f32_16x16x32_bf16 v[100:103], v[184:187], v[24:27], 0
  s_waitcnt lgkmcnt(2)
  v_mfma_f32_16x16x32_bf16 v[104:107], v[112:115], v[28:31], 0
  s_add_u32 m0, s35, 24576
  s_add_u32 s49, s4, 73728
  s_mov_b64 exec, s[74:75]
  buffer_load_dwordx4 v1, s[12:15], s49 offen lds
  s_mov_b64 exec, -1
  ds_read_b128 v[24:27], v2 offset:1024
  v_mfma_f32_16x16x32_bf16 v[108:111], v[184:187], v[28:31], 0
  s_waitcnt lgkmcnt(2)
  v_mfma_f32_16x16x32_bf16 v[96:99], v[116:119], v[16:19], v[96:99]
  ds_read_b128 v[28:31], v2 offset:7168
  v_mfma_f32_16x16x32_bf16 v[100:103], v[188:191], v[16:19], v[100:103]
  s_waitcnt lgkmcnt(2)
  v_mfma_f32_16x16x32_bf16 v[104:107], v[116:119], v[20:23], v[104:107]
  ds_read_b128 v[16:19], v3 offset:1024
  v_mfma_f32_16x16x32_bf16 v[108:111], v[188:191], v[20:23], v[108:111]
  s_waitcnt lgkmcnt(2)
  v_mfma_f32_16x16x32_bf16 v[96:99], v[120:123], v[24:27], v[96:99]
  ds_read_b128 v[20:23], v3 offset:7168
  v_mfma_f32_16x16x32_bf16 v[100:103], v[192:195], v[24:27], v[100:103]
  s_waitcnt lgkmcnt(2)
  v_mfma_f32_16x16x32_bf16 v[104:107], v[120:123], v[28:31], v[104:107]
  s_add_u32 m0, s35, 25600
  s_add_u32 s49, s4, 73856
  buffer_load_dwordx4 v1, s[12:15], s49 offen lds
  ds_read_b128 v[24:27], v2 offset:2048
  v_mfma_f32_16x16x32_bf16 v[108:111], v[192:195], v[28:31], v[108:111]
  s_waitcnt lgkmcnt(2)
  v_mfma_f32_16x16x32_bf16 v[96:99], v[124:127], v[16:19], v[96:99]
  ds_read_b128 v[28:31], v2 offset:8192
  v_mfma_f32_16x16x32_bf16 v[100:103], v[196:199], v[16:19], v[100:103]
  s_waitcnt lgkmcnt(2)
  v_mfma_f32_16x16x32_bf16 v[104:107], v[124:127], v[20:23], v[104:107]
  ds_read_b128 v[16:19], v3 offset:2048
  v_mfma_f32_16x16x32_bf16 v[108:111], v[196:199], v[20:23], v[108:111]
  s_waitcnt lgkmcnt(2)
  v_mfma_f32_16x16x32_bf16 v[96:99], v[128:131], v[24:27], v[96:99]
  ds_read_b128 v[112:115], v7
  ds_read_b128 v[116:119], v7 offset:16
  ds_read_b64 v[122:123], v4 offset:5120
  ds_read_b128 v[20:23], v3 offset:8192
  v_mfma_f32_16x16x32_bf16 v[100:103], v[200:203], v[24:27], v[100:103]
  s_waitcnt lgkmcnt(5)
  v_mfma_f32_16x16x32_bf16 v[104:107], v[128:131], v[28:31], v[104:107]
  s_add_u32 m0, s35, 26624
  s_add_u32 s49, s4, 73984
  s_mov_b64 exec, s[76:77]
  buffer_load_dwordx4 v1, s[12:15], s49 offen lds
  s_mov_b64 exec, -1
  ds_read_b128 v[24:27], v2 offset:24576
  v_mfma_f32_16x16x32_bf16 v[108:111], v[200:203], v[28:31], v[108:111]
  s_waitcnt lgkmcnt(5)
  v_mfma_f32_16x16x32_bf16 v[96:99], v[132:135], v[16:19], v[96:99]
  ds_read_b128 v[28:31], v2 offset:30720
  v_mfma_f32_16x16x32_bf16 v[100:103], v[204:207], v[16:19], v[100:103]
  s_waitcnt lgkmcnt(3)
  v_mul_f32 v78, v80, v112
  v_mul_f32 v79, v88, v112
  s_waitcnt lgkmcnt(2)
  v_mfma_f32_16x16x32_bf16 v[104:107], v[132:135], v[20:23], v[104:107]
  v_mul_f32 v184, v81, v113
  v_mul_f32 v185, v89, v113
  ds_read_b128 v[16:19], v3 offset:24576
  v_mfma_f32_16x16x32_bf16 v[108:111], v[204:207], v[20:23], v[108:111]
  v_mul_f32 v80, v82, v114
  v_mul_f32 v81, v90, v114
  s_waitcnt vmcnt(6)
  s_barrier
  s_waitcnt lgkmcnt(2)
  v_mfma_f32_16x16x32_bf16 v[96:99], v[136:139], v[24:27], v[96:99]
  v_mul_f32 v88, v83, v115
  v_mul_f32 v89, v91, v115
  ds_read_b128 v[20:23], v3 offset:30720
  v_mfma_f32_16x16x32_bf16 v[100:103], v[208:211], v[24:27], v[100:103]
  v_mul_f32 v82, v84, v116
  v_mul_f32 v83, v92, v116
  s_waitcnt lgkmcnt(2)
  v_mfma_f32_16x16x32_bf16 v[104:107], v[136:139], v[28:31], v[104:107]
  s_add_u32 m0, s35, 49152
  s_add_u32 s49, s4, 147456
  s_mov_b64 exec, s[74:75]
  buffer_load_dwordx4 v1, s[12:15], s49 offen lds
  s_mov_b64 exec, -1
  ds_read_b128 v[24:27], v2 offset:25600
  v_mfma_f32_16x16x32_bf16 v[108:111], v[208:211], v[28:31], v[108:111]
  v_mul_f32 v90, v85, v117
  v_mul_f32 v91, v93, v117
  s_waitcnt lgkmcnt(2)
  v_mfma_f32_16x16x32_bf16 v[96:99], v[140:143], v[16:19], v[96:99]
  v_mul_f32 v84, v86, v118
  v_mul_f32 v85, v94, v118
  ds_read_b128 v[28:31], v2 offset:31744
  v_mfma_f32_16x16x32_bf16 v[100:103], v[212:215], v[16:19], v[100:103]
  v_mul_f32 v92, v87, v119
  v_mul_f32 v93, v95, v119
  s_waitcnt lgkmcnt(2)
  v_mfma_f32_16x16x32_bf16 v[104:107], v[140:143], v[20:23], v[104:107]
  ds_read_b64 v[112:113], v4 offset:9728
  ds_read_b64 v[114:115], v4 offset:10880
  v_fma_f32 v126, v122, v78, v184
  ds_read_b128 v[16:19], v3 offset:25600
  v_mfma_f32_16x16x32_bf16 v[108:111], v[212:215], v[20:23], v[108:111]
  v_fma_f32 v127, v122, v79, v185
  v_fma_f32 v126, -v123, v79, v126
  s_waitcnt lgkmcnt(4)
  v_mfma_f32_16x16x32_bf16 v[96:99], v[144:147], v[24:27], v[96:99]
  v_fma_f32 v127, v123, v78, v127
  v_fma_f32 v124, v122, v126, v80
  ds_read_b128 v[20:23], v3 offset:31744
  v_mfma_f32_16x16x32_bf16 v[100:103], v[216:219], v[24:27], v[100:103]
  v_fma_f32 v125, v122, v127, v81
  v_fma_f32 v124, -v123, v127, v124
  s_waitcnt lgkmcnt(4)
  v_mfma_f32_16x16x32_bf16 v[104:107], v[144:147], v[28:31], v[104:107]
  s_add_u32 m0, s35, 50176
  s_add_u32 s49, s4, 147584
  buffer_load_dwordx4 v1, s[12:15], s49 offen lds
  ds_read_b128 v[24:27], v2 offset:26624
  v_mfma_f32_16x16x32_bf16 v[108:111], v[216:219], v[28:31], v[108:111]
  v_fma_f32 v125, v123, v126, v125
  v_fma_f32 v126, v122, v124, v88
  s_waitcnt lgkmcnt(2)
  v_mfma_f32_16x16x32_bf16 v[96:99], v[148:151], v[16:19], v[96:99]
  v_fma_f32 v127, v122, v125, v89
  v_fma_f32 v126, -v123, v125, v126
  ds_read_b128 v[28:31], v2 offset:32768
  v_mfma_f32_16x16x32_bf16 v[100:103], v[220:223], v[16:19], v[100:103]
  v_fma_f32 v127, v123, v124, v127
  v_fma_f32 v124, v122, v126, v82
  s_waitcnt lgkmcnt(2)
  v_mfma_f32_16x16x32_bf16 v[104:107], v[148:151], v[20:23], v[104:107]
  v_fma_f32 v125, v122, v127, v83
  v_fma_f32 v124, -v123, v127, v124
  ds_read_b128 v[16:19], v3 offset:26624
  v_mfma_f32_16x16x32_bf16 v[108:111], v[220:223], v[20:23], v[108:111]
  v_fma_f32 v125, v123, v126, v125
  v_fma_f32 v126, v122, v124, v90
  s_waitcnt lgkmcnt(2)
  v_mfma_f32_16x16x32_bf16 v[96:99], v[152:155], v[24:27], v[96:99]
  v_fma_f32 v127, v122, v125, v91
  v_fma_f32 v126, -v123, v125, v126
  ds_read_b128 v[20:23], v3 offset:32768
  v_mfma_f32_16x16x32_bf16 v[100:103], v[224:227], v[24:27], v[100:103]
  v_fma_f32 v127, v123, v124, v127
  v_fma_f32 v124, v122, v126, v84
  s_waitcnt lgkmcnt(2)
  v_mfma_f32_16x16x32_bf16 v[104:107], v[152:155], v[28:31], v[104:107]
  s_add_u32 m0, s35, 51200
  s_add_u32 s49, s4, 147712
  s_mov_b64 exec, s[76:77]
  buffer_load_dwordx4 v1, s[12:15], s49 offen lds
  s_mov_b64 exec, -1
  v_add_u32 v2, 49152, v2
  v_add_u32 v3, 49152, v3
  ds_read_b128 v[24:27], v2 offset:0
  v_mfma_f32_16x16x32_bf16 v[108:111], v[224:227], v[28:31], v[108:111]
  v_fma_f32 v125, v122, v127, v85
  v_fma_f32 v124, -v123, v127, v124
  s_waitcnt lgkmcnt(2)
  v_mfma_f32_16x16x32_bf16 v[96:99], v[156:159], v[16:19], v[96:99]
  v_fma_f32 v125, v123, v126, v125
  v_fma_f32 v126, v122, v124, v92
  ds_read_b128 v[28:31], v2 offset:6144
  v_mfma_f32_16x16x32_bf16 v[100:103], v[228:231], v[16:19], v[100:103]
  v_fma_f32 v127, v122, v125, v93
  v_fma_f32 v126, -v123, v125, v126
  s_waitcnt lgkmcnt(2)
  v_mfma_f32_16x16x32_bf16 v[104:107], v[156:159], v[20:23], v[104:107]
  v_fma_f32 v127, v123, v124, v127
  v_mov_b32 v124, v126
  ds_read_b128 v[16:19], v3 offset:0
  v_mfma_f32_16x16x32_bf16 v[108:111], v[228:231], v[20:23], v[108:111]
  v_mov_b32 v125, v127
  v_permlane16_swap_b32 v126, v124
  s_nop 0
  v_permlane16_swap_b32 v127, v125
  v_fma_f32 v116, v112, v126, v124
  v_fma_f32 v117, v112, v127, v125
  v_fma_f32 v116, -v113, v127, v116
  v_fma_f32 v117, v113, v126, v117
  v_mov_b32 v118, v116
  v_mov_b32 v119, v117
  s_nop 0
  v_permlane32_swap_b32 v116, v118
  v_permlane32_swap_b32 v117, v119
  v_fma_f32 v118, v114, v116, v118
  v_fma_f32 v119, v114, v117, v119
  v_fma_f32 v118, -v115, v117, v118
  v_fma_f32 v119, v115, v116, v119
  ds_write_b64 v6, v[118:119] offset:3968
  v_cndmask_b32 v120, 0, v116, s[40:41]
  v_cndmask_b32 v121, 0, v117, s[40:41]
  v_fma_f32 v126, v112, v120, v126
  v_fma_f32 v127, v112, v121, v127
  v_fma_f32 v126, -v113, v121, v126
  v_fma_f32 v127, v113, v120, v127
  v_cndmask_b32 v86, v120, v126, s[36:37]
  v_cndmask_b32 v87, v121, v127, s[36:37]
  s_waitcnt lgkmcnt(0)
  s_waitcnt vmcnt(6)
  s_barrier
  v_mfma_f32_16x16x32_bf16 v[96:99], v[160:163], v[24:27], v[96:99]
  ds_read_b64 v[112:113], v6 offset:3584
  ds_read_b64 v[114:115], v6 offset:3712
  ds_read_b64 v[116:117], v6 offset:3840
  ds_read_b64 v[124:125], v6 offset:3968
  ds_read_b128 v[20:23], v3 offset:6144
  v_mfma_f32_16x16x32_bf16 v[100:103], v[232:235], v[24:27], v[100:103]
  ds_read_b64 v[120:121], v4 offset:13184
  ds_read_b64 v[122:123], v5 offset:8576
  v_mov_b32 v126, s34
  v_mfma_f32_16x16x32_bf16 v[104:107], v[160:163], v[28:31], v[104:107]
  v_mov_b32 v127, s38
  ds_read_b128 v[24:27], v2 offset:1024
  v_mfma_f32_16x16x32_bf16 v[108:111], v[232:235], v[28:31], v[108:111]
  v_mfma_f32_16x16x32_bf16 v[96:99], v[164:167], v[16:19], v[96:99]
  ds_read_b128 v[28:31], v2 offset:7168
  v_mfma_f32_16x16x32_bf16 v[100:103], v[236:239], v[16:19], v[100:103]
  s_waitcnt lgkmcnt(2)
  v_fma_f32 v114, v120, v112, v114
  v_fma_f32 v115, v120, v113, v115
  v_mfma_f32_16x16x32_bf16 v[104:107], v[164:167], v[20:23], v[104:107]
  v_fma_f32 v114, -v121, v113, v114
  v_fma_f32 v115, v121, v112, v115
  ds_read_b128 v[16:19], v3 offset:1024
  v_mfma_f32_16x16x32_bf16 v[108:111], v[236:239], v[20:23], v[108:111]
  v_fma_f32 v116, v120, v114, v116
  v_fma_f32 v117, v120, v115, v117
  s_waitcnt lgkmcnt(2)
  v_mfma_f32_16x16x32_bf16 v[96:99], v[168:171], v[24:27], v[96:99]
  v_fma_f32 v116, -v121, v115, v116
  v_fma_f32 v117, v121, v114, v117
  ds_read_b128 v[20:23], v3 offset:7168
  v_mfma_f32_16x16x32_bf16 v[100:103], v[240:243], v[24:27], v[100:103]
  v_fma_f32 v124, v120, v116, v124
  v_fma_f32 v125, v120, v117, v125
  s_waitcnt lgkmcnt(2)
  v_mfma_f32_16x16x32_bf16 v[104:107], v[168:171], v[28:31], v[104:107]
  v_fma_f32 v124, -v121, v117, v124
  v_fma_f32 v125, v121, v116, v125
  ds_read_b128 v[24:27], v2 offset:2048
  v_mfma_f32_16x16x32_bf16 v[108:111], v[240:243], v[28:31], v[108:111]
  s_add_u32 s48, s55, 16384
  s_mov_b32 exec_lo, 0xffff
  s_mov_b32 exec_hi, 0x0
  buffer_store_dwordx4 v[124:127], v0, s[16:19], s48 offen sc1
  s_mov_b64 exec, -1
  s_waitcnt lgkmcnt(2)
  v_mfma_f32_16x16x32_bf16 v[96:99], v[172:175], v[16:19], v[96:99]
  v_fma_f32 v86, v122, v116, v86
  v_fma_f32 v87, v122, v117, v87
  ds_read_b128 v[28:31], v2 offset:8192
  v_mfma_f32_16x16x32_bf16 v[100:103], v[244:247], v[16:19], v[100:103]
  v_fma_f32 v86, -v123, v117, v86
  v_fma_f32 v87, v123, v116, v87
  s_waitcnt lgkmcnt(2)
  v_mfma_f32_16x16x32_bf16 v[104:107], v[172:175], v[20:23], v[104:107]
  v_add_u32 v142, 161152, v0
  v_lshrrev_b32 v143, 1, v0
  ds_read_b128 v[16:19], v3 offset:2048
  v_mfma_f32_16x16x32_bf16 v[108:111], v[244:247], v[20:23], v[108:111]
  ds_read_b128 v[128:131], v142
  v_add_u32 v143, 162176, v143
  ds_read_b64 v[140:141], v143
  s_waitcnt lgkmcnt(4)
  v_mfma_f32_16x16x32_bf16 v[96:99], v[176:179], v[24:27], v[96:99]
  v_add_u32 v200, s3, v5
  v_lshrrev_b32 v147, 6, v0
  ds_read_b128 v[20:23], v3 offset:8192
  v_mfma_f32_16x16x32_bf16 v[100:103], v[248:251], v[24:27], v[100:103]
  v_and_b32 v147, 12, v147
  v_sub_u32 v147, s27, v147
  s_waitcnt lgkmcnt(4)
  v_mfma_f32_16x16x32_bf16 v[104:107], v[176:179], v[28:31], v[104:107]
  v_mov_b32 v149, 0x7ff00000
  v_and_b32 v150, 0xf0, v0
  v_mfma_f32_16x16x32_bf16 v[108:111], v[248:251], v[28:31], v[108:111]
  v_mov_b32 v151, s34
  v_mov_b32 v152, s38
  s_waitcnt lgkmcnt(3)
  v_mfma_f32_16x16x32_bf16 v[96:99], v[180:183], v[16:19], v[96:99]
  v_subrev_u32 v148, 1, v147
  v_cmp_le_i32 vcc, 0, v148
  v_mfma_f32_16x16x32_bf16 v[100:103], v[252:255], v[16:19], v[100:103]
  v_lshl_add_u32 v148, v148, 8, v150
  v_cndmask_b32 v188, v149, v148, vcc
  s_waitcnt lgkmcnt(0)
  v_mfma_f32_16x16x32_bf16 v[104:107], v[180:183], v[20:23], v[104:107]
  v_cndmask_b32 v192, 0, v151, vcc
  v_cndmask_b32 v193, 0, v152, vcc
  v_mfma_f32_16x16x32_bf16 v[108:111], v[252:255], v[20:23], v[108:111]
  v_subrev_u32 v148, 2, v147
  v_cmp_le_i32 vcc, 0, v148
  v_lshl_add_u32 v148, v148, 8, v150
  s_nop 0
  v_cndmask_b32 v189, v149, v148, vcc
  v_cndmask_b32 v194, 0, v151, vcc
  v_cndmask_b32 v195, 0, v152, vcc
  v_subrev_u32 v148, 3, v147
  v_cmp_le_i32 vcc, 0, v148
  v_lshl_add_u32 v148, v148, 8, v150
  s_nop 0
  v_cndmask_b32 v190, v149, v148, vcc
  v_cndmask_b32 v196, 0, v151, vcc
  v_cndmask_b32 v197, 0, v152, vcc
  v_subrev_u32 v148, 4, v147
  v_cmp_le_i32 vcc, 0, v148
  v_lshl_add_u32 v148, v148, 8, v150
  s_nop 0
  v_cndmask_b32 v191, v149, v148, vcc
  v_cndmask_b32 v198, 0, v151, vcc
  v_cndmask_b32 v199, 0, v152, vcc
  s_add_u32 s46, s25, -1
  s_max_i32 s46, s46, 0
  s_cmp_eq_u32 s24, 0
  s_cselect_b32 s46, 4, s46
  s_lshl_b32 s42, s46, 13
  s_add_u32 s42, s42, s39
  s_add_u32 s43, s39, 24576
  s_lshl_b32 s46, s46, 8
  v_add_u32 v204, s46, v4
  v_add_u32 v205, s46, v5
  ds_read_b128 v[112:115], v7
  ds_read_b128 v[116:119], v7 offset:16
  ds_read_b64 v[122:123], v4 offset:5376
  ds_read_b64 v[160:161], v204 offset:26496
  ds_read_b64 v[162:163], v205 offset:0
  ds_read_b64 v[164:165], v4 offset:27264
  ds_read_b64 v[166:167], v5 offset:768
  ds_read_b64 v[168:169], v4 offset:13440
  ds_read_b64 v[170:171], v5 offset:8832
  v_add_u32 v202, s23, v141
  v_add_u32 v140, s22, v140
  v_xor_b32 v203, 8, v202
  v_xor_b32 v141, 32, v140
  v_xor_b32 v142, 8, v140
  v_xor_b32 v143, 40, v140
  v_add_u32 v128, s53, v128
  v_add_u32 v129, s53, v129
  v_add_u32 v130, s53, v130
  v_add_u32 v131, s53, v131
  v_add_u32 v132, 49152, v128
  v_add_u32 v133, 49152, v129
  v_add_u32 v134, 49152, v130
  v_add_u32 v135, 49152, v131
  v_add_u32 v136, 98304, v128
  v_add_u32 v137, 98304, v129
  v_add_u32 v138, 98304, v130
  v_add_u32 v139, 98304, v131
  s_waitcnt lgkmcnt(6)
  v_mul_f32 v94, v96, v112
  v_mul_f32 v95, v104, v112
  v_mul_f32 v186, v97, v113
  v_mul_f32 v187, v105, v113
  v_mul_f32 v96, v98, v114
  v_mul_f32 v97, v106, v114
  v_mul_f32 v104, v99, v115
  v_mul_f32 v105, v107, v115
  v_mul_f32 v98, v100, v116
  v_mul_f32 v99, v108, v116
  v_mul_f32 v106, v101, v117
  v_mul_f32 v107, v109, v117
  v_mul_f32 v100, v102, v118
  v_mul_f32 v101, v110, v118
  v_mul_f32 v108, v103, v119
  v_mul_f32 v109, v111, v119
  ds_read_b64 v[112:113], v4 offset:9984
  ds_read_b64 v[114:115], v4 offset:11136
  v_fma_f32 v126, v122, v94, v186
  v_fma_f32 v127, v122, v95, v187
  v_fma_f32 v126, -v123, v95, v126
  v_fma_f32 v127, v123, v94, v127
  v_fma_f32 v124, v122, v126, v96
  v_fma_f32 v125, v122, v127, v97
  v_fma_f32 v124, -v123, v127, v124
  v_fma_f32 v125, v123, v126, v125
  v_fma_f32 v126, v122, v124, v104
  v_fma_f32 v127, v122, v125, v105
  v_fma_f32 v126, -v123, v125, v126
  v_fma_f32 v127, v123, v124, v127
  v_fma_f32 v124, v122, v126, v98
  v_fma_f32 v125, v122, v127, v99
  v_fma_f32 v124, -v123, v127, v124
  v_fma_f32 v125, v123, v126, v125
  v_fma_f32 v126, v122, v124, v106
  v_fma_f32 v127, v122, v125, v107
  v_fma_f32 v126, -v123, v125, v126
  v_fma_f32 v127, v123, v124, v127
  v_fma_f32 v124, v122, v126, v100
  v_fma_f32 v125, v122, v127, v101
  v_fma_f32 v124, -v123, v127, v124
  v_fma_f32 v125, v123, v126, v125
  v_fma_f32 v126, v122, v124, v108
  v_fma_f32 v127, v122, v125, v109
  v_fma_f32 v126, -v123, v125, v126
  v_fma_f32 v127, v123, v124, v127
  v_mov_b32 v124, v126
  v_mov_b32 v125, v127
  s_waitcnt lgkmcnt(0)
  v_permlane16_swap_b32 v126, v124
  v_permlane16_swap_b32 v127, v125
  v_fma_f32 v116, v112, v126, v124
  v_fma_f32 v117, v112, v127, v125
  v_fma_f32 v116, -v113, v127, v116
  v_fma_f32 v117, v113, v126, v117
  v_mov_b32 v118, v116
  v_mov_b32 v119, v117
  s_nop 0
  v_permlane32_swap_b32 v116, v118
  v_permlane32_swap_b32 v117, v119
  v_fma_f32 v118, v114, v116, v118
  v_fma_f32 v119, v114, v117, v119
  v_fma_f32 v118, -v115, v117, v118
  v_fma_f32 v119, v115, v116, v119
  ds_write_b64 v6, v[118:119] offset:5760
  buffer_load_dwordx4 v[144:147], v188, s[16:19], s42 offen sc1
  buffer_load_dwordx4 v[148:151], v189, s[16:19], s42 offen sc1
  buffer_load_dwordx4 v[152:155], v190, s[16:19], s42 offen sc1
  buffer_load_dwordx4 v[156:159], v191, s[16:19], s42 offen sc1
  s_waitcnt lgkmcnt(0)
  s_barrier
  ds_read_b64 v[16:17], v6 offset:5376
  ds_read_b64 v[18:19], v6 offset:5504
  ds_read_b64 v[20:21], v6 offset:5632
  ds_read_b64 v[28:29], v6 offset:5760
  ds_read_b64 v[208:209], v200 offset:9088
  ds_read_b64 v[210:211], v4 offset:5632
  ds_read_b64 v[212:213], v4 offset:6784
  ds_read_b64 v[216:217], v200 offset:8064
  ds_read_b64 v[218:219], v4 offset:4608
  ds_read_b64 v[220:221], v4 offset:5760
  ds_read_b64 v[224:225], v200 offset:8320
  ds_read_b64 v[226:227], v4 offset:4864
  ds_read_b64 v[228:229], v4 offset:6016
  ds_read_b64 v[232:233], v200 offset:8576
  ds_read_b64 v[234:235], v4 offset:5120
  ds_read_b64 v[236:237], v4 offset:6272
  ds_read_b64 v[240:241], v200 offset:8832
  ds_read_b64 v[242:243], v4 offset:5376
  ds_read_b64 v[244:245], v4 offset:6528
  v_cndmask_b32 v120, 0, v116, s[40:41]
  v_cndmask_b32 v121, 0, v117, s[40:41]
  v_fma_f32 v126, v112, v120, v126
  v_fma_f32 v127, v112, v121, v127
  v_fma_f32 v126, -v113, v121, v126
  v_fma_f32 v127, v113, v120, v127
  v_cndmask_b32 v102, v120, v126, s[36:37]
  v_cndmask_b32 v103, v121, v127, s[36:37]
  v_mov_b32 v30, s34
  v_mov_b32 v31, s38
  s_waitcnt lgkmcnt(15)
  v_pk_fma_f32 v[18:19], v[168:169], v[16:17], v[18:19] op_sel:[0,0,0] op_sel_hi:[0,1,1]
  v_pk_fma_f32 v[18:19], v[168:169], v[16:17], v[18:19] op_sel:[1,1,0] op_sel_hi:[1,0,1] neg_lo:[1,0,0]
  v_pk_fma_f32 v[20:21], v[168:169], v[18:19], v[20:21] op_sel:[0,0,0] op_sel_hi:[0,1,1]
  v_pk_fma_f32 v[20:21], v[168:169], v[18:19], v[20:21] op_sel:[1,1,0] op_sel_hi:[1,0,1] neg_lo:[1,0,0]
  v_pk_fma_f32 v[28:29], v[168:169], v[20:21], v[28:29] op_sel:[0,0,0] op_sel_hi:[0,1,1]
  v_pk_fma_f32 v[28:29], v[168:169], v[20:21], v[28:29] op_sel:[1,1,0] op_sel_hi:[1,0,1] neg_lo:[1,0,0]
  s_add_u32 s48, s55, 24576
  s_mov_b32 exec_lo, 0xffff
  s_mov_b32 exec_hi, 0x0
  buffer_store_dwordx4 v[28:31], v0, s[16:19], s48 offen sc1
  s_mov_b64 exec, -1
  v_pk_fma_f32 v[102:103], v[170:171], v[20:21], v[102:103] op_sel:[0,0,0] op_sel_hi:[0,1,1]
  v_pk_fma_f32 v[102:103], v[170:171], v[20:21], v[102:103] op_sel:[1,1,0] op_sel_hi:[1,0,1] neg_lo:[1,0,0]
  s_waitcnt vmcnt(0)
  v_xor_b32 v146, v146, v192
  v_xor_b32 v147, v147, v193
  v_or3_b32 v201, v146, v147, 0
  v_xor_b32 v150, v150, v194
  v_xor_b32 v151, v151, v195
  v_or3_b32 v201, v150, v151, v201
  v_xor_b32 v154, v154, v196
  v_xor_b32 v155, v155, v197
  v_or3_b32 v201, v154, v155, v201
  v_xor_b32 v158, v158, v198
  v_xor_b32 v159, v159, v199
  v_or3_b32 v201, v158, v159, v201
  v_cmp_ne_u32 vcc, 0, v201
  s_nop 0
  s_cmp_eq_u64 vcc, 0
  s_cbranch_scc0 L_slow_r_9
L_back_r_9:
  v_pk_fma_f32 v[152:153], v[160:161], v[156:157], v[152:153] op_sel:[0,0,0] op_sel_hi:[0,1,1]
  v_pk_fma_f32 v[152:153], v[160:161], v[156:157], v[152:153] op_sel:[1,1,0] op_sel_hi:[1,0,1] neg_lo:[1,0,0]
  v_pk_fma_f32 v[148:149], v[160:161], v[152:153], v[148:149] op_sel:[0,0,0] op_sel_hi:[0,1,1]
  v_pk_fma_f32 v[148:149], v[160:161], v[152:153], v[148:149] op_sel:[1,1,0] op_sel_hi:[1,0,1] neg_lo:[1,0,0]
  v_pk_fma_f32 v[144:145], v[160:161], v[148:149], v[144:145] op_sel:[0,0,0] op_sel_hi:[0,1,1]
  v_pk_fma_f32 v[144:145], v[160:161], v[148:149], v[144:145] op_sel:[1,1,0] op_sel_hi:[1,0,1] neg_lo:[1,0,0]
  v_pk_mul_f32 v[146:147], v[162:163], v[144:145] op_sel:[0,0] op_sel_hi:[0,1]
  v_pk_fma_f32 v[146:147], v[162:163], v[144:145], v[146:147] op_sel:[1,1,0] op_sel_hi:[1,0,1] neg_lo:[1,0,0]
  v_pk_mov_b32 v[150:151], v[146:147], v[146:147] op_sel:[0,1]
  s_nop 1
  v_permlane16_swap_b32 v146, v150
  v_permlane16_swap_b32 v147, v151
  v_pk_add_f32 v[146:147], v[146:147], v[150:151]
  v_pk_mov_b32 v[150:151], v[146:147], v[146:147] op_sel:[0,1]
  s_nop 1
  v_permlane32_swap_b32 v146, v150
  v_permlane32_swap_b32 v147, v151
  v_pk_add_f32 v[146:147], v[146:147], v[150:151]
  ds_write_b64 v204, v[146:147] offset:37120
  s_waitcnt lgkmcnt(0)
  s_barrier
  ds_read_b64 v[214:215], v4 offset:38144
  ds_read_b64 v[222:223], v4 offset:37120
  ds_read_b64 v[230:231], v4 offset:37376
  ds_read_b64 v[238:239], v4 offset:37632
  s_waitcnt lgkmcnt(0)
  v_pk_fma_f32 v[54:55], v[216:217], v[222:223], v[54:55] op_sel:[0,0,0] op_sel_hi:[0,1,1]
  v_pk_fma_f32 v[54:55], v[216:217], v[222:223], v[54:55] op_sel:[1,1,0] op_sel_hi:[1,0,1] neg_lo:[1,0,0]
  v_pk_fma_f32 v[46:47], v[218:219], v[54:55], v[46:47] op_sel:[0,0,0] op_sel_hi:[0,1,1]
  v_pk_fma_f32 v[46:47], v[218:219], v[54:55], v[46:47] op_sel:[1,1,0] op_sel_hi:[1,0,1] neg_lo:[1,0,0]
  v_pk_mul_f32 v[16:17], v[220:221], v[46:47] op_sel:[0,0] op_sel_hi:[0,1]
  v_pk_fma_f32 v[16:17], v[220:221], v[46:47], v[16:17] op_sel:[1,1,0] op_sel_hi:[1,0,1] neg_lo:[1,0,0]
  v_pk_fma_f32 v[12:13], v[218:219], v[46:47], v[12:13] op_sel:[0,0,0] op_sel_hi:[0,1,1]
  v_pk_fma_f32 v[12:13], v[218:219], v[46:47], v[12:13] op_sel:[1,1,0] op_sel_hi:[1,0,1] neg_lo:[1,0,0]
  v_pk_mul_f32 v[18:19], v[220:221], v[12:13] op_sel:[0,0] op_sel_hi:[0,1]
  v_pk_fma_f32 v[18:19], v[220:221], v[12:13], v[18:19] op_sel:[1,1,0] op_sel_hi:[1,0,1] neg_lo:[1,0,0]
  v_pk_fma_f32 v[48:49], v[218:219], v[12:13], v[48:49] op_sel:[0,0,0] op_sel_hi:[0,1,1]
  v_pk_fma_f32 v[48:49], v[218:219], v[12:13], v[48:49] op_sel:[1,1,0] op_sel_hi:[1,0,1] neg_lo:[1,0,0]
  v_pk_mul_f32 v[20:21], v[220:221], v[48:49] op_sel:[0,0] op_sel_hi:[0,1]
  v_pk_fma_f32 v[20:21], v[220:221], v[48:49], v[20:21] op_sel:[1,1,0] op_sel_hi:[1,0,1] neg_lo:[1,0,0]
  v_pk_fma_f32 v[56:57], v[218:219], v[48:49], v[56:57] op_sel:[0,0,0] op_sel_hi:[0,1,1]
  v_pk_fma_f32 v[56:57], v[218:219], v[48:49], v[56:57] op_sel:[1,1,0] op_sel_hi:[1,0,1] neg_lo:[1,0,0]
  v_pk_mul_f32 v[22:23], v[220:221], v[56:57] op_sel:[0,0] op_sel_hi:[0,1]
  v_pk_fma_f32 v[22:23], v[220:221], v[56:57], v[22:23] op_sel:[1,1,0] op_sel_hi:[1,0,1] neg_lo:[1,0,0]
  v_pk_fma_f32 v[50:51], v[218:219], v[56:57], v[50:51] op_sel:[0,0,0] op_sel_hi:[0,1,1]
  v_pk_fma_f32 v[50:51], v[218:219], v[56:57], v[50:51] op_sel:[1,1,0] op_sel_hi:[1,0,1] neg_lo:[1,0,0]
  v_pk_mul_f32 v[24:25], v[220:221], v[50:51] op_sel:[0,0] op_sel_hi:[0,1]
  v_pk_fma_f32 v[24:25], v[220:221], v[50:51], v[24:25] op_sel:[1,1,0] op_sel_hi:[1,0,1] neg_lo:[1,0,0]
  v_pk_fma_f32 v[58:59], v[218:219], v[50:51], v[58:59] op_sel:[0,0,0] op_sel_hi:[0,1,1]
  v_pk_fma_f32 v[58:59], v[218:219], v[50:51], v[58:59] op_sel:[1,1,0] op_sel_hi:[1,0,1] neg_lo:[1,0,0]
  v_pk_mul_f32 v[26:27], v[220:221], v[58:59] op_sel:[0,0] op_sel_hi:[0,1]
  v_pk_fma_f32 v[26:27], v[220:221], v[58:59], v[26:27] op_sel:[1,1,0] op_sel_hi:[1,0,1] neg_lo:[1,0,0]
  v_pk_fma_f32 v[52:53], v[218:219], v[58:59], v[52:53] op_sel:[0,0,0] op_sel_hi:[0,1,1]
  v_pk_fma_f32 v[52:53], v[218:219], v[58:59], v[52:53] op_sel:[1,1,0] op_sel_hi:[1,0,1] neg_lo:[1,0,0]
  v_pk_mul_f32 v[28:29], v[220:221], v[52:53] op_sel:[0,0] op_sel_hi:[0,1]
  v_pk_fma_f32 v[28:29], v[220:221], v[52:53], v[28:29] op_sel:[1,1,0] op_sel_hi:[1,0,1] neg_lo:[1,0,0]
  v_pk_fma_f32 v[60:61], v[218:219], v[52:53], v[60:61] op_sel:[0,0,0] op_sel_hi:[0,1,1]
  v_pk_fma_f32 v[60:61], v[218:219], v[52:53], v[60:61] op_sel:[1,1,0] op_sel_hi:[1,0,1] neg_lo:[1,0,0]
  v_pk_mul_f32 v[30:31], v[220:221], v[60:61] op_sel:[0,0] op_sel_hi:[0,1]
  v_pk_fma_f32 v[30:31], v[220:221], v[60:61], v[30:31] op_sel:[1,1,0] op_sel_hi:[1,0,1] neg_lo:[1,0,0]
  v_cvt_pk_bf16_f32 v172, v16, v18
  v_cvt_pk_bf16_f32 v173, v20, v22
  v_cvt_pk_bf16_f32 v174, v24, v26
  v_cvt_pk_bf16_f32 v175, v28, v30
  v_cvt_pk_bf16_f32 v176, -v17, -v19
  v_cvt_pk_bf16_f32 v177, -v21, -v23
  v_cvt_pk_bf16_f32 v178, -v25, -v27
  v_cvt_pk_bf16_f32 v179, -v29, -v31
  ds_write_b64 v202, v[172:173] offset:0
  ds_write_b64 v203, v[174:175] offset:0
  ds_write_b64 v202, v[176:177] offset:1024
  ds_write_b64 v203, v[178:179] offset:1024
  buffer_load_dwordx4 v[144:147], v188, s[16:19], s43 offen sc1
  buffer_load_dwordx4 v[148:151], v189, s[16:19], s43 offen sc1
  buffer_load_dwordx4 v[152:155], v190, s[16:19], s43 offen sc1
  buffer_load_dwordx4 v[156:159], v191, s[16:19], s43 offen sc1
  v_pk_fma_f32 v[70:71], v[224:225], v[230:231], v[70:71] op_sel:[0,0,0] op_sel_hi:[0,1,1]
  v_pk_fma_f32 v[70:71], v[224:225], v[230:231], v[70:71] op_sel:[1,1,0] op_sel_hi:[1,0,1] neg_lo:[1,0,0]
  v_pk_fma_f32 v[62:63], v[226:227], v[70:71], v[62:63] op_sel:[0,0,0] op_sel_hi:[0,1,1]
  v_pk_fma_f32 v[62:63], v[226:227], v[70:71], v[62:63] op_sel:[1,1,0] op_sel_hi:[1,0,1] neg_lo:[1,0,0]
  v_pk_mul_f32 v[16:17], v[228:229], v[62:63] op_sel:[0,0] op_sel_hi:[0,1]
  v_pk_fma_f32 v[16:17], v[228:229], v[62:63], v[16:17] op_sel:[1,1,0] op_sel_hi:[1,0,1] neg_lo:[1,0,0]
  v_pk_fma_f32 v[14:15], v[226:227], v[62:63], v[14:15] op_sel:[0,0,0] op_sel_hi:[0,1,1]
  v_pk_fma_f32 v[14:15], v[226:227], v[62:63], v[14:15] op_sel:[1,1,0] op_sel_hi:[1,0,1] neg_lo:[1,0,0]
  v_pk_mul_f32 v[18:19], v[228:229], v[14:15] op_sel:[0,0] op_sel_hi:[0,1]
  v_pk_fma_f32 v[18:19], v[228:229], v[14:15], v[18:19] op_sel:[1,1,0] op_sel_hi:[1,0,1] neg_lo:[1,0,0]
  v_pk_fma_f32 v[64:65], v[226:227], v[14:15], v[64:65] op_sel:[0,0,0] op_sel_hi:[0,1,1]
  v_pk_fma_f32 v[64:65], v[226:227], v[14:15], v[64:65] op_sel:[1,1,0] op_sel_hi:[1,0,1] neg_lo:[1,0,0]
  v_pk_mul_f32 v[20:21], v[228:229], v[64:65] op_sel:[0,0] op_sel_hi:[0,1]
  v_pk_fma_f32 v[20:21], v[228:229], v[64:65], v[20:21] op_sel:[1,1,0] op_sel_hi:[1,0,1] neg_lo:[1,0,0]
  v_pk_fma_f32 v[72:73], v[226:227], v[64:65], v[72:73] op_sel:[0,0,0] op_sel_hi:[0,1,1]
  v_pk_fma_f32 v[72:73], v[226:227], v[64:65], v[72:73] op_sel:[1,1,0] op_sel_hi:[1,0,1] neg_lo:[1,0,0]
  v_pk_mul_f32 v[22:23], v[228:229], v[72:73] op_sel:[0,0] op_sel_hi:[0,1]
  v_pk_fma_f32 v[22:23], v[228:229], v[72:73], v[22:23] op_sel:[1,1,0] op_sel_hi:[1,0,1] neg_lo:[1,0,0]
  v_pk_fma_f32 v[66:67], v[226:227], v[72:73], v[66:67] op_sel:[0,0,0] op_sel_hi:[0,1,1]
  v_pk_fma_f32 v[66:67], v[226:227], v[72:73], v[66:67] op_sel:[1,1,0] op_sel_hi:[1,0,1] neg_lo:[1,0,0]
  v_pk_mul_f32 v[24:25], v[228:229], v[66:67] op_sel:[0,0] op_sel_hi:[0,1]
  v_pk_fma_f32 v[24:25], v[228:229], v[66:67], v[24:25] op_sel:[1,1,0] op_sel_hi:[1,0,1] neg_lo:[1,0,0]
  v_pk_fma_f32 v[74:75], v[226:227], v[66:67], v[74:75] op_sel:[0,0,0] op_sel_hi:[0,1,1]
  v_pk_fma_f32 v[74:75], v[226:227], v[66:67], v[74:75] op_sel:[1,1,0] op_sel_hi:[1,0,1] neg_lo:[1,0,0]
  v_pk_mul_f32 v[26:27], v[228:229], v[74:75] op_sel:[0,0] op_sel_hi:[0,1]
  v_pk_fma_f32 v[26:27], v[228:229], v[74:75], v[26:27] op_sel:[1,1,0] op_sel_hi:[1,0,1] neg_lo:[1,0,0]
  v_pk_fma_f32 v[68:69], v[226:227], v[74:75], v[68:69] op_sel:[0,0,0] op_sel_hi:[0,1,1]
  v_pk_fma_f32 v[68:69], v[226:227], v[74:75], v[68:69] op_sel:[1,1,0] op_sel_hi:[1,0,1] neg_lo:[1,0,0]
  v_pk_mul_f32 v[28:29], v[228:229], v[68:69] op_sel:[0,0] op_sel_hi:[0,1]
  v_pk_fma_f32 v[28:29], v[228:229], v[68:69], v[28:29] op_sel:[1,1,0] op_sel_hi:[1,0,1] neg_lo:[1,0,0]
  v_pk_fma_f32 v[76:77], v[226:227], v[68:69], v[76:77] op_sel:[0,0,0] op_sel_hi:[0,1,1]
  v_pk_fma_f32 v[76:77], v[226:227], v[68:69], v[76:77] op_sel:[1,1,0] op_sel_hi:[1,0,1] neg_lo:[1,0,0]
  v_pk_mul_f32 v[30:31], v[228:229], v[76:77] op_sel:[0,0] op_sel_hi:[0,1]
  v_pk_fma_f32 v[30:31], v[228:229], v[76:77], v[30:31] op_sel:[1,1,0] op_sel_hi:[1,0,1] neg_lo:[1,0,0]
  v_cvt_pk_bf16_f32 v248, v16, v18
  v_cvt_pk_bf16_f32 v249, v20, v22
  v_cvt_pk_bf16_f32 v250, v24, v26
  v_cvt_pk_bf16_f32 v251, v28, v30
  v_cvt_pk_bf16_f32 v252, -v17, -v19
  v_cvt_pk_bf16_f32 v253, -v21, -v23
  v_cvt_pk_bf16_f32 v254, -v25, -v27
  v_cvt_pk_bf16_f32 v255, -v29, -v31
  ds_write_b64 v202, v[248:249] offset:4096
  ds_write_b64 v203, v[250:251] offset:4096
  ds_write_b64 v202, v[252:253] offset:5120
  ds_write_b64 v203, v[254:255] offset:5120
  v_pk_fma_f32 v[86:87], v[232:233], v[238:239], v[86:87] op_sel:[0,0,0] op_sel_hi:[0,1,1]
  v_pk_fma_f32 v[86:87], v[232:233], v[238:239], v[86:87] op_sel:[1,1,0] op_sel_hi:[1,0,1] neg_lo:[1,0,0]
  v_pk_fma_f32 v[78:79], v[234:235], v[86:87], v[78:79] op_sel:[0,0,0] op_sel_hi:[0,1,1]
  v_pk_fma_f32 v[78:79], v[234:235], v[86:87], v[78:79] op_sel:[1,1,0] op_sel_hi:[1,0,1] neg_lo:[1,0,0]
  v_pk_mul_f32 v[16:17], v[236:237], v[78:79] op_sel:[0,0] op_sel_hi:[0,1]
  v_pk_fma_f32 v[16:17], v[236:237], v[78:79], v[16:17] op_sel:[1,1,0] op_sel_hi:[1,0,1] neg_lo:[1,0,0]
  v_pk_fma_f32 v[184:185], v[234:235], v[78:79], v[184:185] op_sel:[0,0,0] op_sel_hi:[0,1,1]
  v_pk_fma_f32 v[184:185], v[234:235], v[78:79], v[184:185] op_sel:[1,1,0] op_sel_hi:[1,0,1] neg_lo:[1,0,0]
  v_pk_mul_f32 v[18:19], v[236:237], v[184:185] op_sel:[0,0] op_sel_hi:[0,1]
  v_pk_fma_f32 v[18:19], v[236:237], v[184:185], v[18:19] op_sel:[1,1,0] op_sel_hi:[1,0,1] neg_lo:[1,0,0]
  v_pk_fma_f32 v[80:81], v[234:235], v[184:185], v[80:81] op_sel:[0,0,0] op_sel_hi:[0,1,1]
  v_pk_fma_f32 v[80:81], v[234:235], v[184:185], v[80:81] op_sel:[1,1,0] op_sel_hi:[1,0,1] neg_lo:[1,0,0]
  v_pk_mul_f32 v[20:21], v[236:237], v[80:81] op_sel:[0,0] op_sel_hi:[0,1]
  v_pk_fma_f32 v[20:21], v[236:237], v[80:81], v[20:21] op_sel:[1,1,0] op_sel_hi:[1,0,1] neg_lo:[1,0,0]
  v_pk_fma_f32 v[88:89], v[234:235], v[80:81], v[88:89] op_sel:[0,0,0] op_sel_hi:[0,1,1]
  v_pk_fma_f32 v[88:89], v[234:235], v[80:81], v[88:89] op_sel:[1,1,0] op_sel_hi:[1,0,1] neg_lo:[1,0,0]
  v_pk_mul_f32 v[22:23], v[236:237], v[88:89] op_sel:[0,0] op_sel_hi:[0,1]
  v_pk_fma_f32 v[22:23], v[236:237], v[88:89], v[22:23] op_sel:[1,1,0] op_sel_hi:[1,0,1] neg_lo:[1,0,0]
  v_pk_fma_f32 v[82:83], v[234:235], v[88:89], v[82:83] op_sel:[0,0,0] op_sel_hi:[0,1,1]
  v_pk_fma_f32 v[82:83], v[234:235], v[88:89], v[82:83] op_sel:[1,1,0] op_sel_hi:[1,0,1] neg_lo:[1,0,0]
  v_pk_mul_f32 v[24:25], v[236:237], v[82:83] op_sel:[0,0] op_sel_hi:[0,1]
  v_pk_fma_f32 v[24:25], v[236:237], v[82:83], v[24:25] op_sel:[1,1,0] op_sel_hi:[1,0,1] neg_lo:[1,0,0]
  v_pk_fma_f32 v[90:91], v[234:235], v[82:83], v[90:91] op_sel:[0,0,0] op_sel_hi:[0,1,1]
  v_pk_fma_f32 v[90:91], v[234:235], v[82:83], v[90:91] op_sel:[1,1,0] op_sel_hi:[1,0,1] neg_lo:[1,0,0]
  v_pk_mul_f32 v[26:27], v[236:237], v[90:91] op_sel:[0,0] op_sel_hi:[0,1]
  v_pk_fma_f32 v[26:27], v[236:237], v[90:91], v[26:27] op_sel:[1,1,0] op_sel_hi:[1,0,1] neg_lo:[1,0,0]
  v_pk_fma_f32 v[84:85], v[234:235], v[90:91], v[84:85] op_sel:[0,0,0] op_sel_hi:[0,1,1]
  v_pk_fma_f32 v[84:85], v[234:235], v[90:91], v[84:85] op_sel:[1,1,0] op_sel_hi:[1,0,1] neg_lo:[1,0,0]
  v_pk_mul_f32 v[28:29], v[236:237], v[84:85] op_sel:[0,0] op_sel_hi:[0,1]
  v_pk_fma_f32 v[28:29], v[236:237], v[84:85], v[28:29] op_sel:[1,1,0] op_sel_hi:[1,0,1] neg_lo:[1,0,0]
  v_pk_fma_f32 v[92:93], v[234:235], v[84:85], v[92:93] op_sel:[0,0,0] op_sel_hi:[0,1,1]
  v_pk_fma_f32 v[92:93], v[234:235], v[84:85], v[92:93] op_sel:[1,1,0] op_sel_hi:[1,0,1] neg_lo:[1,0,0]
  v_pk_mul_f32 v[30:31], v[236:237], v[92:93] op_sel:[0,0] op_sel_hi:[0,1]
  v_pk_fma_f32 v[30:31], v[236:237], v[92:93], v[30:31] op_sel:[1,1,0] op_sel_hi:[1,0,1] neg_lo:[1,0,0]
  v_cvt_pk_bf16_f32 v172, v16, v18
  v_cvt_pk_bf16_f32 v173, v20, v22
  v_cvt_pk_bf16_f32 v174, v24, v26
  v_cvt_pk_bf16_f32 v175, v28, v30
  v_cvt_pk_bf16_f32 v176, -v17, -v19
  v_cvt_pk_bf16_f32 v177, -v21, -v23
  v_cvt_pk_bf16_f32 v178, -v25, -v27
  v_cvt_pk_bf16_f32 v179, -v29, -v31
  ds_write_b64 v202, v[172:173] offset:8192
  ds_write_b64 v203, v[174:175] offset:8192
  ds_write_b64 v202, v[176:177] offset:9216
  ds_write_b64 v203, v[178:179] offset:9216
  s_cmp_eq_u32 s26, 1
  s_cbranch_scc1 L_skip_10
  v_pk_fma_f32 v[38:39], v[208:209], v[214:215], v[38:39] op_sel:[0,0,0] op_sel_hi:[0,1,1]
  v_pk_fma_f32 v[38:39], v[208:209], v[214:215], v[38:39] op_sel:[1,1,0] op_sel_hi:[1,0,1] neg_lo:[1,0,0]
  v_pk_fma_f32 v[8:9], v[210:211], v[38:39], v[8:9] op_sel:[0,0,0] op_sel_hi:[0,1,1]
  v_pk_fma_f32 v[8:9], v[210:211], v[38:39], v[8:9] op_sel:[1,1,0] op_sel_hi:[1,0,1] neg_lo:[1,0,0]
  v_pk_mul_f32 v[16:17], v[212:213], v[8:9] op_sel:[0,0] op_sel_hi:[0,1]
  v_pk_fma_f32 v[16:17], v[212:213], v[8:9], v[16:17] op_sel:[1,1,0] op_sel_hi:[1,0,1] neg_lo:[1,0,0]
  v_pk_fma_f32 v[10:11], v[210:211], v[8:9], v[10:11] op_sel:[0,0,0] op_sel_hi:[0,1,1]
  v_pk_fma_f32 v[10:11], v[210:211], v[8:9], v[10:11] op_sel:[1,1,0] op_sel_hi:[1,0,1] neg_lo:[1,0,0]
  v_pk_mul_f32 v[18:19], v[212:213], v[10:11] op_sel:[0,0] op_sel_hi:[0,1]
  v_pk_fma_f32 v[18:19], v[212:213], v[10:11], v[18:19] op_sel:[1,1,0] op_sel_hi:[1,0,1] neg_lo:[1,0,0]
  v_pk_fma_f32 v[32:33], v[210:211], v[10:11], v[32:33] op_sel:[0,0,0] op_sel_hi:[0,1,1]
  v_pk_fma_f32 v[32:33], v[210:211], v[10:11], v[32:33] op_sel:[1,1,0] op_sel_hi:[1,0,1] neg_lo:[1,0,0]
  v_pk_mul_f32 v[20:21], v[212:213], v[32:33] op_sel:[0,0] op_sel_hi:[0,1]
  v_pk_fma_f32 v[20:21], v[212:213], v[32:33], v[20:21] op_sel:[1,1,0] op_sel_hi:[1,0,1] neg_lo:[1,0,0]
  v_pk_fma_f32 v[40:41], v[210:211], v[32:33], v[40:41] op_sel:[0,0,0] op_sel_hi:[0,1,1]
  v_pk_fma_f32 v[40:41], v[210:211], v[32:33], v[40:41] op_sel:[1,1,0] op_sel_hi:[1,0,1] neg_lo:[1,0,0]
  v_pk_mul_f32 v[22:23], v[212:213], v[40:41] op_sel:[0,0] op_sel_hi:[0,1]
  v_pk_fma_f32 v[22:23], v[212:213], v[40:41], v[22:23] op_sel:[1,1,0] op_sel_hi:[1,0,1] neg_lo:[1,0,0]
  v_pk_fma_f32 v[34:35], v[210:211], v[40:41], v[34:35] op_sel:[0,0,0] op_sel_hi:[0,1,1]
  v_pk_fma_f32 v[34:35], v[210:211], v[40:41], v[34:35] op_sel:[1,1,0] op_sel_hi:[1,0,1] neg_lo:[1,0,0]
  v_pk_mul_f32 v[24:25], v[212:213], v[34:35] op_sel:[0,0] op_sel_hi:[0,1]
  v_pk_fma_f32 v[24:25], v[212:213], v[34:35], v[24:25] op_sel:[1,1,0] op_sel_hi:[1,0,1] neg_lo:[1,0,0]
  v_pk_fma_f32 v[42:43], v[210:211], v[34:35], v[42:43] op_sel:[0,0,0] op_sel_hi:[0,1,1]
  v_pk_fma_f32 v[42:43], v[210:211], v[34:35], v[42:43] op_sel:[1,1,0] op_sel_hi:[1,0,1] neg_lo:[1,0,0]
  v_pk_mul_f32 v[26:27], v[212:213], v[42:43] op_sel:[0,0] op_sel_hi:[0,1]
  v_pk_fma_f32 v[26:27], v[212:213], v[42:43], v[26:27] op_sel:[1,1,0] op_sel_hi:[1,0,1] neg_lo:[1,0,0]
  v_pk_fma_f32 v[36:37], v[210:211], v[42:43], v[36:37] op_sel:[0,0,0] op_sel_hi:[0,1,1]
  v_pk_fma_f32 v[36:37], v[210:211], v[42:43], v[36:37] op_sel:[1,1,0] op_sel_hi:[1,0,1] neg_lo:[1,0,0]
  v_pk_mul_f32 v[28:29], v[212:213], v[36:37] op_sel:[0,0] op_sel_hi:[0,1]
  v_pk_fma_f32 v[28:29], v[212:213], v[36:37], v[28:29] op_sel:[1,1,0] op_sel_hi:[1,0,1] neg_lo:[1,0,0]
  v_pk_fma_f32 v[44:45], v[210:211], v[36:37], v[44:45] op_sel:[0,0,0] op_sel_hi:[0,1,1]
  v_pk_fma_f32 v[44:45], v[210:211], v[36:37], v[44:45] op_sel:[1,1,0] op_sel_hi:[1,0,1] neg_lo:[1,0,0]
  v_pk_mul_f32 v[30:31], v[212:213], v[44:45] op_sel:[0,0] op_sel_hi:[0,1]
  v_pk_fma_f32 v[30:31], v[212:213], v[44:45], v[30:31] op_sel:[1,1,0] op_sel_hi:[1,0,1] neg_lo:[1,0,0]
  v_cvt_pk_bf16_f32 v248, v16, v18
  v_cvt_pk_bf16_f32 v249, v20, v22
  v_cvt_pk_bf16_f32 v250, v24, v26
  v_cvt_pk_bf16_f32 v251, v28, v30
  v_cvt_pk_bf16_f32 v252, -v17, -v19
  v_cvt_pk_bf16_f32 v253, -v21, -v23
  v_cvt_pk_bf16_f32 v254, -v25, -v27
  v_cvt_pk_bf16_f32 v255, -v29, -v31
  ds_write_b64 v202, v[248:249] offset:16384
  ds_write_b64 v203, v[250:251] offset:16384
  ds_write_b64 v202, v[252:253] offset:17408
  ds_write_b64 v203, v[254:255] offset:17408
L_skip_10:
  s_waitcnt vmcnt(0)
  v_xor_b32 v146, v146, v192
  v_xor_b32 v147, v147, v193
  v_or3_b32 v201, v146, v147, 0
  v_xor_b32 v150, v150, v194
  v_xor_b32 v151, v151, v195
  v_or3_b32 v201, v150, v151, v201
  v_xor_b32 v154, v154, v196
  v_xor_b32 v155, v155, v197
  v_or3_b32 v201, v154, v155, v201
  v_xor_b32 v158, v158, v198
  v_xor_b32 v159, v159, v199
  v_or3_b32 v201, v158, v159, v201
  v_cmp_ne_u32 vcc, 0, v201
  s_nop 0
  s_cmp_eq_u64 vcc, 0
  s_cbranch_scc0 L_slow_r_11
L_back_r_11:
  v_pk_fma_f32 v[152:153], v[164:165], v[156:157], v[152:153] op_sel:[0,0,0] op_sel_hi:[0,1,1]
  v_pk_fma_f32 v[152:153], v[164:165], v[156:157], v[152:153] op_sel:[1,1,0] op_sel_hi:[1,0,1] neg_lo:[1,0,0]
  v_pk_fma_f32 v[148:149], v[164:165], v[152:153], v[148:149] op_sel:[0,0,0] op_sel_hi:[0,1,1]
  v_pk_fma_f32 v[148:149], v[164:165], v[152:153], v[148:149] op_sel:[1,1,0] op_sel_hi:[1,0,1] neg_lo:[1,0,0]
  v_pk_fma_f32 v[144:145], v[164:165], v[148:149], v[144:145] op_sel:[0,0,0] op_sel_hi:[0,1,1]
  v_pk_fma_f32 v[144:145], v[164:165], v[148:149], v[144:145] op_sel:[1,1,0] op_sel_hi:[1,0,1] neg_lo:[1,0,0]
  v_pk_mul_f32 v[146:147], v[166:167], v[144:145] op_sel:[0,0] op_sel_hi:[0,1]
  v_pk_fma_f32 v[146:147], v[166:167], v[144:145], v[146:147] op_sel:[1,1,0] op_sel_hi:[1,0,1] neg_lo:[1,0,0]
  v_pk_mov_b32 v[150:151], v[146:147], v[146:147] op_sel:[0,1]
  s_nop 1
  v_permlane16_swap_b32 v146, v150
  v_permlane16_swap_b32 v147, v151
  v_pk_add_f32 v[146:147], v[146:147], v[150:151]
  v_pk_mov_b32 v[150:151], v[146:147], v[146:147] op_sel:[0,1]
  s_nop 1
  v_permlane32_swap_b32 v146, v150
  v_permlane32_swap_b32 v147, v151
  v_pk_add_f32 v[146:147], v[146:147], v[150:151]
  v_pk_fma_f32 v[102:103], v[240:241], v[146:147], v[102:103] op_sel:[0,0,0] op_sel_hi:[0,1,1]
  v_pk_fma_f32 v[102:103], v[240:241], v[146:147], v[102:103] op_sel:[1,1,0] op_sel_hi:[1,0,1] neg_lo:[1,0,0]
  v_pk_fma_f32 v[94:95], v[242:243], v[102:103], v[94:95] op_sel:[0,0,0] op_sel_hi:[0,1,1]
  v_pk_fma_f32 v[94:95], v[242:243], v[102:103], v[94:95] op_sel:[1,1,0] op_sel_hi:[1,0,1] neg_lo:[1,0,0]
  v_pk_mul_f32 v[16:17], v[244:245], v[94:95] op_sel:[0,0] op_sel_hi:[0,1]
  v_pk_fma_f32 v[16:17], v[244:245], v[94:95], v[16:17] op_sel:[1,1,0] op_sel_hi:[1,0,1] neg_lo:[1,0,0]
  v_pk_fma_f32 v[186:187], v[242:243], v[94:95], v[186:187] op_sel:[0,0,0] op_sel_hi:[0,1,1]
  v_pk_fma_f32 v[186:187], v[242:243], v[94:95], v[186:187] op_sel:[1,1,0] op_sel_hi:[1,0,1] neg_lo:[1,0,0]
  v_pk_mul_f32 v[18:19], v[244:245], v[186:187] op_sel:[0,0] op_sel_hi:[0,1]
  v_pk_fma_f32 v[18:19], v[244:245], v[186:187], v[18:19] op_sel:[1,1,0] op_sel_hi:[1,0,1] neg_lo:[1,0,0]
  v_pk_fma_f32 v[96:97], v[242:243], v[186:187], v[96:97] op_sel:[0,0,0] op_sel_hi:[0,1,1]
  v_pk_fma_f32 v[96:97], v[242:243], v[186:187], v[96:97] op_sel:[1,1,0] op_sel_hi:[1,0,1] neg_lo:[1,0,0]
  v_pk_mul_f32 v[20:21], v[244:245], v[96:97] op_sel:[0,0] op_sel_hi:[0,1]
  v_pk_fma_f32 v[20:21], v[244:245], v[96:97], v[20:21] op_sel:[1,1,0] op_sel_hi:[1,0,1] neg_lo:[1,0,0]
  v_pk_fma_f32 v[104:105], v[242:243], v[96:97], v[104:105] op_sel:[0,0,0] op_sel_hi:[0,1,1]
  v_pk_fma_f32 v[104:105], v[242:243], v[96:97], v[104:105] op_sel:[1,1,0] op_sel_hi:[1,0,1] neg_lo:[1,0,0]
  v_pk_mul_f32 v[22:23], v[244:245], v[104:105] op_sel:[0,0] op_sel_hi:[0,1]
  v_pk_fma_f32 v[22:23], v[244:245], v[104:105], v[22:23] op_sel:[1,1,0] op_sel_hi:[1,0,1] neg_lo:[1,0,0]
  v_pk_fma_f32 v[98:99], v[242:243], v[104:105], v[98:99] op_sel:[0,0,0] op_sel_hi:[0,1,1]
  v_pk_fma_f32 v[98:99], v[242:243], v[104:105], v[98:99] op_sel:[1,1,0] op_sel_hi:[1,0,1] neg_lo:[1,0,0]
  v_pk_mul_f32 v[24:25], v[244:245], v[98:99] op_sel:[0,0] op_sel_hi:[0,1]
  v_pk_fma_f32 v[24:25], v[244:245], v[98:99], v[24:25] op_sel:[1,1,0] op_sel_hi:[1,0,1] neg_lo:[1,0,0]
  v_pk_fma_f32 v[106:107], v[242:243], v[98:99], v[106:107] op_sel:[0,0,0] op_sel_hi:[0,1,1]
  v_pk_fma_f32 v[106:107], v[242:243], v[98:99], v[106:107] op_sel:[1,1,0] op_sel_hi:[1,0,1] neg_lo:[1,0,0]
  v_pk_mul_f32 v[26:27], v[244:245], v[106:107] op_sel:[0,0] op_sel_hi:[0,1]
  v_pk_fma_f32 v[26:27], v[244:245], v[106:107], v[26:27] op_sel:[1,1,0] op_sel_hi:[1,0,1] neg_lo:[1,0,0]
  v_pk_fma_f32 v[100:101], v[242:243], v[106:107], v[100:101] op_sel:[0,0,0] op_sel_hi:[0,1,1]
  v_pk_fma_f32 v[100:101], v[242:243], v[106:107], v[100:101] op_sel:[1,1,0] op_sel_hi:[1,0,1] neg_lo:[1,0,0]
  v_pk_mul_f32 v[28:29], v[244:245], v[100:101] op_sel:[0,0] op_sel_hi:[0,1]
  v_pk_fma_f32 v[28:29], v[244:245], v[100:101], v[28:29] op_sel:[1,1,0] op_sel_hi:[1,0,1] neg_lo:[1,0,0]
  v_pk_fma_f32 v[108:109], v[242:243], v[100:101], v[108:109] op_sel:[0,0,0] op_sel_hi:[0,1,1]
  v_pk_fma_f32 v[108:109], v[242:243], v[100:101], v[108:109] op_sel:[1,1,0] op_sel_hi:[1,0,1] neg_lo:[1,0,0]
  v_pk_mul_f32 v[30:31], v[244:245], v[108:109] op_sel:[0,0] op_sel_hi:[0,1]
  v_pk_fma_f32 v[30:31], v[244:245], v[108:109], v[30:31] op_sel:[1,1,0] op_sel_hi:[1,0,1] neg_lo:[1,0,0]
  v_cvt_pk_bf16_f32 v248, v16, v18
  v_cvt_pk_bf16_f32 v249, v20, v22
  v_cvt_pk_bf16_f32 v250, v24, v26
  v_cvt_pk_bf16_f32 v251, v28, v30
  v_cvt_pk_bf16_f32 v252, -v17, -v19
  v_cvt_pk_bf16_f32 v253, -v21, -v23
  v_cvt_pk_bf16_f32 v254, -v25, -v27
  v_cvt_pk_bf16_f32 v255, -v29, -v31
  ds_write_b64 v202, v[248:249] offset:12288
  ds_write_b64 v203, v[250:251] offset:12288
  ds_write_b64 v202, v[252:253] offset:13312
  ds_write_b64 v203, v[254:255] offset:13312
  s_waitcnt vmcnt(0) lgkmcnt(0)
  s_barrier
  ds_read_b64_tr_b16 v[32:33], v140 offset:0
  ds_read_b64_tr_b16 v[34:35], v141 offset:256
  ds_read_b64_tr_b16 v[36:37], v142 offset:0
  ds_read_b64_tr_b16 v[38:39], v143 offset:256
  ds_read_b64_tr_b16 v[40:41], v140 offset:2048
  ds_read_b64_tr_b16 v[42:43], v141 offset:2304
  ds_read_b64_tr_b16 v[44:45], v142 offset:2048
  ds_read_b64_tr_b16 v[46:47], v143 offset:2304
  ds_read_b64_tr_b16 v[48:49], v140 offset:4096
  ds_read_b64_tr_b16 v[50:51], v141 offset:4352
  ds_read_b64_tr_b16 v[52:53], v142 offset:4096
  ds_read_b64_tr_b16 v[54:55], v143 offset:4352
  ds_read_b64_tr_b16 v[56:57], v140 offset:6144
  ds_read_b64_tr_b16 v[58:59], v141 offset:6400
  ds_read_b64_tr_b16 v[60:61], v142 offset:6144
  ds_read_b64_tr_b16 v[62:63], v143 offset:6400
  ds_read_b64_tr_b16 v[64:65], v140 offset:8192
  ds_read_b64_tr_b16 v[66:67], v141 offset:8448
  ds_read_b64_tr_b16 v[68:69], v142 offset:8192
  ds_read_b64_tr_b16 v[70:71], v143 offset:8448
  ds_read_b64_tr_b16 v[72:73], v140 offset:10240
  ds_read_b64_tr_b16 v[74:75], v141 offset:10496
  ds_read_b64_tr_b16 v[76:77], v142 offset:10240
  ds_read_b64_tr_b16 v[78:79], v143 offset:10496
  ds_read_b64_tr_b16 v[80:81], v140 offset:12288
  ds_read_b64_tr_b16 v[82:83], v141 offset:12544
  ds_read_b64_tr_b16 v[84:85], v142 offset:12288
  ds_read_b64_tr_b16 v[86:87], v143 offset:12544
  ds_read_b64_tr_b16 v[88:89], v140 offset:14336
  ds_read_b64_tr_b16 v[90:91], v141 offset:14592
  ds_read_b64_tr_b16 v[92:93], v142 offset:14336
  ds_read_b64_tr_b16 v[94:95], v143 offset:14592
  ds_read_b64_tr_b16 v[96:97], v140 offset:16384
  ds_read_b64_tr_b16 v[98:99], v141 offset:16640
  ds_read_b64_tr_b16 v[100:101], v142 offset:16384
  ds_read_b64_tr_b16 v[102:103], v143 offset:16640
  v_mov_b32 v240, s30
  v_mov_b32 v241, s31
  v_lshlrev_b32 v242, 5, v0
  v_lshrrev_b32 v243, 2, v0
  v_sub_u32 v243, v0, v243
  ds_read_b128 v[176:179], v128 offset:0
  ds_read_b128 v[180:183], v129 offset:0
  ds_read_b128 v[184:187], v130 offset:0
  ds_read_b128 v[188:191], v131 offset:0
  ds_read_b128 v[192:195], v128 offset:1024
  ds_read_b128 v[196:199], v129 offset:1024
  ds_read_b128 v[200:203], v130 offset:1024
  s_waitcnt lgkmcnt(7)
  s_barrier
  s_waitcnt lgkmcnt(6)
  ds_read_b128 v[204:207], v131 offset:1024
  v_mfma_f32_16x16x32_bf16 v[144:147], v[176:179], v[32:35], 0
  s_add_u32 m0, s35, 73728
  s_add_u32 s49, s20, 1
  s_cmp_ge_u32 s49, 6
  s_cselect_b32 s4, 6, 0
  s_sub_u32 s49, s49, s4
  s_lshr_b32 s4, s49, 1
  s_lshl_b32 s4, s4, 2
  s_add_u32 s4, s4, s49
  s_mul_i32 s4, s4, 36864
  s_add_u32 s4, s4, s33
  s_add_u32 s49, s4, 0
  s_mov_b64 exec, s[74:75]
  buffer_load_dwordx4 v1, s[12:15], s49 offen lds
  s_mov_b64 exec, -1
  v_mfma_f32_16x16x32_bf16 v[148:151], v[176:179], v[36:39], 0
  s_waitcnt lgkmcnt(6)
  ds_read_b128 v[176:179], v128 offset:2048
  v_mfma_f32_16x16x32_bf16 v[144:147], v[180:183], v[40:43], v[144:147]
  s_add_u32 m0, s35, 74752
  s_add_u32 s49, s4, 128
  buffer_load_dwordx4 v1, s[12:15], s49 offen lds
  v_mfma_f32_16x16x32_bf16 v[148:151], v[180:183], v[44:47], v[148:151]
  s_waitcnt lgkmcnt(6)
  ds_read_b128 v[180:183], v128 offset:24576
  v_mfma_f32_16x16x32_bf16 v[144:147], v[184:187], v[48:51], v[144:147]
  s_add_u32 m0, s35, 75776
  s_add_u32 s49, s4, 256
  s_mov_b64 exec, s[76:77]
  buffer_load_dwordx4 v1, s[12:15], s49 offen lds
  s_mov_b64 exec, -1
  v_mfma_f32_16x16x32_bf16 v[148:151], v[184:187], v[52:55], v[148:151]
  s_waitcnt lgkmcnt(6)
  ds_read_b128 v[184:187], v129 offset:24576
  v_mfma_f32_16x16x32_bf16 v[144:147], v[188:191], v[56:59], v[144:147]
  s_add_u32 m0, s35, 98304
  s_add_u32 s49, s4, 73728
  s_mov_b64 exec, s[74:75]
  buffer_load_dwordx4 v1, s[12:15], s49 offen lds
  s_mov_b64 exec, -1
  v_mfma_f32_16x16x32_bf16 v[148:151], v[188:191], v[60:63], v[148:151]
  s_waitcnt lgkmcnt(6)
  ds_read_b128 v[188:191], v130 offset:24576
  v_mfma_f32_16x16x32_bf16 v[144:147], v[192:195], v[64:67], v[144:147]
  s_add_u32 m0, s35, 99328
  s_add_u32 s49, s4, 73856
  buffer_load_dwordx4 v1, s[12:15], s49 offen lds
  v_mfma_f32_16x16x32_bf16 v[148:151], v[192:195], v[68:71], v[148:151]
  s_waitcnt lgkmcnt(6)
  ds_read_b128 v[192:195], v131 offset:24576
  v_mfma_f32_16x16x32_bf16 v[144:147], v[196:199], v[72:75], v[144:147]
  s_add_u32 m0, s35, 100352
  s_add_u32 s49, s4, 73984
  s_mov_b64 exec, s[76:77]
  buffer_load_dwordx4 v1, s[12:15], s49 offen lds
  s_mov_b64 exec, -1
  v_mfma_f32_16x16x32_bf16 v[148:151], v[196:199], v[76:79], v[148:151]
  s_waitcnt lgkmcnt(6)
  ds_read_b128 v[196:199], v128 offset:25600
  v_mfma_f32_16x16x32_bf16 v[144:147], v[200:203], v[80:83], v[144:147]
  s_add_u32 m0, s35, 122880
  s_add_u32 s49, s4, 147456
  s_mov_b64 exec, s[74:75]
  buffer_load_dwordx4 v1, s[12:15], s49 offen lds
  s_mov_b64 exec, -1
  v_mfma_f32_16x16x32_bf16 v[148:151], v[200:203], v[84:87], v[148:151]
  s_waitcnt lgkmcnt(6)
  ds_read_b128 v[200:203], v129 offset:25600
  v_mfma_f32_16x16x32_bf16 v[144:147], v[204:207], v[88:91], v[144:147]
  s_add_u32 m0, s35, 123904
  s_add_u32 s49, s4, 147584
  buffer_load_dwordx4 v1, s[12:15], s49 offen lds
  v_mfma_f32_16x16x32_bf16 v[148:151], v[204:207], v[92:95], v[148:151]
  s_waitcnt lgkmcnt(6)
  ds_read_b128 v[204:207], v130 offset:25600
  v_mfma_f32_16x16x32_bf16 v[144:147], v[176:179], v[96:99], v[144:147]
  s_add_u32 m0, s35, 124928
  s_add_u32 s49, s4, 147712
  s_mov_b64 exec, s[76:77]
  buffer_load_dwordx4 v1, s[12:15], s49 offen lds
  s_mov_b64 exec, -1
  v_mfma_f32_16x16x32_bf16 v[148:151], v[176:179], v[100:103], v[148:151]
  s_barrier
  s_waitcnt lgkmcnt(6)
  ds_read_b128 v[176:179], v131 offset:25600
  v_mfma_f32_16x16x32_bf16 v[152:155], v[180:183], v[32:35], 0
  s_add_u32 m0, s35, 0
  s_add_u32 s49, s20, 2
  s_cmp_ge_u32 s49, 6
  s_cselect_b32 s4, 6, 0
  s_sub_u32 s49, s49, s4
  s_lshr_b32 s4, s49, 1
  s_lshl_b32 s4, s4, 2
  s_add_u32 s4, s4, s49
  s_mul_i32 s4, s4, 36864
  s_add_u32 s4, s4, s33
  s_add_u32 s49, s4, 0
  s_mov_b64 exec, s[74:75]
  buffer_load_dwordx4 v1, s[12:15], s49 offen lds
  s_mov_b64 exec, -1
  v_mfma_f32_16x16x32_bf16 v[156:159], v[180:183], v[36:39], 0
  s_waitcnt lgkmcnt(6)
  ds_read_b128 v[180:183], v128 offset:26624
  v_mfma_f32_16x16x32_bf16 v[152:155], v[184:187], v[40:43], v[152:155]
  v_mfma_f32_16x16x32_bf16 v[156:159], v[184:187], v[44:47], v[156:159]
  s_waitcnt lgkmcnt(6)
  ds_read_b128 v[184:187], v132 offset:0
  v_mfma_f32_16x16x32_bf16 v[152:155], v[188:191], v[48:51], v[152:155]
  v_cvt_pk_bf16_f32 v208, v144, v145
  v_cvt_pk_bf16_f32 v209, v146, v147
  v_mfma_f32_16x16x32_bf16 v[156:159], v[188:191], v[52:55], v[156:159]
  v_cvt_pk_bf16_f32 v216, v148, v149
  v_cvt_pk_bf16_f32 v217, v150, v151
  s_waitcnt lgkmcnt(6)
  ds_read_b128 v[188:191], v133 offset:0
  v_mfma_f32_16x16x32_bf16 v[152:155], v[192:195], v[56:59], v[152:155]
  s_add_u32 m0, s35, 1024
  s_add_u32 s49, s4, 128
  buffer_load_dwordx4 v1, s[12:15], s49 offen lds
  v_mfma_f32_16x16x32_bf16 v[156:159], v[192:195], v[60:63], v[156:159]
  s_add_u32 s5, s20, 0
  s_cmp_ge_u32 s5, 6
  s_cselect_b32 s48, 6, 0
  s_sub_u32 s5, s5, s48
  s_lshl_b32 s6, s5, 10
  s_add_u32 s6, s6, s59
  s_lshl_b32 s5, s5, 15
  s_add_u32 s5, s5, s54
  s_bfe_u32 s48, s86, 0x20000
  s_mul_i32 s7, s48, 3145728
  s_add_u32 s5, s5, s7
  s_lshl_b32 s48, s48, 3
  s_add_u32 s50, s6, s48
  s_add_u32 s7, s5, 16384
  s_waitcnt lgkmcnt(6)
  ds_read_b128 v[192:195], v134 offset:0
  v_mfma_f32_16x16x32_bf16 v[152:155], v[196:199], v[64:67], v[152:155]
  v_mfma_f32_16x16x32_bf16 v[156:159], v[196:199], v[68:71], v[156:159]
  s_waitcnt lgkmcnt(6)
  ds_read_b128 v[196:199], v135 offset:0
  v_mfma_f32_16x16x32_bf16 v[152:155], v[200:203], v[72:75], v[152:155]
  v_mfma_f32_16x16x32_bf16 v[156:159], v[200:203], v[76:79], v[156:159]
  s_waitcnt lgkmcnt(6)
  ds_read_b128 v[200:203], v132 offset:1024
  v_mfma_f32_16x16x32_bf16 v[152:155], v[204:207], v[80:83], v[152:155]
  s_add_u32 m0, s35, 2048
  s_add_u32 s49, s4, 256
  s_mov_b64 exec, s[76:77]
  buffer_load_dwordx4 v1, s[12:15], s49 offen lds
  s_mov_b64 exec, -1
  v_mfma_f32_16x16x32_bf16 v[156:159], v[204:207], v[84:87], v[156:159]
  s_waitcnt lgkmcnt(6)
  ds_read_b128 v[204:207], v133 offset:1024
  v_mfma_f32_16x16x32_bf16 v[152:155], v[176:179], v[88:91], v[152:155]
  v_mfma_f32_16x16x32_bf16 v[156:159], v[176:179], v[92:95], v[156:159]
  s_waitcnt lgkmcnt(6)
  ds_read_b128 v[176:179], v134 offset:1024
  v_mfma_f32_16x16x32_bf16 v[152:155], v[180:183], v[96:99], v[152:155]
  v_mfma_f32_16x16x32_bf16 v[156:159], v[180:183], v[100:103], v[156:159]
  s_waitcnt vmcnt(9)
  s_barrier
  s_waitcnt lgkmcnt(6)
  ds_read_b128 v[180:183], v135 offset:1024
  v_mfma_f32_16x16x32_bf16 v[144:147], v[184:187], v[32:35], 0
  s_add_u32 m0, s35, 24576
  s_add_u32 s49, s4, 73728
  s_mov_b64 exec, s[74:75]
  buffer_load_dwordx4 v1, s[12:15], s49 offen lds
  s_mov_b64 exec, -1
  v_mfma_f32_16x16x32_bf16 v[148:151], v[184:187], v[36:39], 0
  s_waitcnt lgkmcnt(6)
  ds_read_b128 v[184:187], v132 offset:2048
  v_mfma_f32_16x16x32_bf16 v[144:147], v[188:191], v[40:43], v[144:147]
  v_mfma_f32_16x16x32_bf16 v[148:151], v[188:191], v[44:47], v[148:151]
  s_waitcnt lgkmcnt(6)
  ds_read_b128 v[188:191], v132 offset:24576
  v_mfma_f32_16x16x32_bf16 v[144:147], v[192:195], v[48:51], v[144:147]
  v_cvt_pk_bf16_f32 v210, v152, v153
  v_cvt_pk_bf16_f32 v212, v154, v155
  v_mfma_f32_16x16x32_bf16 v[148:151], v[192:195], v[52:55], v[148:151]
  v_cvt_pk_bf16_f32 v218, v156, v157
  v_cvt_pk_bf16_f32 v220, v158, v159
  s_waitcnt lgkmcnt(6)
  ds_read_b128 v[192:195], v133 offset:24576
  v_mfma_f32_16x16x32_bf16 v[144:147], v[196:199], v[56:59], v[144:147]
  s_add_u32 m0, s35, 25600
  s_add_u32 s49, s4, 73856
  buffer_load_dwordx4 v1, s[12:15], s49 offen lds
  v_mfma_f32_16x16x32_bf16 v[148:151], v[196:199], v[60:63], v[148:151]
  s_waitcnt lgkmcnt(6)
  ds_read_b128 v[196:199], v134 offset:24576
  v_mfma_f32_16x16x32_bf16 v[144:147], v[200:203], v[64:67], v[144:147]
  v_mfma_f32_16x16x32_bf16 v[148:151], v[200:203], v[68:71], v[148:151]
  buffer_store_dwordx3 v[208:210], v243, s[16:19], s5 offen offset:0 sc1
  s_waitcnt lgkmcnt(6)
  ds_read_b128 v[200:203], v135 offset:24576
  v_mfma_f32_16x16x32_bf16 v[144:147], v[204:207], v[72:75], v[144:147]
  v_mfma_f32_16x16x32_bf16 v[148:151], v[204:207], v[76:79], v[148:151]
  s_waitcnt lgkmcnt(6)
  ds_read_b128 v[204:207], v132 offset:25600
  v_mfma_f32_16x16x32_bf16 v[144:147], v[176:179], v[80:83], v[144:147]
  s_add_u32 m0, s35, 26624
  s_add_u32 s49, s4, 73984
  s_mov_b64 exec, s[76:77]
  buffer_load_dwordx4 v1, s[12:15], s49 offen lds
  s_mov_b64 exec, -1
  v_mfma_f32_16x16x32_bf16 v[148:151], v[176:179], v[84:87], v[148:151]
  s_waitcnt lgkmcnt(6)
  ds_read_b128 v[176:179], v133 offset:25600
  v_mfma_f32_16x16x32_bf16 v[144:147], v[180:183], v[88:91], v[144:147]
  v_mfma_f32_16x16x32_bf16 v[148:151], v[180:183], v[92:95], v[148:151]
  s_waitcnt lgkmcnt(6)
  ds_read_b128 v[180:183], v134 offset:25600
  v_mfma_f32_16x16x32_bf16 v[144:147], v[184:187], v[96:99], v[144:147]
  buffer_store_dwordx3 v[216:218], v243, s[16:19], s7 offen offset:0 sc1
  v_mfma_f32_16x16x32_bf16 v[148:151], v[184:187], v[100:103], v[148:151]
  s_waitcnt vmcnt(11)
  s_barrier
  s_waitcnt lgkmcnt(6)
  ds_read_b128 v[184:187], v135 offset:25600
  v_mfma_f32_16x16x32_bf16 v[152:155], v[188:191], v[32:35], 0
  s_add_u32 m0, s35, 49152
  s_add_u32 s49, s4, 147456
  s_mov_b64 exec, s[74:75]
  buffer_load_dwordx4 v1, s[12:15], s49 offen lds
  s_mov_b64 exec, -1
  v_mfma_f32_16x16x32_bf16 v[156:159], v[188:191], v[36:39], 0
  s_waitcnt lgkmcnt(6)
  ds_read_b128 v[188:191], v132 offset:26624
  v_mfma_f32_16x16x32_bf16 v[152:155], v[192:195], v[40:43], v[152:155]
  v_mfma_f32_16x16x32_bf16 v[156:159], v[192:195], v[44:47], v[156:159]
  s_waitcnt lgkmcnt(6)
  ds_read_b128 v[192:195], v136 offset:0
  v_mfma_f32_16x16x32_bf16 v[152:155], v[196:199], v[48:51], v[152:155]
  v_cvt_pk_bf16_f32 v213, v144, v145
  v_cvt_pk_bf16_f32 v214, v146, v147
  v_mfma_f32_16x16x32_bf16 v[156:159], v[196:199], v[52:55], v[156:159]
  v_cvt_pk_bf16_f32 v221, v148, v149
  v_cvt_pk_bf16_f32 v222, v150, v151
  s_waitcnt lgkmcnt(6)
  ds_read_b128 v[196:199], v137 offset:0
  v_mfma_f32_16x16x32_bf16 v[152:155], v[200:203], v[56:59], v[152:155]
  s_add_u32 m0, s35, 50176
  s_add_u32 s49, s4, 147584
  buffer_load_dwordx4 v1, s[12:15], s49 offen lds
  v_mfma_f32_16x16x32_bf16 v[156:159], v[200:203], v[60:63], v[156:159]
  s_waitcnt lgkmcnt(6)
  ds_read_b128 v[200:203], v138 offset:0
  v_mfma_f32_16x16x32_bf16 v[152:155], v[204:207], v[64:67], v[152:155]
  v_mfma_f32_16x16x32_bf16 v[156:159], v[204:207], v[68:71], v[156:159]
  s_waitcnt lgkmcnt(6)
  ds_read_b128 v[204:207], v139 offset:0
  v_mfma_f32_16x16x32_bf16 v[152:155], v[176:179], v[72:75], v[152:155]
  v_mfma_f32_16x16x32_bf16 v[156:159], v[176:179], v[76:79], v[156:159]
  buffer_store_dwordx3 v[212:214], v243, s[16:19], s5 offen offset:1024 sc1
  s_waitcnt lgkmcnt(6)
  ds_read_b128 v[176:179], v136 offset:1024
  v_mfma_f32_16x16x32_bf16 v[152:155], v[180:183], v[80:83], v[152:155]
  s_add_u32 m0, s35, 51200
  s_add_u32 s49, s4, 147712
  s_mov_b64 exec, s[76:77]
  buffer_load_dwordx4 v1, s[12:15], s49 offen lds
  s_mov_b64 exec, -1
  v_mfma_f32_16x16x32_bf16 v[156:159], v[180:183], v[84:87], v[156:159]
  s_waitcnt lgkmcnt(6)
  ds_read_b128 v[180:183], v137 offset:1024
  v_mfma_f32_16x16x32_bf16 v[152:155], v[184:187], v[88:91], v[152:155]
  v_mfma_f32_16x16x32_bf16 v[156:159], v[184:187], v[92:95], v[156:159]
  buffer_store_dwordx3 v[220:222], v243, s[16:19], s7 offen offset:1024 sc1
  s_waitcnt lgkmcnt(6)
  ds_read_b128 v[184:187], v138 offset:1024
  v_mfma_f32_16x16x32_bf16 v[152:155], v[188:191], v[96:99], v[152:155]
  v_mfma_f32_16x16x32_bf16 v[156:159], v[188:191], v[100:103], v[156:159]
  s_waitcnt vmcnt(13)
  s_barrier
  s_waitcnt lgkmcnt(6)
  ds_read_b128 v[188:191], v139 offset:1024
  v_mfma_f32_16x16x32_bf16 v[144:147], v[192:195], v[32:35], 0
  s_add_u32 m0, s35, 73728
  s_add_u32 s49, s20, 3
  s_cmp_ge_u32 s49, 6
  s_cselect_b32 s4, 6, 0
  s_sub_u32 s49, s49, s4
  s_lshr_b32 s4, s49, 1
  s_lshl_b32 s4, s4, 2
  s_add_u32 s4, s4, s49
  s_mul_i32 s4, s4, 36864
  s_add_u32 s4, s4, s33
  s_add_u32 s49, s4, 0
  s_mov_b64 exec, s[74:75]
  buffer_load_dwordx4 v1, s[12:15], s49 offen lds
  s_mov_b64 exec, -1
  v_mfma_f32_16x16x32_bf16 v[148:151], v[192:195], v[36:39], 0
  s_waitcnt lgkmcnt(6)
  ds_read_b128 v[192:195], v136 offset:2048
  v_mfma_f32_16x16x32_bf16 v[144:147], v[196:199], v[40:43], v[144:147]
  v_mfma_f32_16x16x32_bf16 v[148:151], v[196:199], v[44:47], v[148:151]
  s_waitcnt lgkmcnt(6)
  ds_read_b128 v[196:199], v136 offset:24576
  v_mfma_f32_16x16x32_bf16 v[144:147], v[200:203], v[48:51], v[144:147]
  v_cvt_pk_bf16_f32 v224, v152, v153
  v_cvt_pk_bf16_f32 v225, v154, v155
  v_mfma_f32_16x16x32_bf16 v[148:151], v[200:203], v[52:55], v[148:151]
  v_cvt_pk_bf16_f32 v232, v156, v157
  v_cvt_pk_bf16_f32 v233, v158, v159
  s_waitcnt lgkmcnt(6)
  ds_read_b128 v[200:203], v137 offset:24576
  v_mfma_f32_16x16x32_bf16 v[144:147], v[204:207], v[56:59], v[144:147]
  s_add_u32 m0, s35, 74752
  s_add_u32 s49, s4, 128
  buffer_load_dwordx4 v1, s[12:15], s49 offen lds
  v_mfma_f32_16x16x32_bf16 v[148:151], v[204:207], v[60:63], v[148:151]
  s_add_u32 s5, s20, 1
  s_cmp_ge_u32 s5, 6
  s_cselect_b32 s48, 6, 0
  s_sub_u32 s5, s5, s48
  s_lshl_b32 s6, s5, 10
  s_add_u32 s6, s6, s59
  s_lshl_b32 s5, s5, 15
  s_add_u32 s5, s5, s54
  s_bfe_u32 s48, s86, 0x20002
  s_mul_i32 s7, s48, 3145728
  s_add_u32 s5, s5, s7
  s_lshl_b32 s48, s48, 3
  s_add_u32 s51, s6, s48
  s_add_u32 s7, s5, 16384
  s_waitcnt lgkmcnt(6)
  ds_read_b128 v[204:207], v138 offset:24576
  v_mfma_f32_16x16x32_bf16 v[144:147], v[176:179], v[64:67], v[144:147]
  v_mfma_f32_16x16x32_bf16 v[148:151], v[176:179], v[68:71], v[148:151]
  s_waitcnt lgkmcnt(6)
  ds_read_b128 v[176:179], v139 offset:24576
  v_mfma_f32_16x16x32_bf16 v[144:147], v[180:183], v[72:75], v[144:147]
  v_mfma_f32_16x16x32_bf16 v[148:151], v[180:183], v[76:79], v[148:151]
  s_waitcnt lgkmcnt(6)
  ds_read_b128 v[180:183], v136 offset:25600
  v_mfma_f32_16x16x32_bf16 v[144:147], v[184:187], v[80:83], v[144:147]
  s_add_u32 m0, s35, 75776
  s_add_u32 s49, s4, 256
  s_mov_b64 exec, s[76:77]
  buffer_load_dwordx4 v1, s[12:15], s49 offen lds
  s_mov_b64 exec, -1
  v_mfma_f32_16x16x32_bf16 v[148:151], v[184:187], v[84:87], v[148:151]
  s_waitcnt lgkmcnt(6)
  ds_read_b128 v[184:187], v137 offset:25600
  v_mfma_f32_16x16x32_bf16 v[144:147], v[188:191], v[88:91], v[144:147]
  v_mfma_f32_16x16x32_bf16 v[148:151], v[188:191], v[92:95], v[148:151]
  s_waitcnt lgkmcnt(6)
  ds_read_b128 v[188:191], v138 offset:25600
  v_mfma_f32_16x16x32_bf16 v[144:147], v[192:195], v[96:99], v[144:147]
  v_mfma_f32_16x16x32_bf16 v[148:151], v[192:195], v[100:103], v[148:151]
  s_waitcnt vmcnt(13)
  s_barrier
  s_waitcnt lgkmcnt(6)
  ds_read_b128 v[192:195], v139 offset:25600
  v_mfma_f32_16x16x32_bf16 v[152:155], v[196:199], v[32:35], 0
  s_add_u32 m0, s35, 98304
  s_add_u32 s49, s4, 73728
  s_mov_b64 exec, s[74:75]
  buffer_load_dwordx4 v1, s[12:15], s49 offen lds
  s_mov_b64 exec, -1
  v_mfma_f32_16x16x32_bf16 v[156:159], v[196:199], v[36:39], 0
  s_waitcnt lgkmcnt(6)
  ds_read_b128 v[196:199], v136 offset:26624
  v_mfma_f32_16x16x32_bf16 v[152:155], v[200:203], v[40:43], v[152:155]
  v_mfma_f32_16x16x32_bf16 v[156:159], v[200:203], v[44:47], v[156:159]
  s_waitcnt lgkmcnt(6)
  ds_read_b128 v[200:203], v128 offset:0
  v_mfma_f32_16x16x32_bf16 v[152:155], v[204:207], v[48:51], v[152:155]
  v_cvt_pk_bf16_f32 v226, v144, v145
  v_cvt_pk_bf16_f32 v228, v146, v147
  v_mfma_f32_16x16x32_bf16 v[156:159], v[204:207], v[52:55], v[156:159]
  v_cvt_pk_bf16_f32 v234, v148, v149
  v_cvt_pk_bf16_f32 v236, v150, v151
  s_waitcnt lgkmcnt(6)
  ds_read_b128 v[204:207], v129 offset:0
  v_mfma_f32_16x16x32_bf16 v[152:155], v[176:179], v[56:59], v[152:155]
  s_add_u32 m0, s35, 99328
  s_add_u32 s49, s4, 73856
  buffer_load_dwordx4 v1, s[12:15], s49 offen lds
  v_mfma_f32_16x16x32_bf16 v[156:159], v[176:179], v[60:63], v[156:159]
  s_waitcnt lgkmcnt(6)
  ds_read_b128 v[176:179], v130 offset:0
  v_mfma_f32_16x16x32_bf16 v[152:155], v[180:183], v[64:67], v[152:155]
  v_mfma_f32_16x16x32_bf16 v[156:159], v[180:183], v[68:71], v[156:159]
  buffer_store_dwordx3 v[224:226], v243, s[16:19], s5 offen offset:0 sc1
  s_waitcnt lgkmcnt(6)
  ds_read_b128 v[180:183], v131 offset:0
  v_mfma_f32_16x16x32_bf16 v[152:155], v[184:187], v[72:75], v[152:155]
  v_mfma_f32_16x16x32_bf16 v[156:159], v[184:187], v[76:79], v[156:159]
  s_waitcnt lgkmcnt(6)
  ds_read_b128 v[184:187], v128 offset:1024
  v_mfma_f32_16x16x32_bf16 v[152:155], v[188:191], v[80:83], v[152:155]
  s_add_u32 m0, s35, 100352
  s_add_u32 s49, s4, 73984
  s_mov_b64 exec, s[76:77]
  buffer_load_dwordx4 v1, s[12:15], s49 offen lds
  s_mov_b64 exec, -1
  v_mfma_f32_16x16x32_bf16 v[156:159], v[188:191], v[84:87], v[156:159]
  s_waitcnt lgkmcnt(6)
  ds_read_b128 v[188:191], v129 offset:1024
  v_mfma_f32_16x16x32_bf16 v[152:155], v[192:195], v[88:91], v[152:155]
  v_mfma_f32_16x16x32_bf16 v[156:159], v[192:195], v[92:95], v[156:159]
  s_waitcnt lgkmcnt(6)
  ds_read_b128 v[192:195], v130 offset:1024
  v_mfma_f32_16x16x32_bf16 v[152:155], v[196:199], v[96:99], v[152:155]
  buffer_store_dwordx3 v[232:234], v243, s[16:19], s7 offen offset:0 sc1
  v_mfma_f32_16x16x32_bf16 v[156:159], v[196:199], v[100:103], v[156:159]
  s_waitcnt vmcnt(14)
  s_waitcnt vmcnt(8)
  s_mov_b32 exec_lo, 0x3
  s_mov_b32 exec_hi, 0x0
  buffer_store_dwordx2 v[240:241], v242, s[16:19], s50 offen sc1
  s_mov_b64 exec, -1
  s_barrier
  s_waitcnt lgkmcnt(6)
  ds_read_b128 v[196:199], v131 offset:1024
  v_mfma_f32_16x16x32_bf16 v[144:147], v[200:203], v[32:35], 0
  s_add_u32 m0, s35, 122880
  s_add_u32 s49, s4, 147456
  s_mov_b64 exec, s[74:75]
  buffer_load_dwordx4 v1, s[12:15], s49 offen lds
  s_mov_b64 exec, -1
  v_mfma_f32_16x16x32_bf16 v[148:151], v[200:203], v[36:39], 0
  s_waitcnt lgkmcnt(6)
  ds_read_b128 v[200:203], v128 offset:2048
  v_mfma_f32_16x16x32_bf16 v[144:147], v[204:207], v[40:43], v[144:147]
  v_mfma_f32_16x16x32_bf16 v[148:151], v[204:207], v[44:47], v[148:151]
  s_waitcnt lgkmcnt(6)
  ds_read_b128 v[204:207], v128 offset:24576
  v_mfma_f32_16x16x32_bf16 v[144:147], v[176:179], v[48:51], v[144:147]
  v_cvt_pk_bf16_f32 v229, v152, v153
  v_cvt_pk_bf16_f32 v230, v154, v155
  v_mfma_f32_16x16x32_bf16 v[148:151], v[176:179], v[52:55], v[148:151]
  v_cvt_pk_bf16_f32 v237, v156, v157
  v_cvt_pk_bf16_f32 v238, v158, v159
  s_waitcnt lgkmcnt(6)
  ds_read_b128 v[176:179], v129 offset:24576
  v_mfma_f32_16x16x32_bf16 v[144:147], v[180:183], v[56:59], v[144:147]
  s_add_u32 m0, s35, 123904
  s_add_u32 s49, s4, 147584
  buffer_load_dwordx4 v1, s[12:15], s49 offen lds
  v_mfma_f32_16x16x32_bf16 v[148:151], v[180:183], v[60:63], v[148:151]
  s_waitcnt lgkmcnt(6)
  ds_read_b128 v[180:183], v130 offset:24576
  v_mfma_f32_16x16x32_bf16 v[144:147], v[184:187], v[64:67], v[144:147]
  v_mfma_f32_16x16x32_bf16 v[148:151], v[184:187], v[68:71], v[148:151]
  s_waitcnt lgkmcnt(6)
  ds_read_b128 v[184:187], v131 offset:24576
  v_mfma_f32_16x16x32_bf16 v[144:147], v[188:191], v[72:75], v[144:147]
  v_mfma_f32_16x16x32_bf16 v[148:151], v[188:191], v[76:79], v[148:151]
  buffer_store_dwordx3 v[228:230], v243, s[16:19], s5 offen offset:1024 sc1
  s_waitcnt lgkmcnt(6)
  ds_read_b128 v[188:191], v128 offset:25600
  v_mfma_f32_16x16x32_bf16 v[144:147], v[192:195], v[80:83], v[144:147]
  s_add_u32 m0, s35, 124928
  s_add_u32 s49, s4, 147712
  s_mov_b64 exec, s[76:77]
  buffer_load_dwordx4 v1, s[12:15], s49 offen lds
  s_mov_b64 exec, -1
  v_mfma_f32_16x16x32_bf16 v[148:151], v[192:195], v[84:87], v[148:151]
  s_waitcnt lgkmcnt(6)
  ds_read_b128 v[192:195], v129 offset:25600
  v_mfma_f32_16x16x32_bf16 v[144:147], v[196:199], v[88:91], v[144:147]
  v_mfma_f32_16x16x32_bf16 v[148:151], v[196:199], v[92:95], v[148:151]
  buffer_store_dwordx3 v[236:238], v243, s[16:19], s7 offen offset:1024 sc1
  s_waitcnt lgkmcnt(6)
  ds_read_b128 v[196:199], v130 offset:25600
  v_mfma_f32_16x16x32_bf16 v[144:147], v[200:203], v[96:99], v[144:147]
  v_mfma_f32_16x16x32_bf16 v[148:151], v[200:203], v[100:103], v[148:151]
  s_barrier
  s_waitcnt lgkmcnt(6)
  ds_read_b128 v[200:203], v131 offset:25600
  v_mfma_f32_16x16x32_bf16 v[152:155], v[204:207], v[32:35], 0
  s_add_u32 m0, s35, 0
  s_add_u32 s49, s20, 4
  s_cmp_ge_u32 s49, 6
  s_cselect_b32 s4, 6, 0
  s_sub_u32 s49, s49, s4
  s_lshr_b32 s4, s49, 1
  s_lshl_b32 s4, s4, 2
  s_add_u32 s4, s4, s49
  s_mul_i32 s4, s4, 36864
  s_add_u32 s4, s4, s33
  s_add_u32 s49, s4, 0
  s_mov_b64 exec, s[74:75]
  buffer_load_dwordx4 v1, s[12:15], s49 offen lds
  s_mov_b64 exec, -1
  v_mfma_f32_16x16x32_bf16 v[156:159], v[204:207], v[36:39], 0
  s_waitcnt lgkmcnt(6)
  ds_read_b128 v[204:207], v128 offset:26624
  v_mfma_f32_16x16x32_bf16 v[152:155], v[176:179], v[40:43], v[152:155]
  v_mfma_f32_16x16x32_bf16 v[156:159], v[176:179], v[44:47], v[156:159]
  s_waitcnt lgkmcnt(6)
  ds_read_b128 v[176:179], v132 offset:0
  v_mfma_f32_16x16x32_bf16 v[152:155], v[180:183], v[48:51], v[152:155]
  v_cvt_pk_bf16_f32 v208, v144, v145
  v_cvt_pk_bf16_f32 v209, v146, v147
  v_mfma_f32_16x16x32_bf16 v[156:159], v[180:183], v[52:55], v[156:159]
  v_cvt_pk_bf16_f32 v216, v148, v149
  v_cvt_pk_bf16_f32 v217, v150, v151
  s_waitcnt lgkmcnt(6)
  ds_read_b128 v[180:183], v133 offset:0
  v_mfma_f32_16x16x32_bf16 v[152:155], v[184:187], v[56:59], v[152:155]
  s_add_u32 m0, s35, 1024
  s_add_u32 s49, s4, 128
  buffer_load_dwordx4 v1, s[12:15], s49 offen lds
  v_mfma_f32_16x16x32_bf16 v[156:159], v[184:187], v[60:63], v[156:159]
  s_add_u32 s5, s20, 2
  s_cmp_ge_u32 s5, 6
  s_cselect_b32 s48, 6, 0
  s_sub_u32 s5, s5, s48
  s_lshl_b32 s6, s5, 10
  s_add_u32 s6, s6, s59
  s_lshl_b32 s5, s5, 15
  s_add_u32 s5, s5, s54
  s_bfe_u32 s48, s86, 0x20004
  s_mul_i32 s7, s48, 3145728
  s_add_u32 s5, s5, s7
  s_lshl_b32 s48, s48, 3
  s_add_u32 s50, s6, s48
  s_add_u32 s7, s5, 16384
  s_waitcnt lgkmcnt(6)
  ds_read_b128 v[184:187], v134 offset:0
  v_mfma_f32_16x16x32_bf16 v[152:155], v[188:191], v[64:67], v[152:155]
  v_mfma_f32_16x16x32_bf16 v[156:159], v[188:191], v[68:71], v[156:159]
  s_waitcnt lgkmcnt(6)
  ds_read_b128 v[188:191], v135 offset:0
  v_mfma_f32_16x16x32_bf16 v[152:155], v[192:195], v[72:75], v[152:155]
  v_mfma_f32_16x16x32_bf16 v[156:159], v[192:195], v[76:79], v[156:159]
  s_waitcnt lgkmcnt(6)
  ds_read_b128 v[192:195], v132 offset:1024
  v_mfma_f32_16x16x32_bf16 v[152:155], v[196:199], v[80:83], v[152:155]
  s_add_u32 m0, s35, 2048
  s_add_u32 s49, s4, 256
  s_mov_b64 exec, s[76:77]
  buffer_load_dwordx4 v1, s[12:15], s49 offen lds
  s_mov_b64 exec, -1
  v_mfma_f32_16x16x32_bf16 v[156:159], v[196:199], v[84:87], v[156:159]
  s_waitcnt lgkmcnt(6)
  ds_read_b128 v[196:199], v133 offset:1024
  v_mfma_f32_16x16x32_bf16 v[152:155], v[200:203], v[88:91], v[152:155]
  v_mfma_f32_16x16x32_bf16 v[156:159], v[200:203], v[92:95], v[156:159]
  s_waitcnt lgkmcnt(6)
  ds_read_b128 v[200:203], v134 offset:1024
  v_mfma_f32_16x16x32_bf16 v[152:155], v[204:207], v[96:99], v[152:155]
  v_mfma_f32_16x16x32_bf16 v[156:159], v[204:207], v[100:103], v[156:159]
  s_waitcnt vmcnt(14)
  s_barrier
  s_waitcnt lgkmcnt(6)
  ds_read_b128 v[204:207], v135 offset:1024
  v_mfma_f32_16x16x32_bf16 v[144:147], v[176:179], v[32:35], 0
  s_add_u32 m0, s35, 24576
  s_add_u32 s49, s4, 73728
  s_mov_b64 exec, s[74:75]
  buffer_load_dwordx4 v1, s[12:15], s49 offen lds
  s_mov_b64 exec, -1
  v_mfma_f32_16x16x32_bf16 v[148:151], v[176:179], v[36:39], 0
  s_waitcnt lgkmcnt(6)
  ds_read_b128 v[176:179], v132 offset:2048
  v_mfma_f32_16x16x32_bf16 v[144:147], v[180:183], v[40:43], v[144:147]
  v_mfma_f32_16x16x32_bf16 v[148:151], v[180:183], v[44:47], v[148:151]
  s_waitcnt lgkmcnt(6)
  ds_read_b128 v[180:183], v132 offset:24576
  v_mfma_f32_16x16x32_bf16 v[144:147], v[184:187], v[48:51], v[144:147]
  v_cvt_pk_bf16_f32 v210, v152, v153
  v_cvt_pk_bf16_f32 v212, v154, v155
  v_mfma_f32_16x16x32_bf16 v[148:151], v[184:187], v[52:55], v[148:151]
  v_cvt_pk_bf16_f32 v218, v156, v157
  v_cvt_pk_bf16_f32 v220, v158, v159
  s_waitcnt lgkmcnt(6)
  ds_read_b128 v[184:187], v133 offset:24576
  v_mfma_f32_16x16x32_bf16 v[144:147], v[188:191], v[56:59], v[144:147]
  s_add_u32 m0, s35, 25600
  s_add_u32 s49, s4, 73856
  buffer_load_dwordx4 v1, s[12:15], s49 offen lds
  v_mfma_f32_16x16x32_bf16 v[148:151], v[188:191], v[60:63], v[148:151]
  s_waitcnt lgkmcnt(6)
  ds_read_b128 v[188:191], v134 offset:24576
  v_mfma_f32_16x16x32_bf16 v[144:147], v[192:195], v[64:67], v[144:147]
  v_mfma_f32_16x16x32_bf16 v[148:151], v[192:195], v[68:71], v[148:151]
  buffer_store_dwordx3 v[208:210], v243, s[16:19], s5 offen offset:0 sc1
  s_waitcnt lgkmcnt(6)
  ds_read_b128 v[192:195], v135 offset:24576
  v_mfma_f32_16x16x32_bf16 v[144:147], v[196:199], v[72:75], v[144:147]
  v_mfma_f32_16x16x32_bf16 v[148:151], v[196:199], v[76:79], v[148:151]
  s_waitcnt lgkmcnt(6)
  ds_read_b128 v[196:199], v132 offset:25600
  v_mfma_f32_16x16x32_bf16 v[144:147], v[200:203], v[80:83], v[144:147]
  s_add_u32 m0, s35, 26624
  s_add_u32 s49, s4, 73984
  s_mov_b64 exec, s[76:77]
  buffer_load_dwordx4 v1, s[12:15], s49 offen lds
  s_mov_b64 exec, -1
  v_mfma_f32_16x16x32_bf16 v[148:151], v[200:203], v[84:87], v[148:151]
  s_waitcnt lgkmcnt(6)
  ds_read_b128 v[200:203], v133 offset:25600
  v_mfma_f32_16x16x32_bf16 v[144:147], v[204:207], v[88:91], v[144:147]
  v_mfma_f32_16x16x32_bf16 v[148:151], v[204:207], v[92:95], v[148:151]
  s_waitcnt lgkmcnt(6)
  ds_read_b128 v[204:207], v134 offset:25600
  v_mfma_f32_16x16x32_bf16 v[144:147], v[176:179], v[96:99], v[144:147]
  buffer_store_dwordx3 v[216:218], v243, s[16:19], s7 offen offset:0 sc1
  v_mfma_f32_16x16x32_bf16 v[148:151], v[176:179], v[100:103], v[148:151]
  s_waitcnt vmcnt(15)
  s_waitcnt vmcnt(8)
  s_mov_b32 exec_lo, 0x3
  s_mov_b32 exec_hi, 0x0
  buffer_store_dwordx2 v[240:241], v242, s[16:19], s51 offen sc1
  s_mov_b64 exec, -1
  s_barrier
  s_waitcnt lgkmcnt(6)
  ds_read_b128 v[176:179], v135 offset:25600
  v_mfma_f32_16x16x32_bf16 v[152:155], v[180:183], v[32:35], 0
  s_add_u32 m0, s35, 49152
  s_add_u32 s49, s4, 147456
  s_mov_b64 exec, s[74:75]
  buffer_load_dwordx4 v1, s[12:15], s49 offen lds
  s_mov_b64 exec, -1
  v_mfma_f32_16x16x32_bf16 v[156:159], v[180:183], v[36:39], 0
  s_waitcnt lgkmcnt(6)
  ds_read_b128 v[180:183], v132 offset:26624
  v_mfma_f32_16x16x32_bf16 v[152:155], v[184:187], v[40:43], v[152:155]
  v_mfma_f32_16x16x32_bf16 v[156:159], v[184:187], v[44:47], v[156:159]
  s_waitcnt lgkmcnt(6)
  ds_read_b128 v[184:187], v136 offset:0
  v_mfma_f32_16x16x32_bf16 v[152:155], v[188:191], v[48:51], v[152:155]
  v_cvt_pk_bf16_f32 v213, v144, v145
  v_cvt_pk_bf16_f32 v214, v146, v147
  v_mfma_f32_16x16x32_bf16 v[156:159], v[188:191], v[52:55], v[156:159]
  v_cvt_pk_bf16_f32 v221, v148, v149
  v_cvt_pk_bf16_f32 v222, v150, v151
  s_waitcnt lgkmcnt(6)
  ds_read_b128 v[188:191], v137 offset:0
  v_mfma_f32_16x16x32_bf16 v[152:155], v[192:195], v[56:59], v[152:155]
  s_add_u32 m0, s35, 50176
  s_add_u32 s49, s4, 147584
  buffer_load_dwordx4 v1, s[12:15], s49 offen lds
  v_mfma_f32_16x16x32_bf16 v[156:159], v[192:195], v[60:63], v[156:159]
  s_waitcnt lgkmcnt(6)
  ds_read_b128 v[192:195], v138 offset:0
  v_mfma_f32_16x16x32_bf16 v[152:155], v[196:199], v[64:67], v[152:155]
  v_mfma_f32_16x16x32_bf16 v[156:159], v[196:199], v[68:71], v[156:159]
  s_waitcnt lgkmcnt(6)
  ds_read_b128 v[196:199], v139 offset:0
  v_mfma_f32_16x16x32_bf16 v[152:155], v[200:203], v[72:75], v[152:155]
  v_mfma_f32_16x16x32_bf16 v[156:159], v[200:203], v[76:79], v[156:159]
  buffer_store_dwordx3 v[212:214], v243, s[16:19], s5 offen offset:1024 sc1
  s_waitcnt lgkmcnt(6)
  ds_read_b128 v[200:203], v136 offset:1024
  v_mfma_f32_16x16x32_bf16 v[152:155], v[204:207], v[80:83], v[152:155]
  s_add_u32 m0, s35, 51200
  s_add_u32 s49, s4, 147712
  s_mov_b64 exec, s[76:77]
  buffer_load_dwordx4 v1, s[12:15], s49 offen lds
  s_mov_b64 exec, -1
  v_mfma_f32_16x16x32_bf16 v[156:159], v[204:207], v[84:87], v[156:159]
  s_waitcnt lgkmcnt(6)
  ds_read_b128 v[204:207], v137 offset:1024
  v_mfma_f32_16x16x32_bf16 v[152:155], v[176:179], v[88:91], v[152:155]
  v_mfma_f32_16x16x32_bf16 v[156:159], v[176:179], v[92:95], v[156:159]
  buffer_store_dwordx3 v[220:222], v243, s[16:19], s7 offen offset:1024 sc1
  s_waitcnt lgkmcnt(6)
  ds_read_b128 v[176:179], v138 offset:1024
  v_mfma_f32_16x16x32_bf16 v[152:155], v[180:183], v[96:99], v[152:155]
  v_mfma_f32_16x16x32_bf16 v[156:159], v[180:183], v[100:103], v[156:159]
  s_barrier
  s_waitcnt lgkmcnt(6)
  ds_read_b128 v[180:183], v139 offset:1024
  v_mfma_f32_16x16x32_bf16 v[144:147], v[184:187], v[32:35], 0
  s_add_u32 m0, s35, 73728
  s_add_u32 s49, s20, 5
  s_cmp_ge_u32 s49, 6
  s_cselect_b32 s4, 6, 0
  s_sub_u32 s49, s49, s4
  s_lshr_b32 s4, s49, 1
  s_lshl_b32 s4, s4, 2
  s_add_u32 s4, s4, s49
  s_mul_i32 s4, s4, 36864
  s_add_u32 s4, s4, s33
  s_add_u32 s49, s4, 0
  s_mov_b64 exec, s[74:75]
  buffer_load_dwordx4 v1, s[12:15], s49 offen lds
  s_mov_b64 exec, -1
  v_mfma_f32_16x16x32_bf16 v[148:151], v[184:187], v[36:39], 0
  s_waitcnt lgkmcnt(6)
  ds_read_b128 v[184:187], v136 offset:2048
  v_mfma_f32_16x16x32_bf16 v[144:147], v[188:191], v[40:43], v[144:147]
  v_mfma_f32_16x16x32_bf16 v[148:151], v[188:191], v[44:47], v[148:151]
  s_waitcnt lgkmcnt(6)
  ds_read_b128 v[188:191], v136 offset:24576
  v_mfma_f32_16x16x32_bf16 v[144:147], v[192:195], v[48:51], v[144:147]
  v_cvt_pk_bf16_f32 v224, v152, v153
  v_cvt_pk_bf16_f32 v225, v154, v155
  v_mfma_f32_16x16x32_bf16 v[148:151], v[192:195], v[52:55], v[148:151]
  v_cvt_pk_bf16_f32 v232, v156, v157
  v_cvt_pk_bf16_f32 v233, v158, v159
  s_waitcnt lgkmcnt(6)
  ds_read_b128 v[192:195], v137 offset:24576
  v_mfma_f32_16x16x32_bf16 v[144:147], v[196:199], v[56:59], v[144:147]
  s_add_u32 m0, s35, 74752
  s_add_u32 s49, s4, 128
  buffer_load_dwordx4 v1, s[12:15], s49 offen lds
  v_mfma_f32_16x16x32_bf16 v[148:151], v[196:199], v[60:63], v[148:151]
  s_add_u32 s5, s20, 3
  s_cmp_ge_u32 s5, 6
  s_cselect_b32 s48, 6, 0
  s_sub_u32 s5, s5, s48
  s_lshl_b32 s6, s5, 10
  s_add_u32 s6, s6, s59
  s_lshl_b32 s5, s5, 15
  s_add_u32 s5, s5, s54
  s_bfe_u32 s48, s86, 0x20006
  s_mul_i32 s7, s48, 3145728
  s_add_u32 s5, s5, s7
  s_lshl_b32 s48, s48, 3
  s_add_u32 s51, s6, s48
  s_add_u32 s7, s5, 16384
  s_waitcnt lgkmcnt(6)
  ds_read_b128 v[196:199], v138 offset:24576
  v_mfma_f32_16x16x32_bf16 v[144:147], v[200:203], v[64:67], v[144:147]
  v_mfma_f32_16x16x32_bf16 v[148:151], v[200:203], v[68:71], v[148:151]
  s_waitcnt lgkmcnt(6)
  ds_read_b128 v[200:203], v139 offset:24576
  v_mfma_f32_16x16x32_bf16 v[144:147], v[204:207], v[72:75], v[144:147]
  v_mfma_f32_16x16x32_bf16 v[148:151], v[204:207], v[76:79], v[148:151]
  s_waitcnt lgkmcnt(6)
  ds_read_b128 v[204:207], v136 offset:25600
  v_mfma_f32_16x16x32_bf16 v[144:147], v[176:179], v[80:83], v[144:147]
  s_add_u32 m0, s35, 75776
  s_add_u32 s49, s4, 256
  s_mov_b64 exec, s[76:77]
  buffer_load_dwordx4 v1, s[12:15], s49 offen lds
  s_mov_b64 exec, -1
  v_mfma_f32_16x16x32_bf16 v[148:151], v[176:179], v[84:87], v[148:151]
  s_waitcnt lgkmcnt(6)
  ds_read_b128 v[176:179], v137 offset:25600
  v_mfma_f32_16x16x32_bf16 v[144:147], v[180:183], v[88:91], v[144:147]
  v_mfma_f32_16x16x32_bf16 v[148:151], v[180:183], v[92:95], v[148:151]
  s_waitcnt lgkmcnt(6)
  ds_read_b128 v[180:183], v138 offset:25600
  v_mfma_f32_16x16x32_bf16 v[144:147], v[184:187], v[96:99], v[144:147]
  v_mfma_f32_16x16x32_bf16 v[148:151], v[184:187], v[100:103], v[148:151]
  s_waitcnt vmcnt(14)
  s_barrier
  s_waitcnt lgkmcnt(6)
  ds_read_b128 v[184:187], v139 offset:25600
  v_mfma_f32_16x16x32_bf16 v[152:155], v[188:191], v[32:35], 0
  s_add_u32 m0, s35, 98304
  s_add_u32 s49, s4, 73728
  s_mov_b64 exec, s[74:75]
  buffer_load_dwordx4 v1, s[12:15], s49 offen lds
  s_mov_b64 exec, -1
  v_mfma_f32_16x16x32_bf16 v[156:159], v[188:191], v[36:39], 0
  s_waitcnt lgkmcnt(6)
  ds_read_b128 v[188:191], v136 offset:26624
  v_mfma_f32_16x16x32_bf16 v[152:155], v[192:195], v[40:43], v[152:155]
  v_mfma_f32_16x16x32_bf16 v[156:159], v[192:195], v[44:47], v[156:159]
  s_waitcnt lgkmcnt(6)
  ds_read_b128 v[192:195], v128 offset:0
  v_mfma_f32_16x16x32_bf16 v[152:155], v[196:199], v[48:51], v[152:155]
  v_cvt_pk_bf16_f32 v226, v144, v145
  v_cvt_pk_bf16_f32 v228, v146, v147
  v_mfma_f32_16x16x32_bf16 v[156:159], v[196:199], v[52:55], v[156:159]
  v_cvt_pk_bf16_f32 v234, v148, v149
  v_cvt_pk_bf16_f32 v236, v150, v151
  s_waitcnt lgkmcnt(6)
  ds_read_b128 v[196:199], v129 offset:0
  v_mfma_f32_16x16x32_bf16 v[152:155], v[200:203], v[56:59], v[152:155]
  s_add_u32 m0, s35, 99328
  s_add_u32 s49, s4, 73856
  buffer_load_dwordx4 v1, s[12:15], s49 offen lds
  v_mfma_f32_16x16x32_bf16 v[156:159], v[200:203], v[60:63], v[156:159]
  s_waitcnt lgkmcnt(6)
  ds_read_b128 v[200:203], v130 offset:0
  v_mfma_f32_16x16x32_bf16 v[152:155], v[204:207], v[64:67], v[152:155]
  v_mfma_f32_16x16x32_bf16 v[156:159], v[204:207], v[68:71], v[156:159]
  buffer_store_dwordx3 v[224:226], v243, s[16:19], s5 offen offset:0 sc1
  s_waitcnt lgkmcnt(6)
  ds_read_b128 v[204:207], v131 offset:0
  v_mfma_f32_16x16x32_bf16 v[152:155], v[176:179], v[72:75], v[152:155]
  v_mfma_f32_16x16x32_bf16 v[156:159], v[176:179], v[76:79], v[156:159]
  s_waitcnt lgkmcnt(6)
  ds_read_b128 v[176:179], v128 offset:1024
  v_mfma_f32_16x16x32_bf16 v[152:155], v[180:183], v[80:83], v[152:155]
  s_add_u32 m0, s35, 100352
  s_add_u32 s49, s4, 73984
  s_mov_b64 exec, s[76:77]
  buffer_load_dwordx4 v1, s[12:15], s49 offen lds
  s_mov_b64 exec, -1
  v_mfma_f32_16x16x32_bf16 v[156:159], v[180:183], v[84:87], v[156:159]
  s_waitcnt lgkmcnt(6)
  ds_read_b128 v[180:183], v129 offset:1024
  v_mfma_f32_16x16x32_bf16 v[152:155], v[184:187], v[88:91], v[152:155]
  v_mfma_f32_16x16x32_bf16 v[156:159], v[184:187], v[92:95], v[156:159]
  s_waitcnt lgkmcnt(6)
  ds_read_b128 v[184:187], v130 offset:1024
  v_mfma_f32_16x16x32_bf16 v[152:155], v[188:191], v[96:99], v[152:155]
  buffer_store_dwordx3 v[232:234], v243, s[16:19], s7 offen offset:0 sc1
  v_mfma_f32_16x16x32_bf16 v[156:159], v[188:191], v[100:103], v[156:159]
  s_waitcnt vmcnt(15)
  s_waitcnt vmcnt(8)
  s_mov_b32 exec_lo, 0x3
  s_mov_b32 exec_hi, 0x0
  buffer_store_dwordx2 v[240:241], v242, s[16:19], s50 offen sc1
  s_mov_b64 exec, -1
  s_barrier
  s_waitcnt lgkmcnt(6)
  ds_read_b128 v[188:191], v131 offset:1024
  v_mfma_f32_16x16x32_bf16 v[144:147], v[192:195], v[32:35], 0
  s_add_u32 m0, s35, 122880
  s_add_u32 s49, s4, 147456
  s_mov_b64 exec, s[74:75]
  buffer_load_dwordx4 v1, s[12:15], s49 offen lds
  s_mov_b64 exec, -1
  v_mfma_f32_16x16x32_bf16 v[148:151], v[192:195], v[36:39], 0
  s_waitcnt lgkmcnt(6)
  ds_read_b128 v[192:195], v128 offset:2048
  v_mfma_f32_16x16x32_bf16 v[144:147], v[196:199], v[40:43], v[144:147]
  v_mfma_f32_16x16x32_bf16 v[148:151], v[196:199], v[44:47], v[148:151]
  s_waitcnt lgkmcnt(6)
  ds_read_b128 v[196:199], v128 offset:24576
  v_mfma_f32_16x16x32_bf16 v[144:147], v[200:203], v[48:51], v[144:147]
  v_cvt_pk_bf16_f32 v229, v152, v153
  v_cvt_pk_bf16_f32 v230, v154, v155
  v_mfma_f32_16x16x32_bf16 v[148:151], v[200:203], v[52:55], v[148:151]
  v_cvt_pk_bf16_f32 v237, v156, v157
  v_cvt_pk_bf16_f32 v238, v158, v159
  s_waitcnt lgkmcnt(6)
  ds_read_b128 v[200:203], v129 offset:24576
  v_mfma_f32_16x16x32_bf16 v[144:147], v[204:207], v[56:59], v[144:147]
  s_add_u32 m0, s35, 123904
  s_add_u32 s49, s4, 147584
  buffer_load_dwordx4 v1, s[12:15], s49 offen lds
  v_mfma_f32_16x16x32_bf16 v[148:151], v[204:207], v[60:63], v[148:151]
  s_waitcnt lgkmcnt(6)
  ds_read_b128 v[204:207], v130 offset:24576
  v_mfma_f32_16x16x32_bf16 v[144:147], v[176:179], v[64:67], v[144:147]
  v_mfma_f32_16x16x32_bf16 v[148:151], v[176:179], v[68:71], v[148:151]
  s_waitcnt lgkmcnt(6)
  ds_read_b128 v[176:179], v131 offset:24576
  v_mfma_f32_16x16x32_bf16 v[144:147], v[180:183], v[72:75], v[144:147]
  v_mfma_f32_16x16x32_bf16 v[148:151], v[180:183], v[76:79], v[148:151]
  buffer_store_dwordx3 v[228:230], v243, s[16:19], s5 offen offset:1024 sc1
  s_waitcnt lgkmcnt(6)
  ds_read_b128 v[180:183], v128 offset:25600
  v_mfma_f32_16x16x32_bf16 v[144:147], v[184:187], v[80:83], v[144:147]
  s_add_u32 m0, s35, 124928
  s_add_u32 s49, s4, 147712
  s_mov_b64 exec, s[76:77]
  buffer_load_dwordx4 v1, s[12:15], s49 offen lds
  s_mov_b64 exec, -1
  v_mfma_f32_16x16x32_bf16 v[148:151], v[184:187], v[84:87], v[148:151]
  s_waitcnt lgkmcnt(6)
  ds_read_b128 v[184:187], v129 offset:25600
  v_mfma_f32_16x16x32_bf16 v[144:147], v[188:191], v[88:91], v[144:147]
  v_mfma_f32_16x16x32_bf16 v[148:151], v[188:191], v[92:95], v[148:151]
  buffer_store_dwordx3 v[236:238], v243, s[16:19], s7 offen offset:1024 sc1
  s_waitcnt lgkmcnt(6)
  ds_read_b128 v[188:191], v130 offset:25600
  v_mfma_f32_16x16x32_bf16 v[144:147], v[192:195], v[96:99], v[144:147]
  v_mfma_f32_16x16x32_bf16 v[148:151], v[192:195], v[100:103], v[148:151]
  s_barrier
  s_waitcnt lgkmcnt(6)
  ds_read_b128 v[192:195], v131 offset:25600
  v_mfma_f32_16x16x32_bf16 v[152:155], v[196:199], v[32:35], 0
  v_mfma_f32_16x16x32_bf16 v[156:159], v[196:199], v[36:39], 0
  s_waitcnt lgkmcnt(6)
  ds_read_b128 v[196:199], v128 offset:26624
  v_mfma_f32_16x16x32_bf16 v[152:155], v[200:203], v[40:43], v[152:155]
  v_mfma_f32_16x16x32_bf16 v[156:159], v[200:203], v[44:47], v[156:159]
  s_waitcnt lgkmcnt(6)
  ds_read_b128 v[200:203], v132 offset:0
  v_mfma_f32_16x16x32_bf16 v[152:155], v[204:207], v[48:51], v[152:155]
  v_cvt_pk_bf16_f32 v208, v144, v145
  v_cvt_pk_bf16_f32 v209, v146, v147
  v_mfma_f32_16x16x32_bf16 v[156:159], v[204:207], v[52:55], v[156:159]
  v_cvt_pk_bf16_f32 v216, v148, v149
  v_cvt_pk_bf16_f32 v217, v150, v151
  s_waitcnt lgkmcnt(6)
  ds_read_b128 v[204:207], v133 offset:0
  v_mfma_f32_16x16x32_bf16 v[152:155], v[176:179], v[56:59], v[152:155]
  s_add_u32 s5, s20, 4
  s_cmp_ge_u32 s5, 6
  s_cselect_b32 s48, 6, 0
  s_sub_u32 s5, s5, s48
  s_lshl_b32 s6, s5, 10
  s_add_u32 s6, s6, s59
  s_lshl_b32 s5, s5, 15
  s_add_u32 s5, s5, s54
  s_bfe_u32 s48, s86, 0x20008
  s_mul_i32 s7, s48, 3145728
  s_add_u32 s5, s5, s7
  s_lshl_b32 s48, s48, 3
  s_add_u32 s50, s6, s48
  s_add_u32 s7, s5, 16384
  v_mfma_f32_16x16x32_bf16 v[156:159], v[176:179], v[60:63], v[156:159]
  s_waitcnt lgkmcnt(6)
  ds_read_b128 v[176:179], v134 offset:0
  v_mfma_f32_16x16x32_bf16 v[152:155], v[180:183], v[64:67], v[152:155]
  v_mfma_f32_16x16x32_bf16 v[156:159], v[180:183], v[68:71], v[156:159]
  s_waitcnt lgkmcnt(6)
  ds_read_b128 v[180:183], v135 offset:0
  v_mfma_f32_16x16x32_bf16 v[152:155], v[184:187], v[72:75], v[152:155]
  v_mfma_f32_16x16x32_bf16 v[156:159], v[184:187], v[76:79], v[156:159]
  s_waitcnt lgkmcnt(6)
  ds_read_b128 v[184:187], v132 offset:1024
  v_mfma_f32_16x16x32_bf16 v[152:155], v[188:191], v[80:83], v[152:155]
  v_mfma_f32_16x16x32_bf16 v[156:159], v[188:191], v[84:87], v[156:159]
  s_waitcnt lgkmcnt(6)
  ds_read_b128 v[188:191], v133 offset:1024
  v_mfma_f32_16x16x32_bf16 v[152:155], v[192:195], v[88:91], v[152:155]
  v_mfma_f32_16x16x32_bf16 v[156:159], v[192:195], v[92:95], v[156:159]
  s_waitcnt lgkmcnt(6)
  ds_read_b128 v[192:195], v134 offset:1024
  v_mfma_f32_16x16x32_bf16 v[152:155], v[196:199], v[96:99], v[152:155]
  v_mfma_f32_16x16x32_bf16 v[156:159], v[196:199], v[100:103], v[156:159]
  s_waitcnt vmcnt(11)
  s_barrier
  s_waitcnt lgkmcnt(6)
  ds_read_b128 v[196:199], v135 offset:1024
  v_mfma_f32_16x16x32_bf16 v[144:147], v[200:203], v[32:35], 0
  v_mfma_f32_16x16x32_bf16 v[148:151], v[200:203], v[36:39], 0
  s_waitcnt lgkmcnt(6)
  ds_read_b128 v[200:203], v132 offset:2048
  v_mfma_f32_16x16x32_bf16 v[144:147], v[204:207], v[40:43], v[144:147]
  v_mfma_f32_16x16x32_bf16 v[148:151], v[204:207], v[44:47], v[148:151]
  s_waitcnt lgkmcnt(6)
  ds_read_b128 v[204:207], v132 offset:24576
  v_mfma_f32_16x16x32_bf16 v[144:147], v[176:179], v[48:51], v[144:147]
  v_cvt_pk_bf16_f32 v210, v152, v153
  v_cvt_pk_bf16_f32 v212, v154, v155
  v_mfma_f32_16x16x32_bf16 v[148:151], v[176:179], v[52:55], v[148:151]
  v_cvt_pk_bf16_f32 v218, v156, v157
  v_cvt_pk_bf16_f32 v220, v158, v159
  s_waitcnt lgkmcnt(6)
  ds_read_b128 v[176:179], v133 offset:24576
  v_mfma_f32_16x16x32_bf16 v[144:147], v[180:183], v[56:59], v[144:147]
  v_mfma_f32_16x16x32_bf16 v[148:151], v[180:183], v[60:63], v[148:151]
  s_waitcnt lgkmcnt(6)
  ds_read_b128 v[180:183], v134 offset:24576
  v_mfma_f32_16x16x32_bf16 v[144:147], v[184:187], v[64:67], v[144:147]
  buffer_store_dwordx3 v[208:210], v243, s[16:19], s5 offen offset:0 sc1
  v_mfma_f32_16x16x32_bf16 v[148:151], v[184:187], v[68:71], v[148:151]
  s_waitcnt lgkmcnt(6)
  ds_read_b128 v[184:187], v135 offset:24576
  v_mfma_f32_16x16x32_bf16 v[144:147], v[188:191], v[72:75], v[144:147]
  v_mfma_f32_16x16x32_bf16 v[148:151], v[188:191], v[76:79], v[148:151]
  s_waitcnt lgkmcnt(6)
  ds_read_b128 v[188:191], v132 offset:25600
  v_mfma_f32_16x16x32_bf16 v[144:147], v[192:195], v[80:83], v[144:147]
  v_mfma_f32_16x16x32_bf16 v[148:151], v[192:195], v[84:87], v[148:151]
  s_waitcnt lgkmcnt(6)
  ds_read_b128 v[192:195], v133 offset:25600
  v_mfma_f32_16x16x32_bf16 v[144:147], v[196:199], v[88:91], v[144:147]
  buffer_store_dwordx3 v[216:218], v243, s[16:19], s7 offen offset:0 sc1
  v_mfma_f32_16x16x32_bf16 v[148:151], v[196:199], v[92:95], v[148:151]
  s_waitcnt lgkmcnt(6)
  ds_read_b128 v[196:199], v134 offset:25600
  v_mfma_f32_16x16x32_bf16 v[144:147], v[200:203], v[96:99], v[144:147]
  v_mfma_f32_16x16x32_bf16 v[148:151], v[200:203], v[100:103], v[148:151]
  s_waitcnt vmcnt(9)
  s_waitcnt vmcnt(2)
  s_mov_b32 exec_lo, 0x3
  s_mov_b32 exec_hi, 0x0
  buffer_store_dwordx2 v[240:241], v242, s[16:19], s51 offen sc1
  s_mov_b64 exec, -1
  s_barrier
  s_waitcnt lgkmcnt(6)
  ds_read_b128 v[200:203], v135 offset:25600
  v_mfma_f32_16x16x32_bf16 v[152:155], v[204:207], v[32:35], 0
  v_mfma_f32_16x16x32_bf16 v[156:159], v[204:207], v[36:39], 0
  s_waitcnt lgkmcnt(6)
  ds_read_b128 v[204:207], v132 offset:26624
  v_mfma_f32_16x16x32_bf16 v[152:155], v[176:179], v[40:43], v[152:155]
  v_mfma_f32_16x16x32_bf16 v[156:159], v[176:179], v[44:47], v[156:159]
  s_waitcnt lgkmcnt(6)
  ds_read_b128 v[176:179], v136 offset:0
  v_mfma_f32_16x16x32_bf16 v[152:155], v[180:183], v[48:51], v[152:155]
  v_cvt_pk_bf16_f32 v213, v144, v145
  v_cvt_pk_bf16_f32 v214, v146, v147
  v_mfma_f32_16x16x32_bf16 v[156:159], v[180:183], v[52:55], v[156:159]
  v_cvt_pk_bf16_f32 v221, v148, v149
  v_cvt_pk_bf16_f32 v222, v150, v151
  s_waitcnt lgkmcnt(6)
  ds_read_b128 v[180:183], v137 offset:0
  v_mfma_f32_16x16x32_bf16 v[152:155], v[184:187], v[56:59], v[152:155]
  v_mfma_f32_16x16x32_bf16 v[156:159], v[184:187], v[60:63], v[156:159]
  s_waitcnt lgkmcnt(6)
  ds_read_b128 v[184:187], v138 offset:0
  v_mfma_f32_16x16x32_bf16 v[152:155], v[188:191], v[64:67], v[152:155]
  v_mfma_f32_16x16x32_bf16 v[156:159], v[188:191], v[68:71], v[156:159]
  s_waitcnt lgkmcnt(6)
  ds_read_b128 v[188:191], v139 offset:0
  v_mfma_f32_16x16x32_bf16 v[152:155], v[192:195], v[72:75], v[152:155]
  buffer_store_dwordx3 v[212:214], v243, s[16:19], s5 offen offset:1024 sc1
  v_mfma_f32_16x16x32_bf16 v[156:159], v[192:195], v[76:79], v[156:159]
  s_waitcnt lgkmcnt(6)
  ds_read_b128 v[192:195], v136 offset:1024
  v_mfma_f32_16x16x32_bf16 v[152:155], v[196:199], v[80:83], v[152:155]
  v_mfma_f32_16x16x32_bf16 v[156:159], v[196:199], v[84:87], v[156:159]
  buffer_store_dwordx3 v[220:222], v243, s[16:19], s7 offen offset:1024 sc1
  s_waitcnt lgkmcnt(6)
  ds_read_b128 v[196:199], v137 offset:1024
  v_mfma_f32_16x16x32_bf16 v[152:155], v[200:203], v[88:91], v[152:155]
  v_mfma_f32_16x16x32_bf16 v[156:159], v[200:203], v[92:95], v[156:159]
  s_waitcnt lgkmcnt(6)
  ds_read_b128 v[200:203], v138 offset:1024
  v_mfma_f32_16x16x32_bf16 v[152:155], v[204:207], v[96:99], v[152:155]
  v_mfma_f32_16x16x32_bf16 v[156:159], v[204:207], v[100:103], v[156:159]
  s_barrier
  s_waitcnt lgkmcnt(6)
  ds_read_b128 v[204:207], v139 offset:1024
  v_mfma_f32_16x16x32_bf16 v[144:147], v[176:179], v[32:35], 0
  v_mfma_f32_16x16x32_bf16 v[148:151], v[176:179], v[36:39], 0
  s_waitcnt lgkmcnt(6)
  ds_read_b128 v[176:179], v136 offset:2048
  v_mfma_f32_16x16x32_bf16 v[144:147], v[180:183], v[40:43], v[144:147]
  v_mfma_f32_16x16x32_bf16 v[148:151], v[180:183], v[44:47], v[148:151]
  s_waitcnt lgkmcnt(6)
  ds_read_b128 v[180:183], v136 offset:24576
  v_mfma_f32_16x16x32_bf16 v[144:147], v[184:187], v[48:51], v[144:147]
  v_cvt_pk_bf16_f32 v224, v152, v153
  v_cvt_pk_bf16_f32 v225, v154, v155
  v_mfma_f32_16x16x32_bf16 v[148:151], v[184:187], v[52:55], v[148:151]
  v_cvt_pk_bf16_f32 v232, v156, v157
  v_cvt_pk_bf16_f32 v233, v158, v159
  s_waitcnt lgkmcnt(6)
  ds_read_b128 v[184:187], v137 offset:24576
  v_mfma_f32_16x16x32_bf16 v[144:147], v[188:191], v[56:59], v[144:147]
  s_add_u32 s5, s20, 5
  s_cmp_ge_u32 s5, 6
  s_cselect_b32 s48, 6, 0
  s_sub_u32 s5, s5, s48
  s_lshl_b32 s6, s5, 10
  s_add_u32 s6, s6, s59
  s_lshl_b32 s5, s5, 15
  s_add_u32 s5, s5, s54
  s_bfe_u32 s48, s86, 0x2000a
  s_mul_i32 s7, s48, 3145728
  s_add_u32 s5, s5, s7
  s_lshl_b32 s48, s48, 3
  s_add_u32 s51, s6, s48
  s_add_u32 s7, s5, 16384
  v_mfma_f32_16x16x32_bf16 v[148:151], v[188:191], v[60:63], v[148:151]
  s_waitcnt lgkmcnt(6)
  ds_read_b128 v[188:191], v138 offset:24576
  v_mfma_f32_16x16x32_bf16 v[144:147], v[192:195], v[64:67], v[144:147]
  v_mfma_f32_16x16x32_bf16 v[148:151], v[192:195], v[68:71], v[148:151]
  s_waitcnt lgkmcnt(6)
  ds_read_b128 v[192:195], v139 offset:24576
  v_mfma_f32_16x16x32_bf16 v[144:147], v[196:199], v[72:75], v[144:147]
  v_mfma_f32_16x16x32_bf16 v[148:151], v[196:199], v[76:79], v[148:151]
  s_waitcnt lgkmcnt(6)
  ds_read_b128 v[196:199], v136 offset:25600
  v_mfma_f32_16x16x32_bf16 v[144:147], v[200:203], v[80:83], v[144:147]
  v_mfma_f32_16x16x32_bf16 v[148:151], v[200:203], v[84:87], v[148:151]
  s_waitcnt lgkmcnt(6)
  ds_read_b128 v[200:203], v137 offset:25600
  v_mfma_f32_16x16x32_bf16 v[144:147], v[204:207], v[88:91], v[144:147]
  v_mfma_f32_16x16x32_bf16 v[148:151], v[204:207], v[92:95], v[148:151]
  s_waitcnt lgkmcnt(6)
  ds_read_b128 v[204:207], v138 offset:25600
  v_mfma_f32_16x16x32_bf16 v[144:147], v[176:179], v[96:99], v[144:147]
  v_mfma_f32_16x16x32_bf16 v[148:151], v[176:179], v[100:103], v[148:151]
  s_waitcnt vmcnt(0)
  s_mov_b32 exec_lo, 0x3
  s_mov_b32 exec_hi, 0x0
  buffer_store_dwordx2 v[240:241], v242, s[16:19], s50 offen sc1
  s_mov_b64 exec, -1
  s_barrier
  s_waitcnt lgkmcnt(6)
  ds_read_b128 v[176:179], v139 offset:25600
  v_mfma_f32_16x16x32_bf16 v[152:155], v[180:183], v[32:35], 0
  v_mfma_f32_16x16x32_bf16 v[156:159], v[180:183], v[36:39], 0
  s_waitcnt lgkmcnt(6)
  ds_read_b128 v[180:183], v136 offset:26624
  v_mfma_f32_16x16x32_bf16 v[152:155], v[184:187], v[40:43], v[152:155]
  v_mfma_f32_16x16x32_bf16 v[156:159], v[184:187], v[44:47], v[156:159]
  s_waitcnt lgkmcnt(6)
  v_mfma_f32_16x16x32_bf16 v[152:155], v[188:191], v[48:51], v[152:155]
  v_cvt_pk_bf16_f32 v226, v144, v145
  v_cvt_pk_bf16_f32 v228, v146, v147
  v_mfma_f32_16x16x32_bf16 v[156:159], v[188:191], v[52:55], v[156:159]
  v_cvt_pk_bf16_f32 v234, v148, v149
  v_cvt_pk_bf16_f32 v236, v150, v151
  s_waitcnt lgkmcnt(5)
  v_mfma_f32_16x16x32_bf16 v[152:155], v[192:195], v[56:59], v[152:155]
  v_mfma_f32_16x16x32_bf16 v[156:159], v[192:195], v[60:63], v[156:159]
  s_waitcnt lgkmcnt(4)
  v_mfma_f32_16x16x32_bf16 v[152:155], v[196:199], v[64:67], v[152:155]
  buffer_store_dwordx3 v[224:226], v243, s[16:19], s5 offen offset:0 sc1
  v_mfma_f32_16x16x32_bf16 v[156:159], v[196:199], v[68:71], v[156:159]
  s_waitcnt lgkmcnt(3)
  v_mfma_f32_16x16x32_bf16 v[152:155], v[200:203], v[72:75], v[152:155]
  v_mfma_f32_16x16x32_bf16 v[156:159], v[200:203], v[76:79], v[156:159]
  s_waitcnt lgkmcnt(2)
  v_mfma_f32_16x16x32_bf16 v[152:155], v[204:207], v[80:83], v[152:155]
  v_mfma_f32_16x16x32_bf16 v[156:159], v[204:207], v[84:87], v[156:159]
  s_waitcnt lgkmcnt(1)
  v_mfma_f32_16x16x32_bf16 v[152:155], v[176:179], v[88:91], v[152:155]
  buffer_store_dwordx3 v[232:234], v243, s[16:19], s7 offen offset:0 sc1
  v_mfma_f32_16x16x32_bf16 v[156:159], v[176:179], v[92:95], v[156:159]
  s_waitcnt lgkmcnt(0)
  v_mfma_f32_16x16x32_bf16 v[152:155], v[180:183], v[96:99], v[152:155]
  v_mfma_f32_16x16x32_bf16 v[156:159], v[180:183], v[100:103], v[156:159]
  s_nop 6
  v_cvt_pk_bf16_f32 v229, v152, v153
  v_cvt_pk_bf16_f32 v230, v154, v155
  v_cvt_pk_bf16_f32 v237, v156, v157
  v_cvt_pk_bf16_f32 v238, v158, v159
  buffer_store_dwordx3 v[228:230], v243, s[16:19], s5 offen offset:1024 sc1
  buffer_store_dwordx3 v[236:238], v243, s[16:19], s7 offen offset:1024 sc1
  s_waitcnt vmcnt(0)
  s_mov_b32 exec_lo, 0x3
  s_mov_b32 exec_hi, 0x0
  buffer_store_dwordx2 v[240:241], v242, s[16:19], s51 offen sc1
  s_mov_b64 exec, -1
  s_lshl_b32 s46, s28, 7
  s_add_u32 s46, s46, 2048
  s_xor_b32 s47, s27, 15
  s_or_b32 s47, s47, s24
  s_cmp_eq_u32 s47, 0
  s_cbranch_scc0 L_skip_12
  v_mov_b32 v1, s34
  s_mov_b64 exec, 1
  buffer_store_dword v1, v0, s[16:19], s46 offen sc1
  s_mov_b64 exec, -1
L_skip_12:
  s_endpgm
L_slow_r_9:
  s_mov_b32 s56, 0x80000
L_spin_r_9:
  s_nop 1
  buffer_load_dwordx4 v[144:147], v188, s[16:19], s42 offen sc1
  buffer_load_dwordx4 v[148:151], v189, s[16:19], s42 offen sc1
  buffer_load_dwordx4 v[152:155], v190, s[16:19], s42 offen sc1
  buffer_load_dwordx4 v[156:159], v191, s[16:19], s42 offen sc1
  s_waitcnt vmcnt(0)
  v_xor_b32 v146, v146, v192
  v_xor_b32 v147, v147, v193
  v_or3_b32 v201, v146, v147, 0
  v_xor_b32 v150, v150, v194
  v_xor_b32 v151, v151, v195
  v_or3_b32 v201, v150, v151, v201
  v_xor_b32 v154, v154, v196
  v_xor_b32 v155, v155, v197
  v_or3_b32 v201, v154, v155, v201
  v_xor_b32 v158, v158, v198
  v_xor_b32 v159, v159, v199
  v_or3_b32 v201, v158, v159, v201
  v_cmp_ne_u32 vcc, 0, v201
  s_nop 0
  s_cmp_eq_u64 vcc, 0
  s_cbranch_scc1 L_back_r_9
  s_sub_u32 s56, s56, 1
  s_cmp_lg_u32 s56, 0
  s_cbranch_scc1 L_spin_r_9
  s_branch L_back_r_9
L_slow_r_11:
  s_mov_b32 s56, 0x80000
L_spin_r_11:
  s_nop 1
  buffer_load_dwordx4 v[144:147], v188, s[16:19], s43 offen sc1
  buffer_load_dwordx4 v[148:151], v189, s[16:19], s43 offen sc1
  buffer_load_dwordx4 v[152:155], v190, s[16:19], s43 offen sc1
  buffer_load_dwordx4 v[156:159], v191, s[16:19], s43 offen sc1
  s_waitcnt vmcnt(0)
  v_xor_b32 v146, v146, v192
  v_xor_b32 v147, v147, v193
  v_or3_b32 v201, v146, v147, 0
  v_xor_b32 v150, v150, v194
  v_xor_b32 v151, v151, v195
  v_or3_b32 v201, v150, v151, v201
  v_xor_b32 v154, v154, v196
  v_xor_b32 v155, v155, v197
  v_or3_b32 v201, v154, v155, v201
  v_xor_b32 v158, v158, v198
  v_xor_b32 v159, v159, v199
  v_or3_b32 v201, v158, v159, v201
  v_cmp_ne_u32 vcc, 0, v201
  s_nop 0
  s_cmp_eq_u64 vcc, 0
  s_cbranch_scc1 L_back_r_11
  s_sub_u32 s56, s56, 1
  s_cmp_lg_u32 s56, 0
  s_cbranch_scc1 L_spin_r_11
  s_branch L_back_r_11
L_end:
  s_endpgm
L_code_end:
.section .rodata,"a"
.p2align 6
.amdhsa_kernel recurrent_scan__ssm_conv_s5__dense_activation_silu__prompt_kernel
  .amdhsa_next_free_vgpr 256
  .amdhsa_next_free_sgpr 102
  .amdhsa_accum_offset 256
  .amdhsa_group_segment_fixed_size 0
  .amdhsa_kernarg_size 120
  .amdhsa_user_sgpr_count 2
  .amdhsa_user_sgpr_kernarg_segment_ptr 1
  .amdhsa_system_sgpr_workgroup_id_x 1
  .amdhsa_float_denorm_mode_32 3
.end_amdhsa_kernel
```
